```python
import torch

def _softmax(x, axis=-1):
    return torch.softmax(x, dim=axis)
def _gelu(x):
    return torch.nn.functional.gelu(x, approximate="tanh")
def _silu(x):
    return torch.nn.functional.silu(x)
def _sigmoid(x):
    return torch.sigmoid(x)
def _layernorm(x, axis=-1, eps=1e-5):
    m = x.mean(dim=axis, keepdim=True)
    v = x.var(dim=axis, keepdim=True, unbiased=False)
    return (x - m) / torch.sqrt(v + eps)
def _scatter_add(tgt, idx, src, axis=0):
    return tgt.clone().index_add_(axis, idx, src)
def _segment_sum(src, seg, n):
    out = torch.zeros((n,) + src.shape[1:], dtype=src.dtype)
    return out.index_add_(0, seg, src)
def _pad(x, pw):
    flat = tuple(v for pair in reversed(pw) for v in pair)
    return torch.nn.functional.pad(x, flat)

kernel_name = 'recurrent_scan__ssm_conv_s4d__dense_activation_silu__prompt'

def setup_inputs():

    _w = (lambda a: (lambda t: t.to(torch.bfloat16) if t.is_floating_point() else t)(torch.as_tensor(a)))
    def _A_setup():
        Bsz, L, D, N = 1, 2048, 640, 128
        return {
            "u": _w((lambda *s: torch.randn(*s, dtype=torch.bfloat16) * 0.05)(Bsz, L, D)),
            "log_A_real": _w((lambda *s: torch.randn(*s, dtype=torch.bfloat16) * 6.4)(D, N) * 0.5),
            "A_imag": _w((lambda *s: torch.randn(*s, dtype=torch.bfloat16) * 0.2)(D, N) * 3.14),
            "C_real": _w((lambda *s: torch.randn(*s, dtype=torch.bfloat16) * 0.4)(D, N) / N ** 0.5),
            "C_imag": _w((lambda *s: torch.randn(*s, dtype=torch.bfloat16) * 0.4)(D, N) / N ** 0.5),
            "log_dt": _w((lambda *s: torch.randn(*s, dtype=torch.bfloat16) * 0.2)(D) * 0.5 - 4.0),
            "D_skip": _w((lambda *s: torch.randn(*s, dtype=torch.bfloat16) * 0.2)(D)),
        }
    _A_in = _A_setup()

    def _B_setup():
        B, S, D, F = 1, 2048, 640, 1728
        return {
            "x": _w((lambda *s: torch.randn(*s, dtype=torch.bfloat16) * 0.05)(B, S, D)),
            "w1": _w((lambda *s: torch.randn(*s, dtype=torch.bfloat16) * 0.8)(D, F) * (D ** -0.5)),
            "w2": _w((lambda *s: torch.randn(*s, dtype=torch.bfloat16) * 0.1)(F, D) * (F ** -0.5)),
        }
    _B_in = _B_setup()

    return {
        "A_u": _A_in["u"],
        "A_log_A_real": _A_in["log_A_real"],
        "A_A_imag": _A_in["A_imag"],
        "A_C_real": _A_in["C_real"],
        "A_C_imag": _A_in["C_imag"],
        "A_log_dt": _A_in["log_dt"],
        "A_D_skip": _A_in["D_skip"],
        "B_x": _B_in["x"],
        "B_w1": _B_in["w1"],
        "B_w2": _B_in["w2"],
    }

def reference(A_u, A_log_A_real, A_A_imag, A_C_real, A_C_imag, A_log_dt, A_D_skip, B_x, B_w1, B_w2):
    def _A_ref(u, log_A_real, A_imag, C_real, C_imag, log_dt, D_skip):
        L = u.shape[1]
        dt = torch.exp(log_dt)
        A = -torch.exp(log_A_real) + 1j * A_imag
        C = (C_real + 1j * C_imag) * dt[:, None]
        pos = (lambda x, dt: x.to(dt))(torch.arange(L), log_dt.dtype)
        P = torch.exp((A * dt[:, None])[:, :, None] * pos[None, None, :])
        K = 2.0 * torch.einsum("dn,dnl->dl", C, P).real
        L2 = 2 * L
        u_t = (lambda x, *d: x.permute(*d))(u, 0, 2, 1)
        Kf = (lambda x, *a, **k: torch.fft.rfft(x.float(), *a, **k))(K, L2)
        Uf = (lambda x, *a, **k: torch.fft.rfft(x.float(), *a, **k))(u_t, L2)
        y = (lambda x, *a, **k: torch.fft.irfft(x, *a, **k).to(torch.bfloat16))(Uf * Kf[None, :, :], L2)[:, :, :L]
        y = (lambda x, *d: x.permute(*d))(y, 0, 2, 1)
        return y + u * D_skip[None, None, :]

    def _B_ref(x, w1, w2):
        h = torch.einsum("bsd,df->bsf", x, w1)
        h = _silu(h)
        out = torch.einsum("bsf,fd->bsd", h, w2)
        return out

    x = A_u
    xn = _layernorm(x, axis=-1)
    s = _A_ref(xn, A_log_A_real, A_A_imag, A_C_real, A_C_imag, A_log_dt, A_D_skip)
    g = _silu(_B_ref(xn, B_w1, B_w2))
    return x + s * g
```

```asm
; @launch kernel=l1_kernel grid=(256,1,1) block=(704,1,1) lds=149520
; @launch kernel=l2_kernel grid=(256,1,1) block=(512,1,1) lds=153920
.amdgcn_target "amdgcn-amd-amdhsa--gfx950"
.text
.globl l1_kernel
.p2align 8
.type l1_kernel,@function
l1_kernel:
s_cmp_ge_u32 s2, 256
s_cbranch_scc1 l1_kernel_end
s_load_dwordx2 s[24:25], s[0:1], 0
s_load_dwordx2 s[28:29], s[0:1], 64
s_load_dwordx2 s[26:27], s[0:1], 96
s_and_b32 s20, s2, 7
s_lshr_b32 s21, s2, 3
s_cmp_ge_u32 s21, 28
s_cbranch_scc1 l1_kernel_spare
v_lshrrev_b32 v1, 6, v0
s_nop 0
v_readfirstlane_b32 s6, v1
s_and_b32 s4, s20, 3
s_lshl_b32 s4, s4, 2
s_and_b32 s22, s21, 3
s_add_u32 s4, s4, s22
s_lshr_b32 s5, s20, 2
s_mul_i32 s5, s5, 7
s_lshr_b32 s23, s21, 2
s_add_u32 s5, s5, s23
s_mov_b32 s30, 0
s_mov_b32 s74, s5
v_and_b32 v1, 63, v0
s_cmp_ge_u32 s6, 8
s_cbranch_scc1 l1_kernel_bg
s_cmp_lt_u32 s6, 4
s_cbranch_scc1 l1_kernel_cmp
s_sub_u32 s75, s6, 4
s_setprio 1
v_lshrrev_b32 v32, 3, v1
s_lshl_b32 s20, s75, 5
v_add_u32 v32, s20, v32
v_mul_u32_u24 v32, 1280, v32
v_and_b32 v33, 7, v1
v_lshrrev_b32 v34, 4, v1
v_xor_b32 v35, v34, v33
v_lshl_add_u32 v2, v35, 4, v32
v_xor_b32 v35, 64, v2
v_add_u32 v3, 9216, v35
v_add_u32 v4, 18432, v2
v_add_u32 v5, 27648, v35
s_lshl_b32 s20, s75, 4
v_add_u32 v32, s20, v34
v_mul_u32_u24 v32, 3456, v32
v_and_b32 v33, 15, v1
v_lshlrev_b32 v35, 2, v34
v_xor_b32 v35, v35, v33
v_lshl_add_u32 v35, v35, 4, v32
v_mov_b32 v6, v35
v_add_u32 v7, 12800, v35
v_add_u32 v8, 25600, v35
v_add_u32 v9, 38400, v35
s_lshl_b32 s22, s75, 12
s_add_u32 s23, s22, 16384
s_waitcnt lgkmcnt(0)
s_mul_i32 s20, s4, 163840
s_add_u32 s8, s24, s20
s_addc_u32 s9, s25, 0
s_and_b32 s9, s9, 0xffff
s_mov_b32 s10, 0x28000
s_mov_b32 s11, 0x20000
s_lshl_b32 s20, s5, 8
s_sub_u32 s21, 2211840, s20
s_add_u32 s16, s28, s20
s_addc_u32 s17, s29, 0
s_and_b32 s17, s17, 0xffff
s_mov_b32 s18, s21
s_mov_b32 s19, 0x20000
s_mov_b32 s25, s30
s_lshl_b32 s20, s25, 7
s_mul_i32 s21, s25, 221184
s_add_u32 m0, s22, 0
s_nop 0
buffer_load_dwordx4 v2, s[8:11], s20 offen offset:0 lds
buffer_load_dwordx4 v3, s[8:11], s20 offen offset:1024 lds
buffer_load_dwordx4 v4, s[8:11], s20 offen offset:2048 lds
buffer_load_dwordx4 v5, s[8:11], s20 offen offset:3072 lds
s_add_u32 m0, s23, 0
s_nop 0
buffer_load_dwordx4 v6, s[16:19], s21 offen offset:0 lds
buffer_load_dwordx4 v7, s[16:19], s21 offen offset:1024 lds
buffer_load_dwordx4 v8, s[16:19], s21 offen offset:2048 lds
buffer_load_dwordx4 v9, s[16:19], s21 offen offset:3072 lds
s_add_u32 s25, s25, 1
s_cmp_eq_u32 s25, 10
s_cselect_b32 s25, 0, s25
s_lshl_b32 s20, s25, 7
s_mul_i32 s21, s25, 221184
s_barrier
s_add_u32 m0, s22, 32768
s_nop 0
buffer_load_dwordx4 v2, s[8:11], s20 offen offset:0 lds
buffer_load_dwordx4 v3, s[8:11], s20 offen offset:1024 lds
buffer_load_dwordx4 v4, s[8:11], s20 offen offset:2048 lds
buffer_load_dwordx4 v5, s[8:11], s20 offen offset:3072 lds
s_add_u32 m0, s23, 32768
s_nop 0
buffer_load_dwordx4 v6, s[16:19], s21 offen offset:0 lds
buffer_load_dwordx4 v7, s[16:19], s21 offen offset:1024 lds
buffer_load_dwordx4 v8, s[16:19], s21 offen offset:2048 lds
buffer_load_dwordx4 v9, s[16:19], s21 offen offset:3072 lds
s_add_u32 s25, s25, 1
s_cmp_eq_u32 s25, 10
s_cselect_b32 s25, 0, s25
s_lshl_b32 s20, s25, 7
s_mul_i32 s21, s25, 221184
s_mov_b32 s12, s26
s_and_b32 s13, s27, 0xffff
s_mov_b32 s14, 0x1090000
s_mov_b32 s15, 0x20000
v_and_b32 v32, 15, v1
v_lshrrev_b32 v33, 4, v1
v_lshrrev_b32 v34, 2, v32
v_lshl_add_u32 v35, v33, 3, v34
s_lshl_b32 s58, s75, 5
v_add_u32 v35, s58, v35
v_and_b32 v36, 3, v32
v_add_u32 v37, 0, v35
v_lshrrev_b32 v38, 1, v37
v_and_b32 v38, 7, v38
v_lshrrev_b32 v39, 1, v36
v_xor_b32 v38, v38, v39
v_lshlrev_b32 v38, 4, v38
v_lshl_add_u32 v38, v37, 7, v38
v_and_b32 v39, 1, v36
v_lshl_add_u32 v10, v39, 3, v38
v_add_u32 v37, 4, v35
v_lshrrev_b32 v38, 1, v37
v_and_b32 v38, 7, v38
v_lshrrev_b32 v39, 1, v36
v_xor_b32 v38, v38, v39
v_lshlrev_b32 v38, 4, v38
v_lshl_add_u32 v38, v37, 7, v38
v_and_b32 v39, 1, v36
v_lshl_add_u32 v11, v39, 3, v38
v_lshlrev_b32 v12, 12, v32
v_lshl_add_u32 v12, v33, 4, v12
s_lshl_b32 s58, s5, 18
s_add_u32 s58, s58, 65536
buffer_load_dword v63, v12, s[12:15], s58 offen
v_lshlrev_b32 v14, 2, v1
v_add_u32 v14, 149504, v14
v_mov_b32 v15, 0
v_cmp_gt_u32 vcc, 4, v1
s_nop 3
s_and_saveexec_b64 s[66:67], vcc
ds_write_b32 v14, v15
s_mov_b64 exec, s[66:67]
s_waitcnt lgkmcnt(0)
s_waitcnt vmcnt(9)
s_barrier
s_add_u32 m0, s22, 65536
s_nop 0
buffer_load_dwordx4 v2, s[8:11], s20 offen offset:0 lds
buffer_load_dwordx4 v3, s[8:11], s20 offen offset:1024 lds
buffer_load_dwordx4 v4, s[8:11], s20 offen offset:2048 lds
buffer_load_dwordx4 v5, s[8:11], s20 offen offset:3072 lds
s_add_u32 m0, s23, 65536
s_nop 0
buffer_load_dwordx4 v6, s[16:19], s21 offen offset:0 lds
buffer_load_dwordx4 v7, s[16:19], s21 offen offset:1024 lds
buffer_load_dwordx4 v8, s[16:19], s21 offen offset:2048 lds
buffer_load_dwordx4 v9, s[16:19], s21 offen offset:3072 lds
s_add_u32 s25, s25, 1
s_cmp_eq_u32 s25, 10
s_cselect_b32 s25, 0, s25
s_lshl_b32 s20, s25, 7
s_mul_i32 s21, s25, 221184
s_cmp_lg_u32 s74, 0
s_cbranch_scc1 l1_kernel_ld_xt_1
v_xor_b32 v13, 0, v10
v_add_u32 v13, 0, v13
ds_read_b64_tr_b16 v[16:17], v13
v_xor_b32 v13, 0, v11
v_add_u32 v13, 0, v13
ds_read_b64_tr_b16 v[18:19], v13
v_xor_b32 v13, 32, v10
v_add_u32 v13, 0, v13
ds_read_b64_tr_b16 v[20:21], v13
v_xor_b32 v13, 32, v11
v_add_u32 v13, 0, v13
ds_read_b64_tr_b16 v[22:23], v13
v_xor_b32 v13, 64, v10
v_add_u32 v13, 0, v13
ds_read_b64_tr_b16 v[24:25], v13
v_xor_b32 v13, 64, v11
v_add_u32 v13, 0, v13
ds_read_b64_tr_b16 v[26:27], v13
v_xor_b32 v13, 96, v10
v_add_u32 v13, 0, v13
ds_read_b64_tr_b16 v[28:29], v13
v_xor_b32 v13, 96, v11
v_add_u32 v13, 0, v13
ds_read_b64_tr_b16 v[30:31], v13
s_waitcnt lgkmcnt(0)
l1_kernel_ld_xt_1:
s_waitcnt vmcnt(9)
s_barrier
s_add_u32 m0, s22, 0
s_nop 0
buffer_load_dwordx4 v2, s[8:11], s20 offen offset:0 lds
buffer_load_dwordx4 v3, s[8:11], s20 offen offset:1024 lds
buffer_load_dwordx4 v4, s[8:11], s20 offen offset:2048 lds
buffer_load_dwordx4 v5, s[8:11], s20 offen offset:3072 lds
s_add_u32 m0, s23, 0
s_nop 0
buffer_load_dwordx4 v6, s[16:19], s21 offen offset:0 lds
buffer_load_dwordx4 v7, s[16:19], s21 offen offset:1024 lds
buffer_load_dwordx4 v8, s[16:19], s21 offen offset:2048 lds
buffer_load_dwordx4 v9, s[16:19], s21 offen offset:3072 lds
s_add_u32 s25, s25, 1
s_cmp_eq_u32 s25, 10
s_cselect_b32 s25, 0, s25
s_lshl_b32 s20, s25, 7
s_mul_i32 s21, s25, 221184
s_cmp_lg_u32 s74, 1
s_cbranch_scc1 l1_kernel_ld_xt_2
v_xor_b32 v13, 0, v10
v_add_u32 v13, 32768, v13
ds_read_b64_tr_b16 v[16:17], v13
v_xor_b32 v13, 0, v11
v_add_u32 v13, 32768, v13
ds_read_b64_tr_b16 v[18:19], v13
v_xor_b32 v13, 32, v10
v_add_u32 v13, 32768, v13
ds_read_b64_tr_b16 v[20:21], v13
v_xor_b32 v13, 32, v11
v_add_u32 v13, 32768, v13
ds_read_b64_tr_b16 v[22:23], v13
v_xor_b32 v13, 64, v10
v_add_u32 v13, 32768, v13
ds_read_b64_tr_b16 v[24:25], v13
v_xor_b32 v13, 64, v11
v_add_u32 v13, 32768, v13
ds_read_b64_tr_b16 v[26:27], v13
v_xor_b32 v13, 96, v10
v_add_u32 v13, 32768, v13
ds_read_b64_tr_b16 v[28:29], v13
v_xor_b32 v13, 96, v11
v_add_u32 v13, 32768, v13
ds_read_b64_tr_b16 v[30:31], v13
s_waitcnt lgkmcnt(0)
l1_kernel_ld_xt_2:
s_waitcnt vmcnt(8)
s_barrier
s_add_u32 m0, s22, 32768
s_nop 0
buffer_load_dwordx4 v2, s[8:11], s20 offen offset:0 lds
buffer_load_dwordx4 v3, s[8:11], s20 offen offset:1024 lds
buffer_load_dwordx4 v4, s[8:11], s20 offen offset:2048 lds
buffer_load_dwordx4 v5, s[8:11], s20 offen offset:3072 lds
s_add_u32 m0, s23, 32768
s_nop 0
buffer_load_dwordx4 v6, s[16:19], s21 offen offset:0 lds
buffer_load_dwordx4 v7, s[16:19], s21 offen offset:1024 lds
buffer_load_dwordx4 v8, s[16:19], s21 offen offset:2048 lds
buffer_load_dwordx4 v9, s[16:19], s21 offen offset:3072 lds
s_add_u32 s25, s25, 1
s_cmp_eq_u32 s25, 10
s_cselect_b32 s25, 0, s25
s_lshl_b32 s20, s25, 7
s_mul_i32 s21, s25, 221184
s_cmp_lg_u32 s74, 2
s_cbranch_scc1 l1_kernel_ld_xt_3
v_xor_b32 v13, 0, v10
v_add_u32 v13, 65536, v13
ds_read_b64_tr_b16 v[16:17], v13
v_xor_b32 v13, 0, v11
v_add_u32 v13, 65536, v13
ds_read_b64_tr_b16 v[18:19], v13
v_xor_b32 v13, 32, v10
v_add_u32 v13, 65536, v13
ds_read_b64_tr_b16 v[20:21], v13
v_xor_b32 v13, 32, v11
v_add_u32 v13, 65536, v13
ds_read_b64_tr_b16 v[22:23], v13
v_xor_b32 v13, 64, v10
v_add_u32 v13, 65536, v13
ds_read_b64_tr_b16 v[24:25], v13
v_xor_b32 v13, 64, v11
v_add_u32 v13, 65536, v13
ds_read_b64_tr_b16 v[26:27], v13
v_xor_b32 v13, 96, v10
v_add_u32 v13, 65536, v13
ds_read_b64_tr_b16 v[28:29], v13
v_xor_b32 v13, 96, v11
v_add_u32 v13, 65536, v13
ds_read_b64_tr_b16 v[30:31], v13
s_waitcnt lgkmcnt(0)
l1_kernel_ld_xt_3:
s_waitcnt vmcnt(8)
s_barrier
s_add_u32 m0, s22, 65536
s_nop 0
buffer_load_dwordx4 v2, s[8:11], s20 offen offset:0 lds
buffer_load_dwordx4 v3, s[8:11], s20 offen offset:1024 lds
buffer_load_dwordx4 v4, s[8:11], s20 offen offset:2048 lds
buffer_load_dwordx4 v5, s[8:11], s20 offen offset:3072 lds
s_add_u32 m0, s23, 65536
s_nop 0
buffer_load_dwordx4 v6, s[16:19], s21 offen offset:0 lds
buffer_load_dwordx4 v7, s[16:19], s21 offen offset:1024 lds
buffer_load_dwordx4 v8, s[16:19], s21 offen offset:2048 lds
buffer_load_dwordx4 v9, s[16:19], s21 offen offset:3072 lds
s_add_u32 s25, s25, 1
s_cmp_eq_u32 s25, 10
s_cselect_b32 s25, 0, s25
s_lshl_b32 s20, s25, 7
s_mul_i32 s21, s25, 221184
s_cmp_lg_u32 s74, 3
s_cbranch_scc1 l1_kernel_ld_xt_4
v_xor_b32 v13, 0, v10
v_add_u32 v13, 0, v13
ds_read_b64_tr_b16 v[16:17], v13
v_xor_b32 v13, 0, v11
v_add_u32 v13, 0, v13
ds_read_b64_tr_b16 v[18:19], v13
v_xor_b32 v13, 32, v10
v_add_u32 v13, 0, v13
ds_read_b64_tr_b16 v[20:21], v13
v_xor_b32 v13, 32, v11
v_add_u32 v13, 0, v13
ds_read_b64_tr_b16 v[22:23], v13
v_xor_b32 v13, 64, v10
v_add_u32 v13, 0, v13
ds_read_b64_tr_b16 v[24:25], v13
v_xor_b32 v13, 64, v11
v_add_u32 v13, 0, v13
ds_read_b64_tr_b16 v[26:27], v13
v_xor_b32 v13, 96, v10
v_add_u32 v13, 0, v13
ds_read_b64_tr_b16 v[28:29], v13
v_xor_b32 v13, 96, v11
v_add_u32 v13, 0, v13
ds_read_b64_tr_b16 v[30:31], v13
s_waitcnt lgkmcnt(0)
l1_kernel_ld_xt_4:
s_waitcnt vmcnt(8)
s_barrier
s_add_u32 m0, s22, 0
s_nop 0
buffer_load_dwordx4 v2, s[8:11], s20 offen offset:0 lds
buffer_load_dwordx4 v3, s[8:11], s20 offen offset:1024 lds
buffer_load_dwordx4 v4, s[8:11], s20 offen offset:2048 lds
buffer_load_dwordx4 v5, s[8:11], s20 offen offset:3072 lds
s_add_u32 m0, s23, 0
s_nop 0
buffer_load_dwordx4 v6, s[16:19], s21 offen offset:0 lds
buffer_load_dwordx4 v7, s[16:19], s21 offen offset:1024 lds
buffer_load_dwordx4 v8, s[16:19], s21 offen offset:2048 lds
buffer_load_dwordx4 v9, s[16:19], s21 offen offset:3072 lds
s_add_u32 s25, s25, 1
s_cmp_eq_u32 s25, 10
s_cselect_b32 s25, 0, s25
s_lshl_b32 s20, s25, 7
s_mul_i32 s21, s25, 221184
s_cmp_lg_u32 s74, 4
s_cbranch_scc1 l1_kernel_ld_xt_5
v_xor_b32 v13, 0, v10
v_add_u32 v13, 32768, v13
ds_read_b64_tr_b16 v[16:17], v13
v_xor_b32 v13, 0, v11
v_add_u32 v13, 32768, v13
ds_read_b64_tr_b16 v[18:19], v13
v_xor_b32 v13, 32, v10
v_add_u32 v13, 32768, v13
ds_read_b64_tr_b16 v[20:21], v13
v_xor_b32 v13, 32, v11
v_add_u32 v13, 32768, v13
ds_read_b64_tr_b16 v[22:23], v13
v_xor_b32 v13, 64, v10
v_add_u32 v13, 32768, v13
ds_read_b64_tr_b16 v[24:25], v13
v_xor_b32 v13, 64, v11
v_add_u32 v13, 32768, v13
ds_read_b64_tr_b16 v[26:27], v13
v_xor_b32 v13, 96, v10
v_add_u32 v13, 32768, v13
ds_read_b64_tr_b16 v[28:29], v13
v_xor_b32 v13, 96, v11
v_add_u32 v13, 32768, v13
ds_read_b64_tr_b16 v[30:31], v13
s_waitcnt lgkmcnt(0)
l1_kernel_ld_xt_5:
s_waitcnt vmcnt(8)
s_barrier
s_add_u32 m0, s22, 32768
s_nop 0
buffer_load_dwordx4 v2, s[8:11], s20 offen offset:0 lds
buffer_load_dwordx4 v3, s[8:11], s20 offen offset:1024 lds
buffer_load_dwordx4 v4, s[8:11], s20 offen offset:2048 lds
buffer_load_dwordx4 v5, s[8:11], s20 offen offset:3072 lds
s_add_u32 m0, s23, 32768
s_nop 0
buffer_load_dwordx4 v6, s[16:19], s21 offen offset:0 lds
buffer_load_dwordx4 v7, s[16:19], s21 offen offset:1024 lds
buffer_load_dwordx4 v8, s[16:19], s21 offen offset:2048 lds
buffer_load_dwordx4 v9, s[16:19], s21 offen offset:3072 lds
s_add_u32 s25, s25, 1
s_cmp_eq_u32 s25, 10
s_cselect_b32 s25, 0, s25
s_lshl_b32 s20, s25, 7
s_mul_i32 s21, s25, 221184
s_cmp_lg_u32 s74, 5
s_cbranch_scc1 l1_kernel_ld_xt_6
v_xor_b32 v13, 0, v10
v_add_u32 v13, 65536, v13
ds_read_b64_tr_b16 v[16:17], v13
v_xor_b32 v13, 0, v11
v_add_u32 v13, 65536, v13
ds_read_b64_tr_b16 v[18:19], v13
v_xor_b32 v13, 32, v10
v_add_u32 v13, 65536, v13
ds_read_b64_tr_b16 v[20:21], v13
v_xor_b32 v13, 32, v11
v_add_u32 v13, 65536, v13
ds_read_b64_tr_b16 v[22:23], v13
v_xor_b32 v13, 64, v10
v_add_u32 v13, 65536, v13
ds_read_b64_tr_b16 v[24:25], v13
v_xor_b32 v13, 64, v11
v_add_u32 v13, 65536, v13
ds_read_b64_tr_b16 v[26:27], v13
v_xor_b32 v13, 96, v10
v_add_u32 v13, 65536, v13
ds_read_b64_tr_b16 v[28:29], v13
v_xor_b32 v13, 96, v11
v_add_u32 v13, 65536, v13
ds_read_b64_tr_b16 v[30:31], v13
s_waitcnt lgkmcnt(0)
l1_kernel_ld_xt_6:
s_waitcnt vmcnt(8)
s_barrier
s_add_u32 m0, s22, 65536
s_nop 0
buffer_load_dwordx4 v2, s[8:11], s20 offen offset:0 lds
buffer_load_dwordx4 v3, s[8:11], s20 offen offset:1024 lds
buffer_load_dwordx4 v4, s[8:11], s20 offen offset:2048 lds
buffer_load_dwordx4 v5, s[8:11], s20 offen offset:3072 lds
s_add_u32 m0, s23, 65536
s_nop 0
buffer_load_dwordx4 v6, s[16:19], s21 offen offset:0 lds
buffer_load_dwordx4 v7, s[16:19], s21 offen offset:1024 lds
buffer_load_dwordx4 v8, s[16:19], s21 offen offset:2048 lds
buffer_load_dwordx4 v9, s[16:19], s21 offen offset:3072 lds
s_add_u32 s25, s25, 1
s_cmp_eq_u32 s25, 10
s_cselect_b32 s25, 0, s25
s_lshl_b32 s20, s25, 7
s_mul_i32 s21, s25, 221184
s_cmp_lg_u32 s74, 6
s_cbranch_scc1 l1_kernel_ld_xt_7
v_xor_b32 v13, 0, v10
v_add_u32 v13, 0, v13
ds_read_b64_tr_b16 v[16:17], v13
v_xor_b32 v13, 0, v11
v_add_u32 v13, 0, v13
ds_read_b64_tr_b16 v[18:19], v13
v_xor_b32 v13, 32, v10
v_add_u32 v13, 0, v13
ds_read_b64_tr_b16 v[20:21], v13
v_xor_b32 v13, 32, v11
v_add_u32 v13, 0, v13
ds_read_b64_tr_b16 v[22:23], v13
v_xor_b32 v13, 64, v10
v_add_u32 v13, 0, v13
ds_read_b64_tr_b16 v[24:25], v13
v_xor_b32 v13, 64, v11
v_add_u32 v13, 0, v13
ds_read_b64_tr_b16 v[26:27], v13
v_xor_b32 v13, 96, v10
v_add_u32 v13, 0, v13
ds_read_b64_tr_b16 v[28:29], v13
v_xor_b32 v13, 96, v11
v_add_u32 v13, 0, v13
ds_read_b64_tr_b16 v[30:31], v13
s_waitcnt lgkmcnt(0)
l1_kernel_ld_xt_7:
s_waitcnt vmcnt(8)
s_barrier
s_add_u32 m0, s22, 0
s_nop 0
buffer_load_dwordx4 v2, s[8:11], s20 offen offset:0 lds
buffer_load_dwordx4 v3, s[8:11], s20 offen offset:1024 lds
buffer_load_dwordx4 v4, s[8:11], s20 offen offset:2048 lds
buffer_load_dwordx4 v5, s[8:11], s20 offen offset:3072 lds
s_add_u32 m0, s23, 0
s_nop 0
buffer_load_dwordx4 v6, s[16:19], s21 offen offset:0 lds
buffer_load_dwordx4 v7, s[16:19], s21 offen offset:1024 lds
buffer_load_dwordx4 v8, s[16:19], s21 offen offset:2048 lds
buffer_load_dwordx4 v9, s[16:19], s21 offen offset:3072 lds
s_add_u32 s25, s25, 1
s_cmp_eq_u32 s25, 10
s_cselect_b32 s25, 0, s25
s_lshl_b32 s20, s25, 7
s_mul_i32 s21, s25, 221184
s_cmp_lg_u32 s74, 7
s_cbranch_scc1 l1_kernel_ld_xt_8
v_xor_b32 v13, 0, v10
v_add_u32 v13, 32768, v13
ds_read_b64_tr_b16 v[16:17], v13
v_xor_b32 v13, 0, v11
v_add_u32 v13, 32768, v13
ds_read_b64_tr_b16 v[18:19], v13
v_xor_b32 v13, 32, v10
v_add_u32 v13, 32768, v13
ds_read_b64_tr_b16 v[20:21], v13
v_xor_b32 v13, 32, v11
v_add_u32 v13, 32768, v13
ds_read_b64_tr_b16 v[22:23], v13
v_xor_b32 v13, 64, v10
v_add_u32 v13, 32768, v13
ds_read_b64_tr_b16 v[24:25], v13
v_xor_b32 v13, 64, v11
v_add_u32 v13, 32768, v13
ds_read_b64_tr_b16 v[26:27], v13
v_xor_b32 v13, 96, v10
v_add_u32 v13, 32768, v13
ds_read_b64_tr_b16 v[28:29], v13
v_xor_b32 v13, 96, v11
v_add_u32 v13, 32768, v13
ds_read_b64_tr_b16 v[30:31], v13
s_waitcnt lgkmcnt(0)
l1_kernel_ld_xt_8:
s_waitcnt vmcnt(8)
s_barrier
s_cmp_lg_u32 s74, 8
s_cbranch_scc1 l1_kernel_ld_xt_9
v_xor_b32 v13, 0, v10
v_add_u32 v13, 65536, v13
ds_read_b64_tr_b16 v[16:17], v13
v_xor_b32 v13, 0, v11
v_add_u32 v13, 65536, v13
ds_read_b64_tr_b16 v[18:19], v13
v_xor_b32 v13, 32, v10
v_add_u32 v13, 65536, v13
ds_read_b64_tr_b16 v[20:21], v13
v_xor_b32 v13, 32, v11
v_add_u32 v13, 65536, v13
ds_read_b64_tr_b16 v[22:23], v13
v_xor_b32 v13, 64, v10
v_add_u32 v13, 65536, v13
ds_read_b64_tr_b16 v[24:25], v13
v_xor_b32 v13, 64, v11
v_add_u32 v13, 65536, v13
ds_read_b64_tr_b16 v[26:27], v13
v_xor_b32 v13, 96, v10
v_add_u32 v13, 65536, v13
ds_read_b64_tr_b16 v[28:29], v13
v_xor_b32 v13, 96, v11
v_add_u32 v13, 65536, v13
ds_read_b64_tr_b16 v[30:31], v13
s_waitcnt lgkmcnt(0)
l1_kernel_ld_xt_9:
s_waitcnt vmcnt(0)
s_barrier
s_cmp_lg_u32 s74, 9
s_cbranch_scc1 l1_kernel_ld_xt_10
v_xor_b32 v13, 0, v10
v_add_u32 v13, 0, v13
ds_read_b64_tr_b16 v[16:17], v13
v_xor_b32 v13, 0, v11
v_add_u32 v13, 0, v13
ds_read_b64_tr_b16 v[18:19], v13
v_xor_b32 v13, 32, v10
v_add_u32 v13, 0, v13
ds_read_b64_tr_b16 v[20:21], v13
v_xor_b32 v13, 32, v11
v_add_u32 v13, 0, v13
ds_read_b64_tr_b16 v[22:23], v13
v_xor_b32 v13, 64, v10
v_add_u32 v13, 0, v13
ds_read_b64_tr_b16 v[24:25], v13
v_xor_b32 v13, 64, v11
v_add_u32 v13, 0, v13
ds_read_b64_tr_b16 v[26:27], v13
v_xor_b32 v13, 96, v10
v_add_u32 v13, 0, v13
ds_read_b64_tr_b16 v[28:29], v13
v_xor_b32 v13, 96, v11
v_add_u32 v13, 0, v13
ds_read_b64_tr_b16 v[30:31], v13
s_waitcnt lgkmcnt(0)
l1_kernel_ld_xt_10:
s_cmp_ge_u32 s5, 10
s_cbranch_scc1 l1_kernel_ld_noxt
s_lshl_b32 s58, s75, 2
s_add_u32 s58, s58, 149504
v_mov_b32 v14, s58
s_mov_b32 s59, 0
l1_kernel_ld_xw:
ds_read_b32 v15, v14
s_waitcnt lgkmcnt(0)
v_readfirstlane_b32 s58, v15
s_nop 3
s_cmp_eq_u32 s58, 1
s_cbranch_scc1 l1_kernel_ld_xw_ok
s_add_u32 s59, s59, 1
s_cmp_lt_u32 s59, 0x100000
s_cbranch_scc1 l1_kernel_ld_xw
l1_kernel_ld_xw_ok:
v_lshrrev_b32 v14, 4, v1
s_lshl_b32 s20, s75, 8
s_add_u32 s20, s20, 147456
v_lshlrev_b32 v14, 6, v14
v_add_u32 v14, s20, v14
ds_read_b128 v[32:35], v14 offset:0
ds_read_b128 v[36:39], v14 offset:16
ds_read_b128 v[40:43], v14 offset:32
ds_read_b128 v[44:47], v14 offset:48
s_lshl_b32 s20, s5, 18
s_lshl_b32 s21, s4, 8
s_add_u32 s20, s20, s21
s_lshl_b32 s21, s75, 6
s_add_u32 s20, s20, s21
s_add_u32 s20, s20, 65536
s_waitcnt lgkmcnt(0)
v_mul_f32 v32, -v32, v33
v_mul_f32 v34, -v34, v35
v_mul_f32 v36, -v36, v37
v_mul_f32 v38, -v38, v39
v_mul_f32 v40, -v40, v41
v_mul_f32 v42, -v42, v43
v_mul_f32 v44, -v44, v45
v_mul_f32 v46, -v46, v47
v_lshlrev_b32 v48, 16, v16
v_and_b32 v49, 0xffff0000, v16
v_lshlrev_b32 v50, 16, v17
v_and_b32 v51, 0xffff0000, v17
v_lshlrev_b32 v52, 16, v18
v_and_b32 v53, 0xffff0000, v18
v_lshlrev_b32 v54, 16, v19
v_and_b32 v55, 0xffff0000, v19
v_fma_f32 v48, v48, v33, v32
v_fma_f32 v49, v49, v35, v34
v_fma_f32 v50, v50, v37, v36
v_fma_f32 v51, v51, v39, v38
v_fma_f32 v52, v52, v41, v40
v_fma_f32 v53, v53, v43, v42
v_fma_f32 v54, v54, v45, v44
v_fma_f32 v55, v55, v47, v46
v_cvt_pk_bf16_f32 v56, v48, v49
v_cvt_pk_bf16_f32 v57, v50, v51
v_cvt_pk_bf16_f32 v58, v52, v53
v_cvt_pk_bf16_f32 v59, v54, v55
buffer_store_dwordx4 v[56:59], v12, s[12:15], s20 offen sc0 sc1
s_add_u32 s20, s20, 65536
v_lshlrev_b32 v48, 16, v20
v_and_b32 v49, 0xffff0000, v20
v_lshlrev_b32 v50, 16, v21
v_and_b32 v51, 0xffff0000, v21
v_lshlrev_b32 v52, 16, v22
v_and_b32 v53, 0xffff0000, v22
v_lshlrev_b32 v54, 16, v23
v_and_b32 v55, 0xffff0000, v23
v_fma_f32 v48, v48, v33, v32
v_fma_f32 v49, v49, v35, v34
v_fma_f32 v50, v50, v37, v36
v_fma_f32 v51, v51, v39, v38
v_fma_f32 v52, v52, v41, v40
v_fma_f32 v53, v53, v43, v42
v_fma_f32 v54, v54, v45, v44
v_fma_f32 v55, v55, v47, v46
v_cvt_pk_bf16_f32 v60, v48, v49
v_cvt_pk_bf16_f32 v61, v50, v51
v_cvt_pk_bf16_f32 v62, v52, v53
v_cvt_pk_bf16_f32 v63, v54, v55
buffer_store_dwordx4 v[60:63], v12, s[12:15], s20 offen sc0 sc1
s_add_u32 s20, s20, 65536
v_lshlrev_b32 v48, 16, v24
v_and_b32 v49, 0xffff0000, v24
v_lshlrev_b32 v50, 16, v25
v_and_b32 v51, 0xffff0000, v25
v_lshlrev_b32 v52, 16, v26
v_and_b32 v53, 0xffff0000, v26
v_lshlrev_b32 v54, 16, v27
v_and_b32 v55, 0xffff0000, v27
v_fma_f32 v48, v48, v33, v32
v_fma_f32 v49, v49, v35, v34
v_fma_f32 v50, v50, v37, v36
v_fma_f32 v51, v51, v39, v38
v_fma_f32 v52, v52, v41, v40
v_fma_f32 v53, v53, v43, v42
v_fma_f32 v54, v54, v45, v44
v_fma_f32 v55, v55, v47, v46
v_cvt_pk_bf16_f32 v56, v48, v49
v_cvt_pk_bf16_f32 v57, v50, v51
v_cvt_pk_bf16_f32 v58, v52, v53
v_cvt_pk_bf16_f32 v59, v54, v55
buffer_store_dwordx4 v[56:59], v12, s[12:15], s20 offen sc0 sc1
s_add_u32 s20, s20, 65536
v_lshlrev_b32 v48, 16, v28
v_and_b32 v49, 0xffff0000, v28
v_lshlrev_b32 v50, 16, v29
v_and_b32 v51, 0xffff0000, v29
v_lshlrev_b32 v52, 16, v30
v_and_b32 v53, 0xffff0000, v30
v_lshlrev_b32 v54, 16, v31
v_and_b32 v55, 0xffff0000, v31
v_fma_f32 v48, v48, v33, v32
v_fma_f32 v49, v49, v35, v34
v_fma_f32 v50, v50, v37, v36
v_fma_f32 v51, v51, v39, v38
v_fma_f32 v52, v52, v41, v40
v_fma_f32 v53, v53, v43, v42
v_fma_f32 v54, v54, v45, v44
v_fma_f32 v55, v55, v47, v46
v_cvt_pk_bf16_f32 v60, v48, v49
v_cvt_pk_bf16_f32 v61, v50, v51
v_cvt_pk_bf16_f32 v62, v52, v53
v_cvt_pk_bf16_f32 v63, v54, v55
buffer_store_dwordx4 v[60:63], v12, s[12:15], s20 offen sc0 sc1
l1_kernel_ld_noxt:
s_branch l1_kernel_fin
l1_kernel_cmp:
s_barrier
s_and_b32 s7, s6, 1
s_lshr_b32 s31, s6, 1
v_lshrrev_b32 v130, 4, v1
v_and_b32 v129, 15, v1
v_and_b32 v128, 1, v130
v_lshrrev_b32 v131, 1, v130
v_lshrrev_b32 v132, 2, v129
v_and_b32 v133, 3, v129
v_lshl_add_u32 v134, v131, 3, v132
v_lshlrev_b32 v134, 8, v134
v_and_b32 v135, 1, v133
v_lshl_add_u32 v134, v135, 3, v134
v_lshrrev_b32 v135, 1, v133
v_lshl_add_u32 v135, v128, 1, v135
s_lshl_b32 s20, s7, 3
v_add_u32 v135, s20, v135
v_lshlrev_b32 v132, 2, v132
s_xor_b32 s20, s31, 0
s_lshl_b32 s20, s20, 2
v_add_u32 v136, s20, v135
v_xor_b32 v136, v136, v132
v_lshl_add_u32 v10, v136, 4, v134
v_add_u32 v10, 16384, v10
v_add_u32 v12, 0x10000, v10
s_xor_b32 s20, s31, 1
s_lshl_b32 s20, s20, 2
v_add_u32 v136, s20, v135
v_xor_b32 v136, v136, v132
v_lshl_add_u32 v11, v136, 4, v134
v_add_u32 v11, 16384, v11
v_add_u32 v13, 0x10000, v11
v_and_b32 v128, 1, v130
v_cmp_eq_u32 vcc, v128, v129
v_mov_b32 v131, 0x3f803f80
s_nop 0
v_cndmask_b32 v52, 0, v131, vcc
v_cndmask_b32 v53, 0, v131, vcc
v_cndmask_b32 v54, 0, v131, vcc
v_cndmask_b32 v55, 0, v131, vcc
v_and_b32 v128, 31, v1
v_lshrrev_b32 v131, 5, v1
s_lshl_b32 s20, s31, 6
v_add_u32 v132, s20, v128
v_lshlrev_b32 v132, 7, v132
s_lshl_b32 s20, s7, 12
v_add_u32 v132, s20, v132
v_lshrrev_b32 v133, 1, v128
v_and_b32 v133, 7, v133
v_xor_b32 v133, v133, v131
v_xor_b32 v134, 0, v133
v_lshl_add_u32 v14, v134, 4, v132
v_add_u32 v18, 0x10000, v14
v_xor_b32 v2, 0x1000, v14
v_add_u32 v6, 0x10000, v2
v_xor_b32 v134, 2, v133
v_lshl_add_u32 v15, v134, 4, v132
v_add_u32 v19, 0x10000, v15
v_xor_b32 v3, 0x1000, v15
v_add_u32 v7, 0x10000, v3
v_xor_b32 v134, 4, v133
v_lshl_add_u32 v16, v134, 4, v132
v_add_u32 v20, 0x10000, v16
v_xor_b32 v4, 0x1000, v16
v_add_u32 v8, 0x10000, v4
v_xor_b32 v134, 6, v133
v_lshl_add_u32 v17, v134, 4, v132
v_add_u32 v21, 0x10000, v17
v_xor_b32 v5, 0x1000, v17
v_add_u32 v9, 0x10000, v5
s_waitcnt lgkmcnt(0)
s_mov_b32 s12, s26
s_and_b32 s13, s27, 0xffff
s_mov_b32 s14, 0x1090000
s_mov_b32 s15, 0x20000
s_barrier
ds_read_b64_tr_b16 v[128:129], v10 offset:0
ds_read_b64_tr_b16 v[130:131], v10 offset:1024
ds_read_b64_tr_b16 v[132:133], v11 offset:0
ds_read_b64_tr_b16 v[134:135], v11 offset:1024
ds_read_b128 v[136:139], v14 offset:0
ds_read_b128 v[140:143], v2 offset:0
v_and_b32 v26, 31, v1
v_lshrrev_b32 v27, 4, v26
v_and_b32 v26, 15, v26
v_lshlrev_b32 v26, 4, v26
v_lshl_add_u32 v26, v27, 10, v26
v_lshrrev_b32 v27, 5, v1
v_lshl_add_u32 v26, v27, 9, v26
s_lshl_b32 s40, s4, 1
s_add_u32 s40, s40, s31
s_mul_i32 s40, s40, 54
s_lshl_b32 s41, s5, 2
s_add_u32 s40, s40, s41
s_lshl_b32 s41, s7, 1
s_add_u32 s40, s40, s41
s_lshl_b32 s40, s40, 12
s_add_u32 s40, s40, 7667712
s_add_u32 s41, s40, 4096
s_cmp_eq_u32 s31, 1
s_cselect_b32 s44, s41, s40
s_cselect_b32 s41, s40, s41
s_mov_b32 s40, s44
s_lshl_b32 s44, s7, 11
s_xor_b32 s45, s44, 2048
s_add_u32 s42, s40, s45
s_add_u32 s43, s41, s45
s_add_u32 s40, s40, s44
s_add_u32 s41, s41, s44
s_mov_b32 s28, 0xbfb8aa3b
s_mov_b32 s29, 0xbfb8aa3b
s_xor_b32 s46, s6, 2
s_xor_b32 s47, s6, 1
s_lshl_b32 s44, s46, 2
s_add_u32 s44, s44, 149504
v_mov_b32 v60, s44
s_lshl_b32 s44, s47, 2
s_add_u32 s44, s44, 149504
v_mov_b32 v61, s44
s_lshl_b32 s44, s46, 7
s_add_u32 s44, s44, 148480
v_lshrrev_b32 v62, 5, v1
v_lshlrev_b32 v62, 4, v62
v_add_u32 v62, s44, v62
s_lshl_b32 s44, s47, 8
s_add_u32 s44, s44, 147456
v_and_b32 v63, 31, v1
v_lshlrev_b32 v63, 3, v63
v_add_u32 v63, s44, v63
buffer_load_dword v27, v26, s[12:15], s40 offen
s_waitcnt lgkmcnt(0)
v_mfma_f32_32x32x16_bf16 v[64:79], v[128:131], v[136:139], 0
ds_read_b64_tr_b16 v[144:145], v10 offset:4096
ds_read_b64_tr_b16 v[146:147], v10 offset:5120
v_mfma_f32_4x4x4bf16_1k v[28:31], v[136:137], v[136:137], 0
v_mfma_f32_32x32x16_bf16 v[80:95], v[128:131], v[140:143], 0
ds_read_b64_tr_b16 v[148:149], v11 offset:4096
ds_read_b64_tr_b16 v[150:151], v11 offset:5120
v_mfma_f32_16x16x32_bf16 v[44:47], v[128:131], v[52:55], 0
v_mfma_f32_32x32x16_bf16 v[96:111], v[132:135], v[136:139], 0
ds_read_b128 v[152:155], v15 offset:0
ds_read_b128 v[156:159], v3 offset:0
v_mfma_f32_4x4x4bf16_1k v[28:31], v[138:139], v[138:139], v[28:31]
v_mfma_f32_32x32x16_bf16 v[112:127], v[132:135], v[140:143], 0
v_mfma_f32_16x16x32_bf16 v[48:51], v[52:55], v[136:139], 0
s_waitcnt lgkmcnt(0)
v_mfma_f32_32x32x16_bf16 v[64:79], v[144:147], v[152:155], v[64:79]
ds_read_b64_tr_b16 v[128:129], v10 offset:8192
ds_read_b64_tr_b16 v[130:131], v10 offset:9216
v_mfma_f32_4x4x4bf16_1k v[28:31], v[152:153], v[152:153], v[28:31]
v_mfma_f32_32x32x16_bf16 v[80:95], v[144:147], v[156:159], v[80:95]
ds_read_b64_tr_b16 v[132:133], v11 offset:8192
ds_read_b64_tr_b16 v[134:135], v11 offset:9216
v_mfma_f32_16x16x32_bf16 v[44:47], v[144:147], v[52:55], v[44:47]
v_mfma_f32_32x32x16_bf16 v[96:111], v[148:151], v[152:155], v[96:111]
ds_read_b128 v[136:139], v16 offset:0
ds_read_b128 v[140:143], v4 offset:0
v_mfma_f32_4x4x4bf16_1k v[28:31], v[154:155], v[154:155], v[28:31]
v_mfma_f32_32x32x16_bf16 v[112:127], v[148:151], v[156:159], v[112:127]
v_mfma_f32_16x16x32_bf16 v[48:51], v[52:55], v[152:155], v[48:51]
s_waitcnt lgkmcnt(0)
v_mfma_f32_32x32x16_bf16 v[64:79], v[128:131], v[136:139], v[64:79]
ds_read_b64_tr_b16 v[144:145], v10 offset:12288
ds_read_b64_tr_b16 v[146:147], v10 offset:13312
v_mfma_f32_4x4x4bf16_1k v[28:31], v[136:137], v[136:137], v[28:31]
v_mfma_f32_32x32x16_bf16 v[80:95], v[128:131], v[140:143], v[80:95]
ds_read_b64_tr_b16 v[148:149], v11 offset:12288
ds_read_b64_tr_b16 v[150:151], v11 offset:13312
v_mfma_f32_16x16x32_bf16 v[44:47], v[128:131], v[52:55], v[44:47]
v_mfma_f32_32x32x16_bf16 v[96:111], v[132:135], v[136:139], v[96:111]
ds_read_b128 v[152:155], v17 offset:0
ds_read_b128 v[156:159], v5 offset:0
v_mfma_f32_4x4x4bf16_1k v[28:31], v[138:139], v[138:139], v[28:31]
v_mfma_f32_32x32x16_bf16 v[112:127], v[132:135], v[140:143], v[112:127]
v_mfma_f32_16x16x32_bf16 v[48:51], v[52:55], v[136:139], v[48:51]
s_waitcnt lgkmcnt(0)
v_mfma_f32_32x32x16_bf16 v[64:79], v[144:147], v[152:155], v[64:79]
v_mfma_f32_4x4x4bf16_1k v[28:31], v[152:153], v[152:153], v[28:31]
v_mfma_f32_32x32x16_bf16 v[80:95], v[144:147], v[156:159], v[80:95]
s_barrier
ds_read_b64_tr_b16 v[128:129], v10 offset:32768
ds_read_b64_tr_b16 v[130:131], v10 offset:33792
v_mfma_f32_16x16x32_bf16 v[44:47], v[144:147], v[52:55], v[44:47]
v_mfma_f32_32x32x16_bf16 v[96:111], v[148:151], v[152:155], v[96:111]
ds_read_b64_tr_b16 v[132:133], v11 offset:32768
ds_read_b64_tr_b16 v[134:135], v11 offset:33792
v_mfma_f32_4x4x4bf16_1k v[28:31], v[154:155], v[154:155], v[28:31]
ds_read_b128 v[136:139], v14 offset:32768
ds_read_b128 v[140:143], v2 offset:32768
v_mfma_f32_32x32x16_bf16 v[112:127], v[148:151], v[156:159], v[112:127]
v_mfma_f32_16x16x32_bf16 v[48:51], v[52:55], v[152:155], v[48:51]
s_waitcnt lgkmcnt(0)
v_mfma_f32_32x32x16_bf16 v[64:79], v[128:131], v[136:139], v[64:79]
ds_read_b64_tr_b16 v[144:145], v10 offset:36864
ds_read_b64_tr_b16 v[146:147], v10 offset:37888
v_mfma_f32_4x4x4bf16_1k v[28:31], v[136:137], v[136:137], v[28:31]
v_mfma_f32_32x32x16_bf16 v[80:95], v[128:131], v[140:143], v[80:95]
ds_read_b64_tr_b16 v[148:149], v11 offset:36864
ds_read_b64_tr_b16 v[150:151], v11 offset:37888
v_mfma_f32_16x16x32_bf16 v[44:47], v[128:131], v[52:55], v[44:47]
v_mfma_f32_32x32x16_bf16 v[96:111], v[132:135], v[136:139], v[96:111]
ds_read_b128 v[152:155], v15 offset:32768
ds_read_b128 v[156:159], v3 offset:32768
v_mfma_f32_4x4x4bf16_1k v[28:31], v[138:139], v[138:139], v[28:31]
v_mfma_f32_32x32x16_bf16 v[112:127], v[132:135], v[140:143], v[112:127]
v_mfma_f32_16x16x32_bf16 v[48:51], v[52:55], v[136:139], v[48:51]
s_waitcnt lgkmcnt(0)
v_mfma_f32_32x32x16_bf16 v[64:79], v[144:147], v[152:155], v[64:79]
ds_read_b64_tr_b16 v[128:129], v10 offset:40960
ds_read_b64_tr_b16 v[130:131], v10 offset:41984
v_mfma_f32_4x4x4bf16_1k v[28:31], v[152:153], v[152:153], v[28:31]
v_mfma_f32_32x32x16_bf16 v[80:95], v[144:147], v[156:159], v[80:95]
ds_read_b64_tr_b16 v[132:133], v11 offset:40960
ds_read_b64_tr_b16 v[134:135], v11 offset:41984
v_mfma_f32_16x16x32_bf16 v[44:47], v[144:147], v[52:55], v[44:47]
v_mfma_f32_32x32x16_bf16 v[96:111], v[148:151], v[152:155], v[96:111]
ds_read_b128 v[136:139], v16 offset:32768
ds_read_b128 v[140:143], v4 offset:32768
v_mfma_f32_4x4x4bf16_1k v[28:31], v[154:155], v[154:155], v[28:31]
v_mfma_f32_32x32x16_bf16 v[112:127], v[148:151], v[156:159], v[112:127]
v_mfma_f32_16x16x32_bf16 v[48:51], v[52:55], v[152:155], v[48:51]
s_waitcnt lgkmcnt(0)
v_mfma_f32_32x32x16_bf16 v[64:79], v[128:131], v[136:139], v[64:79]
ds_read_b64_tr_b16 v[144:145], v10 offset:45056
ds_read_b64_tr_b16 v[146:147], v10 offset:46080
v_mfma_f32_4x4x4bf16_1k v[28:31], v[136:137], v[136:137], v[28:31]
v_mfma_f32_32x32x16_bf16 v[80:95], v[128:131], v[140:143], v[80:95]
ds_read_b64_tr_b16 v[148:149], v11 offset:45056
ds_read_b64_tr_b16 v[150:151], v11 offset:46080
v_mfma_f32_16x16x32_bf16 v[44:47], v[128:131], v[52:55], v[44:47]
v_mfma_f32_32x32x16_bf16 v[96:111], v[132:135], v[136:139], v[96:111]
ds_read_b128 v[152:155], v17 offset:32768
ds_read_b128 v[156:159], v5 offset:32768
v_mfma_f32_4x4x4bf16_1k v[28:31], v[138:139], v[138:139], v[28:31]
v_mfma_f32_32x32x16_bf16 v[112:127], v[132:135], v[140:143], v[112:127]
v_mfma_f32_16x16x32_bf16 v[48:51], v[52:55], v[136:139], v[48:51]
s_waitcnt lgkmcnt(0)
v_mfma_f32_32x32x16_bf16 v[64:79], v[144:147], v[152:155], v[64:79]
v_mfma_f32_4x4x4bf16_1k v[28:31], v[152:153], v[152:153], v[28:31]
v_mfma_f32_32x32x16_bf16 v[80:95], v[144:147], v[156:159], v[80:95]
s_barrier
ds_read_b64_tr_b16 v[128:129], v12 offset:0
ds_read_b64_tr_b16 v[130:131], v12 offset:1024
v_mfma_f32_16x16x32_bf16 v[44:47], v[144:147], v[52:55], v[44:47]
v_mfma_f32_32x32x16_bf16 v[96:111], v[148:151], v[152:155], v[96:111]
ds_read_b64_tr_b16 v[132:133], v13 offset:0
ds_read_b64_tr_b16 v[134:135], v13 offset:1024
v_mfma_f32_4x4x4bf16_1k v[28:31], v[154:155], v[154:155], v[28:31]
ds_read_b128 v[136:139], v18 offset:0
ds_read_b128 v[140:143], v6 offset:0
v_mfma_f32_32x32x16_bf16 v[112:127], v[148:151], v[156:159], v[112:127]
v_mfma_f32_16x16x32_bf16 v[48:51], v[52:55], v[152:155], v[48:51]
s_waitcnt lgkmcnt(0)
v_mfma_f32_32x32x16_bf16 v[64:79], v[128:131], v[136:139], v[64:79]
ds_read_b64_tr_b16 v[144:145], v12 offset:4096
ds_read_b64_tr_b16 v[146:147], v12 offset:5120
v_mfma_f32_4x4x4bf16_1k v[28:31], v[136:137], v[136:137], v[28:31]
v_mfma_f32_32x32x16_bf16 v[80:95], v[128:131], v[140:143], v[80:95]
ds_read_b64_tr_b16 v[148:149], v13 offset:4096
ds_read_b64_tr_b16 v[150:151], v13 offset:5120
v_mfma_f32_16x16x32_bf16 v[44:47], v[128:131], v[52:55], v[44:47]
v_mfma_f32_32x32x16_bf16 v[96:111], v[132:135], v[136:139], v[96:111]
ds_read_b128 v[152:155], v19 offset:0
ds_read_b128 v[156:159], v7 offset:0
v_mfma_f32_4x4x4bf16_1k v[28:31], v[138:139], v[138:139], v[28:31]
v_mfma_f32_32x32x16_bf16 v[112:127], v[132:135], v[140:143], v[112:127]
v_mfma_f32_16x16x32_bf16 v[48:51], v[52:55], v[136:139], v[48:51]
s_waitcnt lgkmcnt(0)
v_mfma_f32_32x32x16_bf16 v[64:79], v[144:147], v[152:155], v[64:79]
ds_read_b64_tr_b16 v[128:129], v12 offset:8192
ds_read_b64_tr_b16 v[130:131], v12 offset:9216
v_mfma_f32_4x4x4bf16_1k v[28:31], v[152:153], v[152:153], v[28:31]
v_mfma_f32_32x32x16_bf16 v[80:95], v[144:147], v[156:159], v[80:95]
ds_read_b64_tr_b16 v[132:133], v13 offset:8192
ds_read_b64_tr_b16 v[134:135], v13 offset:9216
v_mfma_f32_16x16x32_bf16 v[44:47], v[144:147], v[52:55], v[44:47]
v_mfma_f32_32x32x16_bf16 v[96:111], v[148:151], v[152:155], v[96:111]
ds_read_b128 v[136:139], v20 offset:0
ds_read_b128 v[140:143], v8 offset:0
v_mfma_f32_4x4x4bf16_1k v[28:31], v[154:155], v[154:155], v[28:31]
v_mfma_f32_32x32x16_bf16 v[112:127], v[148:151], v[156:159], v[112:127]
v_mfma_f32_16x16x32_bf16 v[48:51], v[52:55], v[152:155], v[48:51]
s_waitcnt lgkmcnt(0)
v_mfma_f32_32x32x16_bf16 v[64:79], v[128:131], v[136:139], v[64:79]
ds_read_b64_tr_b16 v[144:145], v12 offset:12288
ds_read_b64_tr_b16 v[146:147], v12 offset:13312
v_mfma_f32_4x4x4bf16_1k v[28:31], v[136:137], v[136:137], v[28:31]
v_mfma_f32_32x32x16_bf16 v[80:95], v[128:131], v[140:143], v[80:95]
ds_read_b64_tr_b16 v[148:149], v13 offset:12288
ds_read_b64_tr_b16 v[150:151], v13 offset:13312
v_mfma_f32_16x16x32_bf16 v[44:47], v[128:131], v[52:55], v[44:47]
v_mfma_f32_32x32x16_bf16 v[96:111], v[132:135], v[136:139], v[96:111]
ds_read_b128 v[152:155], v21 offset:0
ds_read_b128 v[156:159], v9 offset:0
v_mfma_f32_4x4x4bf16_1k v[28:31], v[138:139], v[138:139], v[28:31]
v_mfma_f32_32x32x16_bf16 v[112:127], v[132:135], v[140:143], v[112:127]
v_mfma_f32_16x16x32_bf16 v[48:51], v[52:55], v[136:139], v[48:51]
s_waitcnt lgkmcnt(0)
v_mfma_f32_32x32x16_bf16 v[64:79], v[144:147], v[152:155], v[64:79]
v_mfma_f32_4x4x4bf16_1k v[28:31], v[152:153], v[152:153], v[28:31]
v_mfma_f32_32x32x16_bf16 v[80:95], v[144:147], v[156:159], v[80:95]
s_barrier
ds_read_b64_tr_b16 v[128:129], v10 offset:0
ds_read_b64_tr_b16 v[130:131], v10 offset:1024
v_mfma_f32_16x16x32_bf16 v[44:47], v[144:147], v[52:55], v[44:47]
v_mfma_f32_32x32x16_bf16 v[96:111], v[148:151], v[152:155], v[96:111]
ds_read_b64_tr_b16 v[132:133], v11 offset:0
ds_read_b64_tr_b16 v[134:135], v11 offset:1024
v_mfma_f32_4x4x4bf16_1k v[28:31], v[154:155], v[154:155], v[28:31]
ds_read_b128 v[136:139], v14 offset:0
ds_read_b128 v[140:143], v2 offset:0
v_mfma_f32_32x32x16_bf16 v[112:127], v[148:151], v[156:159], v[112:127]
v_mfma_f32_16x16x32_bf16 v[48:51], v[52:55], v[152:155], v[48:51]
s_waitcnt lgkmcnt(0)
v_mfma_f32_32x32x16_bf16 v[64:79], v[128:131], v[136:139], v[64:79]
ds_read_b64_tr_b16 v[144:145], v10 offset:4096
ds_read_b64_tr_b16 v[146:147], v10 offset:5120
v_mfma_f32_4x4x4bf16_1k v[28:31], v[136:137], v[136:137], v[28:31]
v_mfma_f32_32x32x16_bf16 v[80:95], v[128:131], v[140:143], v[80:95]
ds_read_b64_tr_b16 v[148:149], v11 offset:4096
ds_read_b64_tr_b16 v[150:151], v11 offset:5120
v_mfma_f32_16x16x32_bf16 v[44:47], v[128:131], v[52:55], v[44:47]
v_mfma_f32_32x32x16_bf16 v[96:111], v[132:135], v[136:139], v[96:111]
ds_read_b128 v[152:155], v15 offset:0
ds_read_b128 v[156:159], v3 offset:0
v_mfma_f32_4x4x4bf16_1k v[28:31], v[138:139], v[138:139], v[28:31]
v_mfma_f32_32x32x16_bf16 v[112:127], v[132:135], v[140:143], v[112:127]
v_mfma_f32_16x16x32_bf16 v[48:51], v[52:55], v[136:139], v[48:51]
s_waitcnt lgkmcnt(0)
v_mfma_f32_32x32x16_bf16 v[64:79], v[144:147], v[152:155], v[64:79]
ds_read_b64_tr_b16 v[128:129], v10 offset:8192
ds_read_b64_tr_b16 v[130:131], v10 offset:9216
v_mfma_f32_4x4x4bf16_1k v[28:31], v[152:153], v[152:153], v[28:31]
v_mfma_f32_32x32x16_bf16 v[80:95], v[144:147], v[156:159], v[80:95]
ds_read_b64_tr_b16 v[132:133], v11 offset:8192
ds_read_b64_tr_b16 v[134:135], v11 offset:9216
v_mfma_f32_16x16x32_bf16 v[44:47], v[144:147], v[52:55], v[44:47]
v_mfma_f32_32x32x16_bf16 v[96:111], v[148:151], v[152:155], v[96:111]
ds_read_b128 v[136:139], v16 offset:0
ds_read_b128 v[140:143], v4 offset:0
v_mfma_f32_4x4x4bf16_1k v[28:31], v[154:155], v[154:155], v[28:31]
v_mfma_f32_32x32x16_bf16 v[112:127], v[148:151], v[156:159], v[112:127]
v_mfma_f32_16x16x32_bf16 v[48:51], v[52:55], v[152:155], v[48:51]
s_waitcnt lgkmcnt(0)
v_mfma_f32_32x32x16_bf16 v[64:79], v[128:131], v[136:139], v[64:79]
ds_read_b64_tr_b16 v[144:145], v10 offset:12288
ds_read_b64_tr_b16 v[146:147], v10 offset:13312
v_mfma_f32_4x4x4bf16_1k v[28:31], v[136:137], v[136:137], v[28:31]
v_mfma_f32_32x32x16_bf16 v[80:95], v[128:131], v[140:143], v[80:95]
ds_read_b64_tr_b16 v[148:149], v11 offset:12288
ds_read_b64_tr_b16 v[150:151], v11 offset:13312
v_mfma_f32_16x16x32_bf16 v[44:47], v[128:131], v[52:55], v[44:47]
v_mfma_f32_32x32x16_bf16 v[96:111], v[132:135], v[136:139], v[96:111]
ds_read_b128 v[152:155], v17 offset:0
ds_read_b128 v[156:159], v5 offset:0
v_mfma_f32_4x4x4bf16_1k v[28:31], v[138:139], v[138:139], v[28:31]
v_mfma_f32_32x32x16_bf16 v[112:127], v[132:135], v[140:143], v[112:127]
v_mfma_f32_16x16x32_bf16 v[48:51], v[52:55], v[136:139], v[48:51]
s_waitcnt lgkmcnt(0)
v_mfma_f32_32x32x16_bf16 v[64:79], v[144:147], v[152:155], v[64:79]
v_mfma_f32_4x4x4bf16_1k v[28:31], v[152:153], v[152:153], v[28:31]
v_mfma_f32_32x32x16_bf16 v[80:95], v[144:147], v[156:159], v[80:95]
s_barrier
ds_read_b64_tr_b16 v[128:129], v10 offset:32768
ds_read_b64_tr_b16 v[130:131], v10 offset:33792
v_mfma_f32_16x16x32_bf16 v[44:47], v[144:147], v[52:55], v[44:47]
v_mfma_f32_32x32x16_bf16 v[96:111], v[148:151], v[152:155], v[96:111]
ds_read_b64_tr_b16 v[132:133], v11 offset:32768
ds_read_b64_tr_b16 v[134:135], v11 offset:33792
v_mfma_f32_4x4x4bf16_1k v[28:31], v[154:155], v[154:155], v[28:31]
ds_read_b128 v[136:139], v14 offset:32768
ds_read_b128 v[140:143], v2 offset:32768
v_mfma_f32_32x32x16_bf16 v[112:127], v[148:151], v[156:159], v[112:127]
v_mfma_f32_16x16x32_bf16 v[48:51], v[52:55], v[152:155], v[48:51]
s_waitcnt lgkmcnt(0)
v_mfma_f32_32x32x16_bf16 v[64:79], v[128:131], v[136:139], v[64:79]
ds_read_b64_tr_b16 v[144:145], v10 offset:36864
ds_read_b64_tr_b16 v[146:147], v10 offset:37888
v_mfma_f32_4x4x4bf16_1k v[28:31], v[136:137], v[136:137], v[28:31]
v_mfma_f32_32x32x16_bf16 v[80:95], v[128:131], v[140:143], v[80:95]
ds_read_b64_tr_b16 v[148:149], v11 offset:36864
ds_read_b64_tr_b16 v[150:151], v11 offset:37888
v_mfma_f32_16x16x32_bf16 v[44:47], v[128:131], v[52:55], v[44:47]
v_mfma_f32_32x32x16_bf16 v[96:111], v[132:135], v[136:139], v[96:111]
ds_read_b128 v[152:155], v15 offset:32768
ds_read_b128 v[156:159], v3 offset:32768
v_mfma_f32_4x4x4bf16_1k v[28:31], v[138:139], v[138:139], v[28:31]
v_mfma_f32_32x32x16_bf16 v[112:127], v[132:135], v[140:143], v[112:127]
v_mfma_f32_16x16x32_bf16 v[48:51], v[52:55], v[136:139], v[48:51]
s_waitcnt lgkmcnt(0)
v_mfma_f32_32x32x16_bf16 v[64:79], v[144:147], v[152:155], v[64:79]
ds_read_b64_tr_b16 v[128:129], v10 offset:40960
ds_read_b64_tr_b16 v[130:131], v10 offset:41984
v_mfma_f32_4x4x4bf16_1k v[28:31], v[152:153], v[152:153], v[28:31]
v_mfma_f32_32x32x16_bf16 v[80:95], v[144:147], v[156:159], v[80:95]
ds_read_b64_tr_b16 v[132:133], v11 offset:40960
ds_read_b64_tr_b16 v[134:135], v11 offset:41984
v_mfma_f32_16x16x32_bf16 v[44:47], v[144:147], v[52:55], v[44:47]
v_mfma_f32_32x32x16_bf16 v[96:111], v[148:151], v[152:155], v[96:111]
ds_read_b128 v[136:139], v16 offset:32768
ds_read_b128 v[140:143], v4 offset:32768
v_mfma_f32_4x4x4bf16_1k v[28:31], v[154:155], v[154:155], v[28:31]
v_mfma_f32_32x32x16_bf16 v[112:127], v[148:151], v[156:159], v[112:127]
v_mfma_f32_16x16x32_bf16 v[48:51], v[52:55], v[152:155], v[48:51]
s_waitcnt lgkmcnt(0)
v_mfma_f32_32x32x16_bf16 v[64:79], v[128:131], v[136:139], v[64:79]
ds_read_b64_tr_b16 v[144:145], v10 offset:45056
ds_read_b64_tr_b16 v[146:147], v10 offset:46080
v_mfma_f32_4x4x4bf16_1k v[28:31], v[136:137], v[136:137], v[28:31]
v_mfma_f32_32x32x16_bf16 v[80:95], v[128:131], v[140:143], v[80:95]
ds_read_b64_tr_b16 v[148:149], v11 offset:45056
ds_read_b64_tr_b16 v[150:151], v11 offset:46080
v_mfma_f32_16x16x32_bf16 v[44:47], v[128:131], v[52:55], v[44:47]
v_mfma_f32_32x32x16_bf16 v[96:111], v[132:135], v[136:139], v[96:111]
ds_read_b128 v[152:155], v17 offset:32768
ds_read_b128 v[156:159], v5 offset:32768
v_mfma_f32_4x4x4bf16_1k v[28:31], v[138:139], v[138:139], v[28:31]
v_mfma_f32_32x32x16_bf16 v[112:127], v[132:135], v[140:143], v[112:127]
v_mfma_f32_16x16x32_bf16 v[48:51], v[52:55], v[136:139], v[48:51]
s_waitcnt lgkmcnt(0)
v_mfma_f32_32x32x16_bf16 v[64:79], v[144:147], v[152:155], v[64:79]
v_mfma_f32_4x4x4bf16_1k v[28:31], v[152:153], v[152:153], v[28:31]
v_mfma_f32_32x32x16_bf16 v[80:95], v[144:147], v[156:159], v[80:95]
s_barrier
ds_read_b64_tr_b16 v[128:129], v12 offset:0
ds_read_b64_tr_b16 v[130:131], v12 offset:1024
v_mfma_f32_16x16x32_bf16 v[44:47], v[144:147], v[52:55], v[44:47]
v_mfma_f32_32x32x16_bf16 v[96:111], v[148:151], v[152:155], v[96:111]
ds_read_b64_tr_b16 v[132:133], v13 offset:0
ds_read_b64_tr_b16 v[134:135], v13 offset:1024
v_mfma_f32_4x4x4bf16_1k v[28:31], v[154:155], v[154:155], v[28:31]
ds_read_b128 v[136:139], v18 offset:0
ds_read_b128 v[140:143], v6 offset:0
v_mfma_f32_32x32x16_bf16 v[112:127], v[148:151], v[156:159], v[112:127]
v_mfma_f32_16x16x32_bf16 v[48:51], v[52:55], v[152:155], v[48:51]
s_waitcnt lgkmcnt(0)
v_mfma_f32_32x32x16_bf16 v[64:79], v[128:131], v[136:139], v[64:79]
ds_read_b64_tr_b16 v[144:145], v12 offset:4096
ds_read_b64_tr_b16 v[146:147], v12 offset:5120
v_mfma_f32_4x4x4bf16_1k v[28:31], v[136:137], v[136:137], v[28:31]
v_mfma_f32_32x32x16_bf16 v[80:95], v[128:131], v[140:143], v[80:95]
ds_read_b64_tr_b16 v[148:149], v13 offset:4096
ds_read_b64_tr_b16 v[150:151], v13 offset:5120
v_mfma_f32_16x16x32_bf16 v[44:47], v[128:131], v[52:55], v[44:47]
v_mfma_f32_32x32x16_bf16 v[96:111], v[132:135], v[136:139], v[96:111]
ds_read_b128 v[152:155], v19 offset:0
ds_read_b128 v[156:159], v7 offset:0
v_mfma_f32_4x4x4bf16_1k v[28:31], v[138:139], v[138:139], v[28:31]
v_mfma_f32_32x32x16_bf16 v[112:127], v[132:135], v[140:143], v[112:127]
v_mfma_f32_16x16x32_bf16 v[48:51], v[52:55], v[136:139], v[48:51]
s_waitcnt lgkmcnt(0)
v_mfma_f32_32x32x16_bf16 v[64:79], v[144:147], v[152:155], v[64:79]
ds_read_b64_tr_b16 v[128:129], v12 offset:8192
ds_read_b64_tr_b16 v[130:131], v12 offset:9216
v_mfma_f32_4x4x4bf16_1k v[28:31], v[152:153], v[152:153], v[28:31]
v_mfma_f32_32x32x16_bf16 v[80:95], v[144:147], v[156:159], v[80:95]
ds_read_b64_tr_b16 v[132:133], v13 offset:8192
ds_read_b64_tr_b16 v[134:135], v13 offset:9216
v_mfma_f32_16x16x32_bf16 v[44:47], v[144:147], v[52:55], v[44:47]
v_mfma_f32_32x32x16_bf16 v[96:111], v[148:151], v[152:155], v[96:111]
ds_read_b128 v[136:139], v20 offset:0
ds_read_b128 v[140:143], v8 offset:0
v_mfma_f32_4x4x4bf16_1k v[28:31], v[154:155], v[154:155], v[28:31]
v_mfma_f32_32x32x16_bf16 v[112:127], v[148:151], v[156:159], v[112:127]
v_mfma_f32_16x16x32_bf16 v[48:51], v[52:55], v[152:155], v[48:51]
s_waitcnt lgkmcnt(0)
v_mfma_f32_32x32x16_bf16 v[64:79], v[128:131], v[136:139], v[64:79]
ds_read_b64_tr_b16 v[144:145], v12 offset:12288
ds_read_b64_tr_b16 v[146:147], v12 offset:13312
v_mfma_f32_4x4x4bf16_1k v[28:31], v[136:137], v[136:137], v[28:31]
v_mfma_f32_32x32x16_bf16 v[80:95], v[128:131], v[140:143], v[80:95]
ds_read_b64_tr_b16 v[148:149], v13 offset:12288
ds_read_b64_tr_b16 v[150:151], v13 offset:13312
v_mfma_f32_16x16x32_bf16 v[44:47], v[128:131], v[52:55], v[44:47]
v_mfma_f32_32x32x16_bf16 v[96:111], v[132:135], v[136:139], v[96:111]
ds_read_b128 v[152:155], v21 offset:0
ds_read_b128 v[156:159], v9 offset:0
v_mfma_f32_4x4x4bf16_1k v[28:31], v[138:139], v[138:139], v[28:31]
v_mfma_f32_32x32x16_bf16 v[112:127], v[132:135], v[140:143], v[112:127]
v_mfma_f32_16x16x32_bf16 v[48:51], v[52:55], v[136:139], v[48:51]
s_waitcnt lgkmcnt(0)
v_mfma_f32_32x32x16_bf16 v[64:79], v[144:147], v[152:155], v[64:79]
v_mfma_f32_4x4x4bf16_1k v[28:31], v[152:153], v[152:153], v[28:31]
v_mfma_f32_32x32x16_bf16 v[80:95], v[144:147], v[156:159], v[80:95]
s_barrier
ds_read_b64_tr_b16 v[128:129], v10 offset:0
ds_read_b64_tr_b16 v[130:131], v10 offset:1024
v_mfma_f32_16x16x32_bf16 v[44:47], v[144:147], v[52:55], v[44:47]
v_mfma_f32_32x32x16_bf16 v[96:111], v[148:151], v[152:155], v[96:111]
ds_read_b64_tr_b16 v[132:133], v11 offset:0
ds_read_b64_tr_b16 v[134:135], v11 offset:1024
v_mfma_f32_4x4x4bf16_1k v[28:31], v[154:155], v[154:155], v[28:31]
ds_read_b128 v[136:139], v14 offset:0
ds_read_b128 v[140:143], v2 offset:0
v_mfma_f32_32x32x16_bf16 v[112:127], v[148:151], v[156:159], v[112:127]
v_mfma_f32_16x16x32_bf16 v[48:51], v[52:55], v[152:155], v[48:51]
s_waitcnt lgkmcnt(0)
v_mfma_f32_32x32x16_bf16 v[64:79], v[128:131], v[136:139], v[64:79]
ds_read_b64_tr_b16 v[144:145], v10 offset:4096
ds_read_b64_tr_b16 v[146:147], v10 offset:5120
v_mfma_f32_4x4x4bf16_1k v[28:31], v[136:137], v[136:137], v[28:31]
v_mfma_f32_32x32x16_bf16 v[80:95], v[128:131], v[140:143], v[80:95]
ds_read_b64_tr_b16 v[148:149], v11 offset:4096
ds_read_b64_tr_b16 v[150:151], v11 offset:5120
v_mfma_f32_16x16x32_bf16 v[44:47], v[128:131], v[52:55], v[44:47]
v_mfma_f32_32x32x16_bf16 v[96:111], v[132:135], v[136:139], v[96:111]
ds_read_b128 v[152:155], v15 offset:0
ds_read_b128 v[156:159], v3 offset:0
v_mfma_f32_4x4x4bf16_1k v[28:31], v[138:139], v[138:139], v[28:31]
v_mfma_f32_32x32x16_bf16 v[112:127], v[132:135], v[140:143], v[112:127]
v_mfma_f32_16x16x32_bf16 v[48:51], v[52:55], v[136:139], v[48:51]
s_waitcnt lgkmcnt(0)
v_mfma_f32_32x32x16_bf16 v[64:79], v[144:147], v[152:155], v[64:79]
ds_read_b64_tr_b16 v[128:129], v10 offset:8192
ds_read_b64_tr_b16 v[130:131], v10 offset:9216
v_mfma_f32_4x4x4bf16_1k v[28:31], v[152:153], v[152:153], v[28:31]
v_mfma_f32_32x32x16_bf16 v[80:95], v[144:147], v[156:159], v[80:95]
ds_read_b64_tr_b16 v[132:133], v11 offset:8192
ds_read_b64_tr_b16 v[134:135], v11 offset:9216
v_mfma_f32_16x16x32_bf16 v[44:47], v[144:147], v[52:55], v[44:47]
v_mfma_f32_32x32x16_bf16 v[96:111], v[148:151], v[152:155], v[96:111]
ds_read_b128 v[136:139], v16 offset:0
ds_read_b128 v[140:143], v4 offset:0
v_mfma_f32_4x4x4bf16_1k v[28:31], v[154:155], v[154:155], v[28:31]
v_mfma_f32_32x32x16_bf16 v[112:127], v[148:151], v[156:159], v[112:127]
v_mfma_f32_16x16x32_bf16 v[48:51], v[52:55], v[152:155], v[48:51]
s_waitcnt lgkmcnt(0)
v_mfma_f32_32x32x16_bf16 v[64:79], v[128:131], v[136:139], v[64:79]
ds_read_b64_tr_b16 v[144:145], v10 offset:12288
ds_read_b64_tr_b16 v[146:147], v10 offset:13312
v_mfma_f32_4x4x4bf16_1k v[28:31], v[136:137], v[136:137], v[28:31]
v_mfma_f32_32x32x16_bf16 v[80:95], v[128:131], v[140:143], v[80:95]
ds_read_b64_tr_b16 v[148:149], v11 offset:12288
ds_read_b64_tr_b16 v[150:151], v11 offset:13312
v_mfma_f32_16x16x32_bf16 v[44:47], v[128:131], v[52:55], v[44:47]
v_mfma_f32_32x32x16_bf16 v[96:111], v[132:135], v[136:139], v[96:111]
ds_read_b128 v[152:155], v17 offset:0
ds_read_b128 v[156:159], v5 offset:0
v_mfma_f32_4x4x4bf16_1k v[28:31], v[138:139], v[138:139], v[28:31]
v_mfma_f32_32x32x16_bf16 v[112:127], v[132:135], v[140:143], v[112:127]
v_mfma_f32_16x16x32_bf16 v[48:51], v[52:55], v[136:139], v[48:51]
s_waitcnt lgkmcnt(0)
v_mfma_f32_32x32x16_bf16 v[64:79], v[144:147], v[152:155], v[64:79]
v_mfma_f32_4x4x4bf16_1k v[28:31], v[152:153], v[152:153], v[28:31]
v_mfma_f32_32x32x16_bf16 v[80:95], v[144:147], v[156:159], v[80:95]
s_barrier
ds_read_b64_tr_b16 v[128:129], v10 offset:32768
ds_read_b64_tr_b16 v[130:131], v10 offset:33792
v_mfma_f32_16x16x32_bf16 v[44:47], v[144:147], v[52:55], v[44:47]
v_mfma_f32_32x32x16_bf16 v[96:111], v[148:151], v[152:155], v[96:111]
ds_read_b64_tr_b16 v[132:133], v11 offset:32768
ds_read_b64_tr_b16 v[134:135], v11 offset:33792
v_mfma_f32_4x4x4bf16_1k v[28:31], v[154:155], v[154:155], v[28:31]
ds_read_b128 v[136:139], v14 offset:32768
ds_read_b128 v[140:143], v2 offset:32768
v_mfma_f32_32x32x16_bf16 v[112:127], v[148:151], v[156:159], v[112:127]
v_mfma_f32_16x16x32_bf16 v[48:51], v[52:55], v[152:155], v[48:51]
s_waitcnt lgkmcnt(0)
v_mfma_f32_32x32x16_bf16 v[64:79], v[128:131], v[136:139], v[64:79]
ds_read_b64_tr_b16 v[144:145], v10 offset:36864
ds_read_b64_tr_b16 v[146:147], v10 offset:37888
v_mfma_f32_4x4x4bf16_1k v[28:31], v[136:137], v[136:137], v[28:31]
v_mfma_f32_32x32x16_bf16 v[80:95], v[128:131], v[140:143], v[80:95]
ds_read_b64_tr_b16 v[148:149], v11 offset:36864
ds_read_b64_tr_b16 v[150:151], v11 offset:37888
v_mfma_f32_16x16x32_bf16 v[44:47], v[128:131], v[52:55], v[44:47]
v_mfma_f32_32x32x16_bf16 v[96:111], v[132:135], v[136:139], v[96:111]
ds_read_b128 v[152:155], v15 offset:32768
ds_read_b128 v[156:159], v3 offset:32768
v_mfma_f32_4x4x4bf16_1k v[28:31], v[138:139], v[138:139], v[28:31]
v_mfma_f32_32x32x16_bf16 v[112:127], v[132:135], v[140:143], v[112:127]
v_mfma_f32_16x16x32_bf16 v[48:51], v[52:55], v[136:139], v[48:51]
s_waitcnt lgkmcnt(0)
v_mfma_f32_32x32x16_bf16 v[64:79], v[144:147], v[152:155], v[64:79]
ds_read_b64_tr_b16 v[128:129], v10 offset:40960
ds_read_b64_tr_b16 v[130:131], v10 offset:41984
v_mfma_f32_4x4x4bf16_1k v[28:31], v[152:153], v[152:153], v[28:31]
v_mfma_f32_32x32x16_bf16 v[80:95], v[144:147], v[156:159], v[80:95]
ds_read_b64_tr_b16 v[132:133], v11 offset:40960
ds_read_b64_tr_b16 v[134:135], v11 offset:41984
v_mfma_f32_16x16x32_bf16 v[44:47], v[144:147], v[52:55], v[44:47]
v_mfma_f32_32x32x16_bf16 v[96:111], v[148:151], v[152:155], v[96:111]
ds_read_b128 v[136:139], v16 offset:32768
ds_read_b128 v[140:143], v4 offset:32768
v_mfma_f32_4x4x4bf16_1k v[28:31], v[154:155], v[154:155], v[28:31]
v_mfma_f32_32x32x16_bf16 v[112:127], v[148:151], v[156:159], v[112:127]
v_mfma_f32_16x16x32_bf16 v[48:51], v[52:55], v[152:155], v[48:51]
s_waitcnt lgkmcnt(0)
v_mfma_f32_32x32x16_bf16 v[64:79], v[128:131], v[136:139], v[64:79]
ds_read_b64_tr_b16 v[144:145], v10 offset:45056
ds_read_b64_tr_b16 v[146:147], v10 offset:46080
v_mfma_f32_4x4x4bf16_1k v[28:31], v[136:137], v[136:137], v[28:31]
v_mfma_f32_32x32x16_bf16 v[80:95], v[128:131], v[140:143], v[80:95]
ds_read_b64_tr_b16 v[148:149], v11 offset:45056
ds_read_b64_tr_b16 v[150:151], v11 offset:46080
v_mfma_f32_16x16x32_bf16 v[44:47], v[128:131], v[52:55], v[44:47]
v_mfma_f32_32x32x16_bf16 v[96:111], v[132:135], v[136:139], v[96:111]
ds_read_b128 v[152:155], v17 offset:32768
ds_read_b128 v[156:159], v5 offset:32768
v_mfma_f32_4x4x4bf16_1k v[28:31], v[138:139], v[138:139], v[28:31]
v_mfma_f32_32x32x16_bf16 v[112:127], v[132:135], v[140:143], v[112:127]
v_mfma_f32_16x16x32_bf16 v[48:51], v[52:55], v[136:139], v[48:51]
s_waitcnt lgkmcnt(0)
v_mfma_f32_32x32x16_bf16 v[64:79], v[144:147], v[152:155], v[64:79]
v_mfma_f32_4x4x4bf16_1k v[28:31], v[152:153], v[152:153], v[28:31]
v_mfma_f32_32x32x16_bf16 v[80:95], v[144:147], v[156:159], v[80:95]
s_barrier
ds_read_b64_tr_b16 v[128:129], v12 offset:0
ds_read_b64_tr_b16 v[130:131], v12 offset:1024
v_mfma_f32_16x16x32_bf16 v[44:47], v[144:147], v[52:55], v[44:47]
v_mfma_f32_32x32x16_bf16 v[96:111], v[148:151], v[152:155], v[96:111]
ds_read_b64_tr_b16 v[132:133], v13 offset:0
ds_read_b64_tr_b16 v[134:135], v13 offset:1024
v_mfma_f32_4x4x4bf16_1k v[28:31], v[154:155], v[154:155], v[28:31]
ds_read_b128 v[136:139], v18 offset:0
ds_read_b128 v[140:143], v6 offset:0
v_mfma_f32_32x32x16_bf16 v[112:127], v[148:151], v[156:159], v[112:127]
v_mfma_f32_16x16x32_bf16 v[48:51], v[52:55], v[152:155], v[48:51]
s_waitcnt lgkmcnt(0)
v_mfma_f32_32x32x16_bf16 v[64:79], v[128:131], v[136:139], v[64:79]
ds_read_b64_tr_b16 v[144:145], v12 offset:4096
ds_read_b64_tr_b16 v[146:147], v12 offset:5120
v_mfma_f32_4x4x4bf16_1k v[28:31], v[136:137], v[136:137], v[28:31]
v_mfma_f32_32x32x16_bf16 v[80:95], v[128:131], v[140:143], v[80:95]
ds_read_b64_tr_b16 v[148:149], v13 offset:4096
ds_read_b64_tr_b16 v[150:151], v13 offset:5120
v_mfma_f32_16x16x32_bf16 v[44:47], v[128:131], v[52:55], v[44:47]
v_mfma_f32_32x32x16_bf16 v[96:111], v[132:135], v[136:139], v[96:111]
ds_read_b128 v[152:155], v19 offset:0
ds_read_b128 v[156:159], v7 offset:0
v_mfma_f32_4x4x4bf16_1k v[28:31], v[138:139], v[138:139], v[28:31]
v_mfma_f32_32x32x16_bf16 v[112:127], v[132:135], v[140:143], v[112:127]
v_mfma_f32_16x16x32_bf16 v[48:51], v[52:55], v[136:139], v[48:51]
s_waitcnt lgkmcnt(0)
v_mfma_f32_32x32x16_bf16 v[64:79], v[144:147], v[152:155], v[64:79]
ds_read_b64_tr_b16 v[128:129], v12 offset:8192
ds_read_b64_tr_b16 v[130:131], v12 offset:9216
v_mfma_f32_4x4x4bf16_1k v[28:31], v[152:153], v[152:153], v[28:31]
v_mfma_f32_32x32x16_bf16 v[80:95], v[144:147], v[156:159], v[80:95]
ds_read_b64_tr_b16 v[132:133], v13 offset:8192
ds_read_b64_tr_b16 v[134:135], v13 offset:9216
v_mfma_f32_16x16x32_bf16 v[44:47], v[144:147], v[52:55], v[44:47]
v_mfma_f32_32x32x16_bf16 v[96:111], v[148:151], v[152:155], v[96:111]
ds_read_b128 v[136:139], v20 offset:0
ds_read_b128 v[140:143], v8 offset:0
v_mfma_f32_4x4x4bf16_1k v[28:31], v[154:155], v[154:155], v[28:31]
v_mfma_f32_32x32x16_bf16 v[112:127], v[148:151], v[156:159], v[112:127]
v_mfma_f32_16x16x32_bf16 v[48:51], v[52:55], v[152:155], v[48:51]
s_waitcnt lgkmcnt(0)
v_mfma_f32_32x32x16_bf16 v[64:79], v[128:131], v[136:139], v[64:79]
ds_read_b64_tr_b16 v[144:145], v12 offset:12288
ds_read_b64_tr_b16 v[146:147], v12 offset:13312
v_mfma_f32_4x4x4bf16_1k v[28:31], v[136:137], v[136:137], v[28:31]
v_mfma_f32_32x32x16_bf16 v[80:95], v[128:131], v[140:143], v[80:95]
ds_read_b64_tr_b16 v[148:149], v13 offset:12288
ds_read_b64_tr_b16 v[150:151], v13 offset:13312
v_mfma_f32_16x16x32_bf16 v[44:47], v[128:131], v[52:55], v[44:47]
v_mfma_f32_32x32x16_bf16 v[96:111], v[132:135], v[136:139], v[96:111]
ds_read_b128 v[152:155], v21 offset:0
ds_read_b128 v[156:159], v9 offset:0
v_mfma_f32_4x4x4bf16_1k v[28:31], v[138:139], v[138:139], v[28:31]
v_mfma_f32_32x32x16_bf16 v[112:127], v[132:135], v[140:143], v[112:127]
v_mfma_f32_16x16x32_bf16 v[48:51], v[52:55], v[136:139], v[48:51]
s_waitcnt lgkmcnt(0)
v_mfma_f32_32x32x16_bf16 v[64:79], v[144:147], v[152:155], v[64:79]
v_mfma_f32_4x4x4bf16_1k v[28:31], v[152:153], v[152:153], v[28:31]
v_mfma_f32_32x32x16_bf16 v[80:95], v[144:147], v[156:159], v[80:95]
s_barrier
ds_read_b64_tr_b16 v[128:129], v10 offset:0
ds_read_b64_tr_b16 v[130:131], v10 offset:1024
v_mfma_f32_16x16x32_bf16 v[44:47], v[144:147], v[52:55], v[44:47]
v_mfma_f32_32x32x16_bf16 v[96:111], v[148:151], v[152:155], v[96:111]
ds_read_b64_tr_b16 v[132:133], v11 offset:0
ds_read_b64_tr_b16 v[134:135], v11 offset:1024
v_mfma_f32_4x4x4bf16_1k v[28:31], v[154:155], v[154:155], v[28:31]
ds_read_b128 v[136:139], v14 offset:0
ds_read_b128 v[140:143], v2 offset:0
v_mfma_f32_32x32x16_bf16 v[112:127], v[148:151], v[156:159], v[112:127]
v_mfma_f32_16x16x32_bf16 v[48:51], v[52:55], v[152:155], v[48:51]
s_waitcnt lgkmcnt(0)
v_mfma_f32_32x32x16_bf16 v[64:79], v[128:131], v[136:139], v[64:79]
ds_read_b64_tr_b16 v[144:145], v10 offset:4096
ds_read_b64_tr_b16 v[146:147], v10 offset:5120
v_mfma_f32_4x4x4bf16_1k v[28:31], v[136:137], v[136:137], v[28:31]
v_mfma_f32_32x32x16_bf16 v[80:95], v[128:131], v[140:143], v[80:95]
ds_read_b64_tr_b16 v[148:149], v11 offset:4096
ds_read_b64_tr_b16 v[150:151], v11 offset:5120
v_mfma_f32_16x16x32_bf16 v[44:47], v[128:131], v[52:55], v[44:47]
v_mfma_f32_32x32x16_bf16 v[96:111], v[132:135], v[136:139], v[96:111]
ds_read_b128 v[152:155], v15 offset:0
ds_read_b128 v[156:159], v3 offset:0
v_mfma_f32_4x4x4bf16_1k v[28:31], v[138:139], v[138:139], v[28:31]
v_mfma_f32_32x32x16_bf16 v[112:127], v[132:135], v[140:143], v[112:127]
v_mfma_f32_16x16x32_bf16 v[48:51], v[52:55], v[136:139], v[48:51]
s_waitcnt lgkmcnt(0)
v_mfma_f32_32x32x16_bf16 v[64:79], v[144:147], v[152:155], v[64:79]
ds_read_b64_tr_b16 v[128:129], v10 offset:8192
ds_read_b64_tr_b16 v[130:131], v10 offset:9216
v_mfma_f32_4x4x4bf16_1k v[28:31], v[152:153], v[152:153], v[28:31]
v_mfma_f32_32x32x16_bf16 v[80:95], v[144:147], v[156:159], v[80:95]
ds_read_b64_tr_b16 v[132:133], v11 offset:8192
ds_read_b64_tr_b16 v[134:135], v11 offset:9216
v_mfma_f32_16x16x32_bf16 v[44:47], v[144:147], v[52:55], v[44:47]
v_mfma_f32_32x32x16_bf16 v[96:111], v[148:151], v[152:155], v[96:111]
ds_read_b128 v[136:139], v16 offset:0
ds_read_b128 v[140:143], v4 offset:0
v_mfma_f32_4x4x4bf16_1k v[28:31], v[154:155], v[154:155], v[28:31]
v_mfma_f32_32x32x16_bf16 v[112:127], v[148:151], v[156:159], v[112:127]
v_mfma_f32_16x16x32_bf16 v[48:51], v[52:55], v[152:155], v[48:51]
s_waitcnt lgkmcnt(0)
v_mfma_f32_32x32x16_bf16 v[64:79], v[128:131], v[136:139], v[64:79]
ds_read_b64_tr_b16 v[144:145], v10 offset:12288
ds_read_b64_tr_b16 v[146:147], v10 offset:13312
v_mfma_f32_4x4x4bf16_1k v[28:31], v[136:137], v[136:137], v[28:31]
v_mfma_f32_32x32x16_bf16 v[80:95], v[128:131], v[140:143], v[80:95]
ds_read_b64_tr_b16 v[148:149], v11 offset:12288
ds_read_b64_tr_b16 v[150:151], v11 offset:13312
v_mfma_f32_16x16x32_bf16 v[44:47], v[128:131], v[52:55], v[44:47]
v_mfma_f32_32x32x16_bf16 v[96:111], v[132:135], v[136:139], v[96:111]
ds_read_b128 v[152:155], v17 offset:0
ds_read_b128 v[156:159], v5 offset:0
v_mfma_f32_4x4x4bf16_1k v[28:31], v[138:139], v[138:139], v[28:31]
v_mfma_f32_32x32x16_bf16 v[112:127], v[132:135], v[140:143], v[112:127]
v_mfma_f32_16x16x32_bf16 v[48:51], v[52:55], v[136:139], v[48:51]
s_waitcnt lgkmcnt(0)
v_mfma_f32_4x4x4bf16_1k v[28:31], v[152:153], v[152:153], v[28:31]
v_mfma_f32_16x16x32_bf16 v[44:47], v[144:147], v[52:55], v[44:47]
v_mfma_f32_16x16x32_bf16 v[48:51], v[52:55], v[152:155], v[48:51]
v_mfma_f32_4x4x4bf16_1k v[28:31], v[154:155], v[154:155], v[28:31]
v_mfma_f32_32x32x16_bf16 v[64:79], v[144:147], v[152:155], v[64:79]
v_mfma_f32_32x32x16_bf16 v[80:95], v[144:147], v[156:159], v[80:95]
v_mfma_f32_32x32x16_bf16 v[96:111], v[148:151], v[152:155], v[96:111]
v_mfma_f32_32x32x16_bf16 v[112:127], v[148:151], v[156:159], v[112:127]
v_and_b32 v129, 15, v1
v_lshrrev_b32 v130, 4, v1
s_lshl_b32 s21, s6, 7
s_add_u32 s22, s21, 148480
v_lshlrev_b32 v131, 6, v129
v_lshl_add_u32 v131, v130, 4, v131
v_add_u32 v131, s22, v131
v_cmp_gt_u32 vcc, 2, v129
s_nop 3
s_and_saveexec_b64 s[26:27], vcc
ds_write_b128 v131, v[44:47]
s_mov_b64 exec, s[26:27]
v_and_b32 v132, 3, v1
v_cmp_eq_u32 vcc, 1, v132
s_nop 1
v_cndmask_b32 v138, v28, v29, vcc
v_cmp_eq_u32 vcc, 2, v132
s_nop 1
v_cndmask_b32 v138, v138, v30, vcc
v_cmp_eq_u32 vcc, 3, v132
s_nop 1
v_cndmask_b32 v138, v138, v31, vcc
v_mov_b32 v140, v138
s_nop 1
v_permlane32_swap_b32 v138, v140
v_add_f32 v138, v138, v140
v_permlane16_swap_b32 v48, v49
v_mov_b32 v139, v48
v_mov_b32 v140, v48
s_nop 1
v_permlane32_swap_b32 v139, v140
v_lshrrev_b32 v130, 5, v1
v_lshlrev_b32 v130, 4, v130
v_add_u32 v131, s22, v130
s_waitcnt lgkmcnt(0)
ds_read_b128 v[28:31], v131 offset:0
ds_read_b128 v[32:35], v131 offset:32
ds_read_b128 v[36:39], v131 offset:64
ds_read_b128 v[40:43], v131 offset:96
v_mul_f32 v139, 0x3acccccd, v139
v_mul_f32 v138, 0x3acccccd, v138
v_fma_f32 v138, -v139, v139, v138
v_max_f32 v138, 0, v138
v_cvt_pk_bf16_f32 v138, v138, v138
v_and_b32 v138, 0xffff0000, v138
v_add_f32 v138, 0x3727c5ac, v138
v_cvt_pk_bf16_f32 v138, v138, v138
v_and_b32 v138, 0xffff0000, v138
v_sqrt_f32 v138, v138
s_nop 0
v_cvt_pk_bf16_f32 v138, v138, v138
v_and_b32 v138, 0xffff0000, v138
v_rcp_f32 v23, v138
v_cvt_pk_bf16_f32 v22, v139, v139
v_and_b32 v22, 0xffff0000, v22
v_and_b32 v133, 31, v1
v_lshlrev_b32 v133, 3, v133
s_lshl_b32 s20, s6, 8
s_add_u32 s20, s20, 147456
v_add_u32 v137, s20, v133
v_cmp_gt_u32 vcc, 32, v1
s_nop 3
s_and_saveexec_b64 s[26:27], vcc
ds_write_b64 v137, v[22:23]
s_mov_b64 exec, s[26:27]
s_waitcnt lgkmcnt(0)
s_lshl_b32 s20, s6, 2
s_add_u32 s20, s20, 149504
v_mov_b32 v128, s20
v_mov_b32 v129, 1
ds_write_b32 v128, v129
s_cmp_eq_u32 s5, 13
s_cselect_b32 s20, s7, 0
s_cmp_lg_u32 s20, 0
s_cbranch_scc1 l1_kernel_g1done
v_mul_f32 v23, s28, v23
s_waitcnt lgkmcnt(0)
ds_read_b32 v20, v60
ds_read_b32 v21, v61
ds_read_b128 v[44:47], v62 offset:0
ds_read_b128 v[48:51], v62 offset:32
ds_read_b128 v[52:55], v62 offset:64
ds_read_b128 v[56:59], v62 offset:96
ds_read_b64 v[24:25], v63
v_pk_fma_f32 v[128:129], v[28:29], v[22:23], v[64:65] op_sel_hi:[1,0,1] neg_lo:[0,1,0] neg_hi:[0,1,0]
v_pk_fma_f32 v[130:131], v[30:31], v[22:23], v[66:67] op_sel_hi:[1,0,1] neg_lo:[0,1,0] neg_hi:[0,1,0]
v_pk_fma_f32 v[132:133], v[32:33], v[22:23], v[68:69] op_sel_hi:[1,0,1] neg_lo:[0,1,0] neg_hi:[0,1,0]
v_pk_fma_f32 v[134:135], v[34:35], v[22:23], v[70:71] op_sel_hi:[1,0,1] neg_lo:[0,1,0] neg_hi:[0,1,0]
v_pk_fma_f32 v[136:137], v[36:37], v[22:23], v[72:73] op_sel_hi:[1,0,1] neg_lo:[0,1,0] neg_hi:[0,1,0]
v_pk_fma_f32 v[138:139], v[38:39], v[22:23], v[74:75] op_sel_hi:[1,0,1] neg_lo:[0,1,0] neg_hi:[0,1,0]
v_pk_fma_f32 v[140:141], v[40:41], v[22:23], v[76:77] op_sel_hi:[1,0,1] neg_lo:[0,1,0] neg_hi:[0,1,0]
v_pk_fma_f32 v[142:143], v[42:43], v[22:23], v[78:79] op_sel_hi:[1,0,1] neg_lo:[0,1,0] neg_hi:[0,1,0]
v_pk_mul_f32 v[128:129], v[128:129], v[22:23] op_sel:[0,1] op_sel_hi:[1,1]
v_pk_mul_f32 v[130:131], v[130:131], v[22:23] op_sel:[0,1] op_sel_hi:[1,1]
v_pk_mul_f32 v[132:133], v[132:133], v[22:23] op_sel:[0,1] op_sel_hi:[1,1]
v_pk_mul_f32 v[134:135], v[134:135], v[22:23] op_sel:[0,1] op_sel_hi:[1,1]
v_pk_mul_f32 v[136:137], v[136:137], v[22:23] op_sel:[0,1] op_sel_hi:[1,1]
v_pk_mul_f32 v[138:139], v[138:139], v[22:23] op_sel:[0,1] op_sel_hi:[1,1]
v_pk_mul_f32 v[140:141], v[140:141], v[22:23] op_sel:[0,1] op_sel_hi:[1,1]
v_pk_mul_f32 v[142:143], v[142:143], v[22:23] op_sel:[0,1] op_sel_hi:[1,1]
v_exp_f32 v144, v128
v_exp_f32 v145, v129
v_exp_f32 v146, v130
v_exp_f32 v147, v131
v_exp_f32 v148, v132
v_exp_f32 v149, v133
v_exp_f32 v150, v134
v_exp_f32 v151, v135
v_exp_f32 v152, v136
v_exp_f32 v153, v137
v_exp_f32 v154, v138
v_exp_f32 v155, v139
v_exp_f32 v156, v140
v_exp_f32 v157, v141
v_exp_f32 v158, v142
v_exp_f32 v159, v143
v_pk_fma_f32 v[144:145], v[144:145], s[28:29], s[28:29]
v_pk_fma_f32 v[146:147], v[146:147], s[28:29], s[28:29]
v_pk_fma_f32 v[148:149], v[148:149], s[28:29], s[28:29]
v_pk_fma_f32 v[150:151], v[150:151], s[28:29], s[28:29]
v_pk_fma_f32 v[152:153], v[152:153], s[28:29], s[28:29]
v_pk_fma_f32 v[154:155], v[154:155], s[28:29], s[28:29]
v_pk_fma_f32 v[156:157], v[156:157], s[28:29], s[28:29]
v_pk_fma_f32 v[158:159], v[158:159], s[28:29], s[28:29]
v_rcp_f32 v144, v144
v_rcp_f32 v145, v145
v_rcp_f32 v146, v146
v_rcp_f32 v147, v147
v_rcp_f32 v148, v148
v_rcp_f32 v149, v149
v_rcp_f32 v150, v150
v_rcp_f32 v151, v151
v_rcp_f32 v152, v152
v_rcp_f32 v153, v153
v_rcp_f32 v154, v154
v_rcp_f32 v155, v155
v_rcp_f32 v156, v156
v_rcp_f32 v157, v157
v_rcp_f32 v158, v158
v_rcp_f32 v159, v159
v_pk_mul_f32 v[128:129], v[128:129], v[144:145]
v_pk_mul_f32 v[130:131], v[130:131], v[146:147]
v_pk_mul_f32 v[132:133], v[132:133], v[148:149]
v_pk_mul_f32 v[134:135], v[134:135], v[150:151]
v_pk_mul_f32 v[136:137], v[136:137], v[152:153]
v_pk_mul_f32 v[138:139], v[138:139], v[154:155]
v_pk_mul_f32 v[140:141], v[140:141], v[156:157]
v_pk_mul_f32 v[142:143], v[142:143], v[158:159]
v_cvt_pk_bf16_f32 v2, v128, v129
v_cvt_pk_bf16_f32 v3, v130, v131
v_cvt_pk_bf16_f32 v4, v132, v133
v_cvt_pk_bf16_f32 v5, v134, v135
v_cvt_pk_bf16_f32 v6, v136, v137
v_cvt_pk_bf16_f32 v7, v138, v139
v_cvt_pk_bf16_f32 v8, v140, v141
v_cvt_pk_bf16_f32 v9, v142, v143
buffer_store_dwordx4 v[2:5], v26, s[12:15], s40 offen offset:0 sc0 sc1
buffer_store_dwordx4 v[6:9], v26, s[12:15], s40 offen offset:256 sc0 sc1
s_mov_b32 s59, 0
l1_kernel_pagain:
s_waitcnt lgkmcnt(0)
v_and_b32 v20, v20, v21
s_nop 0
v_readfirstlane_b32 s58, v20
s_nop 3
s_cmp_eq_u32 s58, 1
s_cbranch_scc1 l1_kernel_pok
s_add_u32 s59, s59, 1
s_cmp_ge_u32 s59, 0x40000
s_cbranch_scc1 l1_kernel_pok
ds_read_b32 v20, v60
ds_read_b32 v21, v61
ds_read_b128 v[44:47], v62 offset:0
ds_read_b128 v[48:51], v62 offset:32
ds_read_b128 v[52:55], v62 offset:64
ds_read_b128 v[56:59], v62 offset:96
ds_read_b64 v[24:25], v63
s_branch l1_kernel_pagain
l1_kernel_pok:
v_mul_f32 v25, s28, v25
v_pk_fma_f32 v[128:129], v[44:45], v[22:23], v[96:97] op_sel_hi:[1,0,1] neg_lo:[0,1,0] neg_hi:[0,1,0]
v_pk_fma_f32 v[130:131], v[46:47], v[22:23], v[98:99] op_sel_hi:[1,0,1] neg_lo:[0,1,0] neg_hi:[0,1,0]
v_pk_fma_f32 v[132:133], v[48:49], v[22:23], v[100:101] op_sel_hi:[1,0,1] neg_lo:[0,1,0] neg_hi:[0,1,0]
v_pk_fma_f32 v[134:135], v[50:51], v[22:23], v[102:103] op_sel_hi:[1,0,1] neg_lo:[0,1,0] neg_hi:[0,1,0]
v_pk_fma_f32 v[136:137], v[52:53], v[22:23], v[104:105] op_sel_hi:[1,0,1] neg_lo:[0,1,0] neg_hi:[0,1,0]
v_pk_fma_f32 v[138:139], v[54:55], v[22:23], v[106:107] op_sel_hi:[1,0,1] neg_lo:[0,1,0] neg_hi:[0,1,0]
v_pk_fma_f32 v[140:141], v[56:57], v[22:23], v[108:109] op_sel_hi:[1,0,1] neg_lo:[0,1,0] neg_hi:[0,1,0]
v_pk_fma_f32 v[142:143], v[58:59], v[22:23], v[110:111] op_sel_hi:[1,0,1] neg_lo:[0,1,0] neg_hi:[0,1,0]
v_pk_mul_f32 v[128:129], v[128:129], v[22:23] op_sel:[0,1] op_sel_hi:[1,1]
v_pk_mul_f32 v[130:131], v[130:131], v[22:23] op_sel:[0,1] op_sel_hi:[1,1]
v_pk_mul_f32 v[132:133], v[132:133], v[22:23] op_sel:[0,1] op_sel_hi:[1,1]
v_pk_mul_f32 v[134:135], v[134:135], v[22:23] op_sel:[0,1] op_sel_hi:[1,1]
v_pk_mul_f32 v[136:137], v[136:137], v[22:23] op_sel:[0,1] op_sel_hi:[1,1]
v_pk_mul_f32 v[138:139], v[138:139], v[22:23] op_sel:[0,1] op_sel_hi:[1,1]
v_pk_mul_f32 v[140:141], v[140:141], v[22:23] op_sel:[0,1] op_sel_hi:[1,1]
v_pk_mul_f32 v[142:143], v[142:143], v[22:23] op_sel:[0,1] op_sel_hi:[1,1]
v_exp_f32 v144, v128
v_exp_f32 v145, v129
v_exp_f32 v146, v130
v_exp_f32 v147, v131
v_exp_f32 v148, v132
v_exp_f32 v149, v133
v_exp_f32 v150, v134
v_exp_f32 v151, v135
v_exp_f32 v152, v136
v_exp_f32 v153, v137
v_exp_f32 v154, v138
v_exp_f32 v155, v139
v_exp_f32 v156, v140
v_exp_f32 v157, v141
v_exp_f32 v158, v142
v_exp_f32 v159, v143
v_pk_fma_f32 v[144:145], v[144:145], s[28:29], s[28:29]
v_pk_fma_f32 v[146:147], v[146:147], s[28:29], s[28:29]
v_pk_fma_f32 v[148:149], v[148:149], s[28:29], s[28:29]
v_pk_fma_f32 v[150:151], v[150:151], s[28:29], s[28:29]
v_pk_fma_f32 v[152:153], v[152:153], s[28:29], s[28:29]
v_pk_fma_f32 v[154:155], v[154:155], s[28:29], s[28:29]
v_pk_fma_f32 v[156:157], v[156:157], s[28:29], s[28:29]
v_pk_fma_f32 v[158:159], v[158:159], s[28:29], s[28:29]
v_rcp_f32 v144, v144
v_rcp_f32 v145, v145
v_rcp_f32 v146, v146
v_rcp_f32 v147, v147
v_rcp_f32 v148, v148
v_rcp_f32 v149, v149
v_rcp_f32 v150, v150
v_rcp_f32 v151, v151
v_rcp_f32 v152, v152
v_rcp_f32 v153, v153
v_rcp_f32 v154, v154
v_rcp_f32 v155, v155
v_rcp_f32 v156, v156
v_rcp_f32 v157, v157
v_rcp_f32 v158, v158
v_rcp_f32 v159, v159
v_pk_mul_f32 v[128:129], v[128:129], v[144:145]
v_pk_mul_f32 v[130:131], v[130:131], v[146:147]
v_pk_mul_f32 v[132:133], v[132:133], v[148:149]
v_pk_mul_f32 v[134:135], v[134:135], v[150:151]
v_pk_mul_f32 v[136:137], v[136:137], v[152:153]
v_pk_mul_f32 v[138:139], v[138:139], v[154:155]
v_pk_mul_f32 v[140:141], v[140:141], v[156:157]
v_pk_mul_f32 v[142:143], v[142:143], v[158:159]
v_cvt_pk_bf16_f32 v10, v128, v129
v_cvt_pk_bf16_f32 v11, v130, v131
v_cvt_pk_bf16_f32 v12, v132, v133
v_cvt_pk_bf16_f32 v13, v134, v135
v_cvt_pk_bf16_f32 v14, v136, v137
v_cvt_pk_bf16_f32 v15, v138, v139
v_cvt_pk_bf16_f32 v16, v140, v141
v_cvt_pk_bf16_f32 v17, v142, v143
buffer_store_dwordx4 v[10:13], v26, s[12:15], s41 offen offset:0 sc0 sc1
buffer_store_dwordx4 v[14:17], v26, s[12:15], s41 offen offset:256 sc0 sc1
v_pk_fma_f32 v[128:129], v[28:29], v[24:25], v[80:81] op_sel_hi:[1,0,1] neg_lo:[0,1,0] neg_hi:[0,1,0]
v_pk_fma_f32 v[130:131], v[30:31], v[24:25], v[82:83] op_sel_hi:[1,0,1] neg_lo:[0,1,0] neg_hi:[0,1,0]
v_pk_fma_f32 v[132:133], v[32:33], v[24:25], v[84:85] op_sel_hi:[1,0,1] neg_lo:[0,1,0] neg_hi:[0,1,0]
v_pk_fma_f32 v[134:135], v[34:35], v[24:25], v[86:87] op_sel_hi:[1,0,1] neg_lo:[0,1,0] neg_hi:[0,1,0]
v_pk_fma_f32 v[136:137], v[36:37], v[24:25], v[88:89] op_sel_hi:[1,0,1] neg_lo:[0,1,0] neg_hi:[0,1,0]
v_pk_fma_f32 v[138:139], v[38:39], v[24:25], v[90:91] op_sel_hi:[1,0,1] neg_lo:[0,1,0] neg_hi:[0,1,0]
v_pk_fma_f32 v[140:141], v[40:41], v[24:25], v[92:93] op_sel_hi:[1,0,1] neg_lo:[0,1,0] neg_hi:[0,1,0]
v_pk_fma_f32 v[142:143], v[42:43], v[24:25], v[94:95] op_sel_hi:[1,0,1] neg_lo:[0,1,0] neg_hi:[0,1,0]
v_pk_mul_f32 v[128:129], v[128:129], v[24:25] op_sel:[0,1] op_sel_hi:[1,1]
v_pk_mul_f32 v[130:131], v[130:131], v[24:25] op_sel:[0,1] op_sel_hi:[1,1]
v_pk_mul_f32 v[132:133], v[132:133], v[24:25] op_sel:[0,1] op_sel_hi:[1,1]
v_pk_mul_f32 v[134:135], v[134:135], v[24:25] op_sel:[0,1] op_sel_hi:[1,1]
v_pk_mul_f32 v[136:137], v[136:137], v[24:25] op_sel:[0,1] op_sel_hi:[1,1]
v_pk_mul_f32 v[138:139], v[138:139], v[24:25] op_sel:[0,1] op_sel_hi:[1,1]
v_pk_mul_f32 v[140:141], v[140:141], v[24:25] op_sel:[0,1] op_sel_hi:[1,1]
v_pk_mul_f32 v[142:143], v[142:143], v[24:25] op_sel:[0,1] op_sel_hi:[1,1]
v_exp_f32 v144, v128
v_exp_f32 v145, v129
v_exp_f32 v146, v130
v_exp_f32 v147, v131
v_exp_f32 v148, v132
v_exp_f32 v149, v133
v_exp_f32 v150, v134
v_exp_f32 v151, v135
v_exp_f32 v152, v136
v_exp_f32 v153, v137
v_exp_f32 v154, v138
v_exp_f32 v155, v139
v_exp_f32 v156, v140
v_exp_f32 v157, v141
v_exp_f32 v158, v142
v_exp_f32 v159, v143
v_pk_fma_f32 v[144:145], v[144:145], s[28:29], s[28:29]
v_pk_fma_f32 v[146:147], v[146:147], s[28:29], s[28:29]
v_pk_fma_f32 v[148:149], v[148:149], s[28:29], s[28:29]
v_pk_fma_f32 v[150:151], v[150:151], s[28:29], s[28:29]
v_pk_fma_f32 v[152:153], v[152:153], s[28:29], s[28:29]
v_pk_fma_f32 v[154:155], v[154:155], s[28:29], s[28:29]
v_pk_fma_f32 v[156:157], v[156:157], s[28:29], s[28:29]
v_pk_fma_f32 v[158:159], v[158:159], s[28:29], s[28:29]
v_rcp_f32 v144, v144
v_rcp_f32 v145, v145
v_rcp_f32 v146, v146
v_rcp_f32 v147, v147
v_rcp_f32 v148, v148
v_rcp_f32 v149, v149
v_rcp_f32 v150, v150
v_rcp_f32 v151, v151
v_rcp_f32 v152, v152
v_rcp_f32 v153, v153
v_rcp_f32 v154, v154
v_rcp_f32 v155, v155
v_rcp_f32 v156, v156
v_rcp_f32 v157, v157
v_rcp_f32 v158, v158
v_rcp_f32 v159, v159
v_pk_mul_f32 v[128:129], v[128:129], v[144:145]
v_pk_mul_f32 v[130:131], v[130:131], v[146:147]
v_pk_mul_f32 v[132:133], v[132:133], v[148:149]
v_pk_mul_f32 v[134:135], v[134:135], v[150:151]
v_pk_mul_f32 v[136:137], v[136:137], v[152:153]
v_pk_mul_f32 v[138:139], v[138:139], v[154:155]
v_pk_mul_f32 v[140:141], v[140:141], v[156:157]
v_pk_mul_f32 v[142:143], v[142:143], v[158:159]
v_cvt_pk_bf16_f32 v2, v128, v129
v_cvt_pk_bf16_f32 v3, v130, v131
v_cvt_pk_bf16_f32 v4, v132, v133
v_cvt_pk_bf16_f32 v5, v134, v135
v_cvt_pk_bf16_f32 v6, v136, v137
v_cvt_pk_bf16_f32 v7, v138, v139
v_cvt_pk_bf16_f32 v8, v140, v141
v_cvt_pk_bf16_f32 v9, v142, v143
buffer_store_dwordx4 v[2:5], v26, s[12:15], s42 offen offset:0 sc0 sc1
buffer_store_dwordx4 v[6:9], v26, s[12:15], s42 offen offset:256 sc0 sc1
v_pk_fma_f32 v[128:129], v[44:45], v[24:25], v[112:113] op_sel_hi:[1,0,1] neg_lo:[0,1,0] neg_hi:[0,1,0]
v_pk_fma_f32 v[130:131], v[46:47], v[24:25], v[114:115] op_sel_hi:[1,0,1] neg_lo:[0,1,0] neg_hi:[0,1,0]
v_pk_fma_f32 v[132:133], v[48:49], v[24:25], v[116:117] op_sel_hi:[1,0,1] neg_lo:[0,1,0] neg_hi:[0,1,0]
v_pk_fma_f32 v[134:135], v[50:51], v[24:25], v[118:119] op_sel_hi:[1,0,1] neg_lo:[0,1,0] neg_hi:[0,1,0]
v_pk_fma_f32 v[136:137], v[52:53], v[24:25], v[120:121] op_sel_hi:[1,0,1] neg_lo:[0,1,0] neg_hi:[0,1,0]
v_pk_fma_f32 v[138:139], v[54:55], v[24:25], v[122:123] op_sel_hi:[1,0,1] neg_lo:[0,1,0] neg_hi:[0,1,0]
v_pk_fma_f32 v[140:141], v[56:57], v[24:25], v[124:125] op_sel_hi:[1,0,1] neg_lo:[0,1,0] neg_hi:[0,1,0]
v_pk_fma_f32 v[142:143], v[58:59], v[24:25], v[126:127] op_sel_hi:[1,0,1] neg_lo:[0,1,0] neg_hi:[0,1,0]
v_pk_mul_f32 v[128:129], v[128:129], v[24:25] op_sel:[0,1] op_sel_hi:[1,1]
v_pk_mul_f32 v[130:131], v[130:131], v[24:25] op_sel:[0,1] op_sel_hi:[1,1]
v_pk_mul_f32 v[132:133], v[132:133], v[24:25] op_sel:[0,1] op_sel_hi:[1,1]
v_pk_mul_f32 v[134:135], v[134:135], v[24:25] op_sel:[0,1] op_sel_hi:[1,1]
v_pk_mul_f32 v[136:137], v[136:137], v[24:25] op_sel:[0,1] op_sel_hi:[1,1]
v_pk_mul_f32 v[138:139], v[138:139], v[24:25] op_sel:[0,1] op_sel_hi:[1,1]
v_pk_mul_f32 v[140:141], v[140:141], v[24:25] op_sel:[0,1] op_sel_hi:[1,1]
v_pk_mul_f32 v[142:143], v[142:143], v[24:25] op_sel:[0,1] op_sel_hi:[1,1]
v_exp_f32 v144, v128
v_exp_f32 v145, v129
v_exp_f32 v146, v130
v_exp_f32 v147, v131
v_exp_f32 v148, v132
v_exp_f32 v149, v133
v_exp_f32 v150, v134
v_exp_f32 v151, v135
v_exp_f32 v152, v136
v_exp_f32 v153, v137
v_exp_f32 v154, v138
v_exp_f32 v155, v139
v_exp_f32 v156, v140
v_exp_f32 v157, v141
v_exp_f32 v158, v142
v_exp_f32 v159, v143
v_pk_fma_f32 v[144:145], v[144:145], s[28:29], s[28:29]
v_pk_fma_f32 v[146:147], v[146:147], s[28:29], s[28:29]
v_pk_fma_f32 v[148:149], v[148:149], s[28:29], s[28:29]
v_pk_fma_f32 v[150:151], v[150:151], s[28:29], s[28:29]
v_pk_fma_f32 v[152:153], v[152:153], s[28:29], s[28:29]
v_pk_fma_f32 v[154:155], v[154:155], s[28:29], s[28:29]
v_pk_fma_f32 v[156:157], v[156:157], s[28:29], s[28:29]
v_pk_fma_f32 v[158:159], v[158:159], s[28:29], s[28:29]
v_rcp_f32 v144, v144
v_rcp_f32 v145, v145
v_rcp_f32 v146, v146
v_rcp_f32 v147, v147
v_rcp_f32 v148, v148
v_rcp_f32 v149, v149
v_rcp_f32 v150, v150
v_rcp_f32 v151, v151
v_rcp_f32 v152, v152
v_rcp_f32 v153, v153
v_rcp_f32 v154, v154
v_rcp_f32 v155, v155
v_rcp_f32 v156, v156
v_rcp_f32 v157, v157
v_rcp_f32 v158, v158
v_rcp_f32 v159, v159
v_pk_mul_f32 v[128:129], v[128:129], v[144:145]
v_pk_mul_f32 v[130:131], v[130:131], v[146:147]
v_pk_mul_f32 v[132:133], v[132:133], v[148:149]
v_pk_mul_f32 v[134:135], v[134:135], v[150:151]
v_pk_mul_f32 v[136:137], v[136:137], v[152:153]
v_pk_mul_f32 v[138:139], v[138:139], v[154:155]
v_pk_mul_f32 v[140:141], v[140:141], v[156:157]
v_pk_mul_f32 v[142:143], v[142:143], v[158:159]
v_cvt_pk_bf16_f32 v10, v128, v129
v_cvt_pk_bf16_f32 v11, v130, v131
v_cvt_pk_bf16_f32 v12, v132, v133
v_cvt_pk_bf16_f32 v13, v134, v135
v_cvt_pk_bf16_f32 v14, v136, v137
v_cvt_pk_bf16_f32 v15, v138, v139
v_cvt_pk_bf16_f32 v16, v140, v141
v_cvt_pk_bf16_f32 v17, v142, v143
buffer_store_dwordx4 v[10:13], v26, s[12:15], s43 offen offset:0 sc0 sc1
buffer_store_dwordx4 v[14:17], v26, s[12:15], s43 offen offset:256 sc0 sc1
l1_kernel_g1done:
s_branch l1_kernel_fin
l1_kernel_bg:
s_barrier
s_load_dwordx2 s[52:53], s[0:1], 8
s_load_dwordx2 s[54:55], s[0:1], 16
s_load_dwordx2 s[56:57], s[0:1], 24
s_load_dwordx2 s[58:59], s[0:1], 32
s_load_dwordx2 s[60:61], s[0:1], 40
s_sub_u32 s75, s6, 8
s_mul_i32 s64, s4, 14
s_add_u32 s64, s64, s5
s_mul_i32 s64, s64, 3
s_add_u32 s64, s64, s75
s_cmp_ge_u32 s64, 640
s_cselect_b32 s64, 639, s64
s_lshl_b32 s65, s75, 14
s_add_u32 s65, s65, 98304
s_waitcnt lgkmcnt(0)
s_mov_b32 s32, s52
s_and_b32 s33, s53, 0xffff
s_mov_b32 s34, 0x28000
s_mov_b32 s35, 0x20000
s_mov_b32 s36, s54
s_and_b32 s37, s55, 0xffff
s_mov_b32 s38, 0x28000
s_mov_b32 s39, 0x20000
s_mov_b32 s40, s56
s_and_b32 s41, s57, 0xffff
s_mov_b32 s42, 0x28000
s_mov_b32 s43, 0x20000
s_mov_b32 s44, s58
s_and_b32 s45, s59, 0xffff
s_mov_b32 s46, 0x28000
s_mov_b32 s47, 0x20000
s_mov_b32 s48, s60
s_and_b32 s49, s61, 0xffff
s_mov_b32 s50, 0x500
s_mov_b32 s51, 0x20000
s_mov_b32 s12, s26
s_and_b32 s13, s27, 0xffff
s_mov_b32 s14, 0x1090000
s_mov_b32 s15, 0x20000
s_mul_i32 s66, s64, 1536
s_add_u32 s66, s66, 2686976
s_barrier
s_lshl_b32 s7, s64, 8
v_lshlrev_b32 v58, 1, v1
buffer_load_ushort v2, v58, s[32:35], s7 offen offset:0
buffer_load_ushort v3, v58, s[32:35], s7 offen offset:128
buffer_load_ushort v4, v58, s[36:39], s7 offen offset:0
buffer_load_ushort v5, v58, s[36:39], s7 offen offset:128
buffer_load_ushort v6, v58, s[40:43], s7 offen offset:0
buffer_load_ushort v7, v58, s[40:43], s7 offen offset:128
buffer_load_ushort v8, v58, s[44:47], s7 offen offset:0
buffer_load_ushort v9, v58, s[44:47], s7 offen offset:128
s_lshl_b32 s7, s64, 1
v_mov_b32 v59, 0
buffer_load_ushort v10, v59, s[48:51], s7 offen
s_barrier
s_barrier
s_barrier
s_waitcnt vmcnt(0)
s_mov_b32 s62, 0x3fb8aa3b
s_mov_b32 s63, 0x32a57060
v_lshlrev_b32 v2, 16, v2
v_lshlrev_b32 v3, 16, v3
v_lshlrev_b32 v4, 16, v4
v_lshlrev_b32 v5, 16, v5
v_lshlrev_b32 v6, 16, v6
v_lshlrev_b32 v7, 16, v7
v_lshlrev_b32 v8, 16, v8
v_lshlrev_b32 v9, 16, v9
v_lshlrev_b32 v10, 16, v10
v_mul_f32 v58, 0x3fb8aa3b, v10
v_fma_f32 v59, v10, s62, -v58
v_fma_f32 v59, v10, s63, v59
v_exp_f32 v10, v58
s_nop 0
v_mul_f32 v58, 0x3f317218, v10
v_fma_f32 v10, v58, v59, v10
v_cvt_pk_bf16_f32 v10, v10, v10
v_and_b32 v10, 0xffff0000, v10
v_mul_f32 v58, 0x3fb8aa3b, v2
v_fma_f32 v59, v2, s62, -v58
v_fma_f32 v59, v2, s63, v59
v_exp_f32 v60, v58
s_nop 0
v_mul_f32 v58, 0x3f317218, v60
v_fma_f32 v60, v58, v59, v60
v_cvt_pk_bf16_f32 v60, v60, v60
v_and_b32 v60, 0xffff0000, v60
v_mul_f32 v12, v4, v10
v_mul_f32 v13, v6, v10
v_mul_f32 v11, -v60, v10
v_mul_f32 v14, v8, v10
v_mul_f32 v12, 0x3e22f983, v12
v_mul_f32 v11, 0x3fb8aa3b, v11
v_add_f32 v50, v13, v13
v_add_f32 v51, v14, v14
v_exp_f32 v40, v11
v_mul_f32 v43, 0x41000000, v11
v_mul_f32 v46, 0x43800000, v11
v_fract_f32 v41, v12
v_mul_f32 v44, 0x41000000, v12
v_mul_f32 v47, 0x43800000, v12
v_cos_f32 v42, v41
v_exp_f32 v43, v43
v_exp_f32 v46, v46
v_sin_f32 v41, v41
v_fract_f32 v44, v44
v_fract_f32 v47, v47
v_mul_f32 v16, v40, v42
v_cos_f32 v45, v44
v_cos_f32 v48, v47
v_mul_f32 v17, v40, v41
v_sin_f32 v44, v44
v_sin_f32 v47, v47
v_mul_f32 v30, v43, v45
v_mul_f32 v32, v46, v48
v_mul_f32 v31, v43, v44
v_mul_f32 v33, v46, v47
v_cvt_pk_bf16_f32 v62, v16, v17
v_cvt_pk_bf16_f32 v69, v32, v33
v_mul_f32 v54, v50, v30
v_mul_f32 v18, v16, v16
v_mul_f32 v34, v32, v32
v_mul_f32 v55, v50, v31
v_mul_f32 v19, v16, v17
v_mul_f32 v35, v32, v33
v_fma_f32 v54, -v51, v31, v54
v_fma_f32 v18, -v17, v17, v18
v_fma_f32 v34, -v33, v33, v34
v_fma_f32 v55, v51, v30, v55
v_fma_f32 v19, v17, v16, v19
v_fma_f32 v35, v33, v32, v35
v_cvt_pk_bf16_f32 v102, v50, -v51
v_cvt_pk_bf16_f32 v63, v18, v19
v_cvt_pk_bf16_f32 v73, v34, v35
v_cvt_pk_bf16_f32 v103, v54, -v55
v_mul_f32 v20, v18, v16
v_mul_f32 v36, v34, v32
v_mul_f32 v21, v18, v17
v_mul_f32 v37, v34, v33
v_fma_f32 v20, -v19, v17, v20
v_fma_f32 v36, -v35, v33, v36
v_fma_f32 v21, v19, v16, v21
v_fma_f32 v37, v35, v32, v37
v_cvt_pk_bf16_f32 v64, v20, v21
v_cvt_pk_bf16_f32 v75, v36, v37
v_mul_f32 v22, v18, v18
v_mul_f32 v38, v34, v34
v_mul_f32 v23, v18, v19
v_mul_f32 v39, v34, v35
v_fma_f32 v22, -v19, v19, v22
v_fma_f32 v38, -v35, v35, v38
v_fma_f32 v23, v19, v18, v23
v_fma_f32 v39, v35, v34, v39
v_cvt_pk_bf16_f32 v65, v22, v23
v_cvt_pk_bf16_f32 v77, v38, v39
v_mul_f32 v24, v22, v16
v_mul_f32 v40, v38, v32
v_mul_f32 v25, v22, v17
v_mul_f32 v41, v38, v33
v_fma_f32 v24, -v23, v17, v24
s_barrier
v_fma_f32 v40, -v39, v33, v40
v_fma_f32 v25, v23, v16, v25
v_fma_f32 v41, v39, v32, v41
v_cvt_pk_bf16_f32 v66, v24, v25
v_cvt_pk_bf16_f32 v78, v40, v41
v_mul_f32 v26, v22, v18
v_mul_f32 v42, v38, v34
v_mul_f32 v27, v22, v19
v_mul_f32 v43, v38, v35
v_fma_f32 v26, -v23, v19, v26
v_fma_f32 v42, -v39, v35, v42
v_fma_f32 v27, v23, v18, v27
v_fma_f32 v43, v39, v34, v43
v_cvt_pk_bf16_f32 v67, v26, v27
v_cvt_pk_bf16_f32 v79, v42, v43
v_mul_f32 v28, v22, v20
v_mul_f32 v40, v38, v36
v_mul_f32 v29, v22, v21
v_mul_f32 v41, v38, v37
v_fma_f32 v28, -v23, v21, v28
v_fma_f32 v40, -v39, v37, v40
v_fma_f32 v29, v23, v20, v29
v_fma_f32 v41, v39, v36, v41
v_cvt_pk_bf16_f32 v68, v28, v29
v_cvt_pk_bf16_f32 v80, v40, v41
v_mul_f32 v42, v38, v38
v_mul_f32 v43, v38, v39
v_fma_f32 v42, -v39, v39, v42
v_fma_f32 v43, v39, v38, v43
v_cvt_pk_bf16_f32 v81, v42, v43
v_mul_f32 v48, v30, v30
v_mul_f32 v49, v30, v31
v_fma_f32 v48, -v31, v31, v48
v_fma_f32 v49, v31, v30, v49
v_mul_f32 v52, v50, v48
v_mul_f32 v56, v54, v48
v_mul_f32 v44, v32, v18
v_mul_f32 v53, v50, v49
v_mul_f32 v57, v54, v49
v_mul_f32 v45, v32, v19
v_fma_f32 v52, -v51, v49, v52
v_fma_f32 v56, -v55, v49, v56
v_fma_f32 v44, -v33, v19, v44
v_fma_f32 v53, v51, v48, v53
v_fma_f32 v57, v55, v48, v57
v_fma_f32 v45, v33, v18, v45
v_cvt_pk_bf16_f32 v104, v52, -v53
v_cvt_pk_bf16_f32 v105, v56, -v57
v_cvt_pk_bf16_f32 v70, v44, v45
v_mul_f32 v50, v52, v48
v_mul_f32 v54, v56, v48
v_mul_f32 v46, v32, v22
v_mul_f32 v51, v52, v49
v_mul_f32 v55, v56, v49
v_mul_f32 v47, v32, v23
v_fma_f32 v50, -v53, v49, v50
v_fma_f32 v54, -v57, v49, v54
v_fma_f32 v46, -v33, v23, v46
v_fma_f32 v51, v53, v48, v51
v_fma_f32 v55, v57, v48, v55
v_fma_f32 v47, v33, v22, v47
v_cvt_pk_bf16_f32 v106, v50, -v51
v_cvt_pk_bf16_f32 v107, v54, -v55
v_cvt_pk_bf16_f32 v71, v46, v47
v_mul_f32 v52, v50, v48
v_mul_f32 v56, v54, v48
v_mul_f32 v44, v32, v26
v_mul_f32 v53, v50, v49
v_mul_f32 v57, v54, v49
v_mul_f32 v45, v32, v27
v_fma_f32 v52, -v51, v49, v52
v_fma_f32 v56, -v55, v49, v56
v_fma_f32 v44, -v33, v27, v44
v_fma_f32 v53, v51, v48, v53
v_fma_f32 v57, v55, v48, v57
v_fma_f32 v45, v33, v26, v45
v_cvt_pk_bf16_f32 v108, v52, -v53
v_cvt_pk_bf16_f32 v109, v56, -v57
v_cvt_pk_bf16_f32 v72, v44, v45
v_mul_f32 v50, v52, v48
v_mul_f32 v54, v56, v48
v_mul_f32 v46, v34, v22
v_mul_f32 v51, v52, v49
v_mul_f32 v55, v56, v49
v_mul_f32 v47, v34, v23
v_fma_f32 v50, -v53, v49, v50
v_fma_f32 v54, -v57, v49, v54
v_fma_f32 v46, -v35, v23, v46
v_fma_f32 v51, v53, v48, v51
v_fma_f32 v55, v57, v48, v55
v_fma_f32 v47, v35, v22, v47
v_cvt_pk_bf16_f32 v110, v50, -v51
v_cvt_pk_bf16_f32 v111, v54, -v55
v_cvt_pk_bf16_f32 v74, v46, v47
v_mul_f32 v52, v50, v48
v_mul_f32 v56, v54, v48
v_mul_f32 v44, v36, v22
v_mul_f32 v53, v50, v49
v_mul_f32 v57, v54, v49
v_mul_f32 v45, v36, v23
s_barrier
v_fma_f32 v52, -v51, v49, v52
v_fma_f32 v56, -v55, v49, v56
v_fma_f32 v44, -v37, v23, v44
v_fma_f32 v53, v51, v48, v53
v_fma_f32 v57, v55, v48, v57
v_fma_f32 v45, v37, v22, v45
v_cvt_pk_bf16_f32 v112, v52, -v53
v_cvt_pk_bf16_f32 v113, v56, -v57
v_cvt_pk_bf16_f32 v76, v44, v45
v_mul_f32 v50, v52, v48
v_mul_f32 v54, v56, v48
v_mul_f32 v51, v52, v49
v_mul_f32 v55, v56, v49
v_fma_f32 v50, -v53, v49, v50
v_fma_f32 v54, -v57, v49, v54
v_fma_f32 v51, v53, v48, v51
v_fma_f32 v55, v57, v48, v55
v_cvt_pk_bf16_f32 v114, v50, -v51
v_cvt_pk_bf16_f32 v115, v54, -v55
v_mul_f32 v52, v50, v48
v_mul_f32 v56, v54, v48
v_mul_f32 v53, v50, v49
v_mul_f32 v57, v54, v49
v_fma_f32 v52, -v51, v49, v52
v_fma_f32 v56, -v55, v49, v56
v_fma_f32 v53, v51, v48, v53
v_fma_f32 v57, v55, v48, v57
v_cvt_pk_bf16_f32 v116, v52, -v53
v_cvt_pk_bf16_f32 v117, v56, -v57
v_mul_f32 v50, v52, v48
v_mul_f32 v54, v56, v48
v_mul_f32 v51, v52, v49
v_mul_f32 v55, v56, v49
v_fma_f32 v50, -v53, v49, v50
v_fma_f32 v54, -v57, v49, v54
v_fma_f32 v51, v53, v48, v51
v_fma_f32 v55, v57, v48, v55
v_cvt_pk_bf16_f32 v118, v50, -v51
v_cvt_pk_bf16_f32 v119, v54, -v55
v_mul_f32 v52, v50, v48
v_mul_f32 v56, v54, v48
v_mul_f32 v53, v50, v49
v_mul_f32 v57, v54, v49
v_fma_f32 v52, -v51, v49, v52
v_fma_f32 v56, -v55, v49, v56
v_fma_f32 v53, v51, v48, v53
v_fma_f32 v57, v55, v48, v57
v_cvt_pk_bf16_f32 v120, v52, -v53
v_cvt_pk_bf16_f32 v121, v56, -v57
v_mul_f32 v50, v52, v48
v_mul_f32 v54, v56, v48
v_mul_f32 v51, v52, v49
v_mul_f32 v55, v56, v49
v_fma_f32 v50, -v53, v49, v50
v_fma_f32 v54, -v57, v49, v54
v_fma_f32 v51, v53, v48, v51
v_fma_f32 v55, v57, v48, v55
v_cvt_pk_bf16_f32 v122, v50, -v51
v_cvt_pk_bf16_f32 v123, v54, -v55
v_mul_f32 v52, v50, v48
v_mul_f32 v56, v54, v48
v_mul_f32 v53, v50, v49
v_mul_f32 v57, v54, v49
v_fma_f32 v52, -v51, v49, v52
v_fma_f32 v56, -v55, v49, v56
v_fma_f32 v53, v51, v48, v53
v_fma_f32 v57, v55, v48, v57
v_cvt_pk_bf16_f32 v124, v52, -v53
v_cvt_pk_bf16_f32 v125, v56, -v57
v_mul_f32 v50, v52, v48
v_mul_f32 v54, v56, v48
v_mul_f32 v51, v52, v49
v_mul_f32 v55, v56, v49
v_fma_f32 v50, -v53, v49, v50
v_fma_f32 v54, -v57, v49, v54
v_fma_f32 v51, v53, v48, v51
v_fma_f32 v55, v57, v48, v55
v_cvt_pk_bf16_f32 v126, v50, -v51
v_cvt_pk_bf16_f32 v127, v54, -v55
v_mul_f32 v52, v50, v48
v_mul_f32 v56, v54, v48
v_mul_f32 v53, v50, v49
v_mul_f32 v57, v54, v49
v_fma_f32 v52, -v51, v49, v52
v_fma_f32 v56, -v55, v49, v56
v_fma_f32 v53, v51, v48, v53
v_fma_f32 v57, v55, v48, v57
v_cvt_pk_bf16_f32 v128, v52, -v53
v_cvt_pk_bf16_f32 v129, v56, -v57
v_mul_f32 v50, v52, v48
v_mul_f32 v54, v56, v48
v_mul_f32 v51, v52, v49
v_mul_f32 v55, v56, v49
v_fma_f32 v50, -v53, v49, v50
v_fma_f32 v54, -v57, v49, v54
v_fma_f32 v51, v53, v48, v51
v_fma_f32 v55, v57, v48, v55
v_cvt_pk_bf16_f32 v130, v50, -v51
v_cvt_pk_bf16_f32 v131, v54, -v55
v_mul_f32 v52, v50, v48
s_barrier
v_mul_f32 v56, v54, v48
v_mul_f32 v53, v50, v49
v_mul_f32 v57, v54, v49
v_fma_f32 v52, -v51, v49, v52
v_fma_f32 v56, -v55, v49, v56
v_fma_f32 v53, v51, v48, v53
v_fma_f32 v57, v55, v48, v57
v_cvt_pk_bf16_f32 v132, v52, -v53
v_cvt_pk_bf16_f32 v133, v56, -v57
v_mul_f32 v58, 0x3fb8aa3b, v3
v_fma_f32 v59, v3, s62, -v58
v_fma_f32 v59, v3, s63, v59
v_exp_f32 v60, v58
s_nop 0
v_mul_f32 v58, 0x3f317218, v60
v_fma_f32 v60, v58, v59, v60
v_cvt_pk_bf16_f32 v60, v60, v60
v_and_b32 v60, 0xffff0000, v60
v_mul_f32 v12, v5, v10
v_mul_f32 v13, v7, v10
v_mul_f32 v11, -v60, v10
v_mul_f32 v14, v9, v10
v_mul_f32 v12, 0x3e22f983, v12
v_mul_f32 v11, 0x3fb8aa3b, v11
v_add_f32 v50, v13, v13
v_add_f32 v51, v14, v14
v_exp_f32 v40, v11
v_mul_f32 v43, 0x41000000, v11
v_mul_f32 v46, 0x43800000, v11
v_fract_f32 v41, v12
v_mul_f32 v44, 0x41000000, v12
v_mul_f32 v47, 0x43800000, v12
v_cos_f32 v42, v41
v_exp_f32 v43, v43
v_exp_f32 v46, v46
v_sin_f32 v41, v41
v_fract_f32 v44, v44
v_fract_f32 v47, v47
v_mul_f32 v16, v40, v42
v_cos_f32 v45, v44
v_cos_f32 v48, v47
v_mul_f32 v17, v40, v41
v_sin_f32 v44, v44
v_sin_f32 v47, v47
v_mul_f32 v30, v43, v45
v_mul_f32 v32, v46, v48
v_mul_f32 v31, v43, v44
v_mul_f32 v33, v46, v47
v_cvt_pk_bf16_f32 v82, v16, v17
v_cvt_pk_bf16_f32 v89, v32, v33
v_mul_f32 v54, v50, v30
v_mul_f32 v18, v16, v16
v_mul_f32 v34, v32, v32
v_mul_f32 v55, v50, v31
v_mul_f32 v19, v16, v17
v_mul_f32 v35, v32, v33
v_fma_f32 v54, -v51, v31, v54
v_fma_f32 v18, -v17, v17, v18
v_fma_f32 v34, -v33, v33, v34
v_fma_f32 v55, v51, v30, v55
v_fma_f32 v19, v17, v16, v19
v_fma_f32 v35, v33, v32, v35
v_cvt_pk_bf16_f32 v134, v50, -v51
v_cvt_pk_bf16_f32 v83, v18, v19
v_cvt_pk_bf16_f32 v93, v34, v35
v_cvt_pk_bf16_f32 v135, v54, -v55
v_mul_f32 v20, v18, v16
v_mul_f32 v36, v34, v32
v_mul_f32 v21, v18, v17
v_mul_f32 v37, v34, v33
v_fma_f32 v20, -v19, v17, v20
v_fma_f32 v36, -v35, v33, v36
v_fma_f32 v21, v19, v16, v21
v_fma_f32 v37, v35, v32, v37
v_cvt_pk_bf16_f32 v84, v20, v21
v_cvt_pk_bf16_f32 v95, v36, v37
v_mul_f32 v22, v18, v18
v_mul_f32 v38, v34, v34
v_mul_f32 v23, v18, v19
v_mul_f32 v39, v34, v35
v_fma_f32 v22, -v19, v19, v22
v_fma_f32 v38, -v35, v35, v38
v_fma_f32 v23, v19, v18, v23
v_fma_f32 v39, v35, v34, v39
v_cvt_pk_bf16_f32 v85, v22, v23
v_cvt_pk_bf16_f32 v97, v38, v39
v_mul_f32 v24, v22, v16
v_mul_f32 v40, v38, v32
v_mul_f32 v25, v22, v17
v_mul_f32 v41, v38, v33
v_fma_f32 v24, -v23, v17, v24
v_fma_f32 v40, -v39, v33, v40
v_fma_f32 v25, v23, v16, v25
v_fma_f32 v41, v39, v32, v41
v_cvt_pk_bf16_f32 v86, v24, v25
v_cvt_pk_bf16_f32 v98, v40, v41
v_mul_f32 v26, v22, v18
v_mul_f32 v42, v38, v34
v_mul_f32 v27, v22, v19
v_mul_f32 v43, v38, v35
s_barrier
v_fma_f32 v26, -v23, v19, v26
v_fma_f32 v42, -v39, v35, v42
v_fma_f32 v27, v23, v18, v27
v_fma_f32 v43, v39, v34, v43
v_cvt_pk_bf16_f32 v87, v26, v27
v_cvt_pk_bf16_f32 v99, v42, v43
v_mul_f32 v28, v22, v20
v_mul_f32 v40, v38, v36
v_mul_f32 v29, v22, v21
v_mul_f32 v41, v38, v37
v_fma_f32 v28, -v23, v21, v28
v_fma_f32 v40, -v39, v37, v40
v_fma_f32 v29, v23, v20, v29
v_fma_f32 v41, v39, v36, v41
v_cvt_pk_bf16_f32 v88, v28, v29
v_cvt_pk_bf16_f32 v100, v40, v41
v_mul_f32 v42, v38, v38
v_mul_f32 v43, v38, v39
v_fma_f32 v42, -v39, v39, v42
v_fma_f32 v43, v39, v38, v43
v_cvt_pk_bf16_f32 v101, v42, v43
v_mul_f32 v48, v30, v30
v_mul_f32 v49, v30, v31
v_fma_f32 v48, -v31, v31, v48
v_fma_f32 v49, v31, v30, v49
v_mul_f32 v52, v50, v48
v_mul_f32 v56, v54, v48
v_mul_f32 v44, v32, v18
v_mul_f32 v53, v50, v49
v_mul_f32 v57, v54, v49
v_mul_f32 v45, v32, v19
v_fma_f32 v52, -v51, v49, v52
v_fma_f32 v56, -v55, v49, v56
v_fma_f32 v44, -v33, v19, v44
v_fma_f32 v53, v51, v48, v53
v_fma_f32 v57, v55, v48, v57
v_fma_f32 v45, v33, v18, v45
v_cvt_pk_bf16_f32 v136, v52, -v53
v_cvt_pk_bf16_f32 v137, v56, -v57
v_cvt_pk_bf16_f32 v90, v44, v45
v_mul_f32 v50, v52, v48
v_mul_f32 v54, v56, v48
v_mul_f32 v46, v32, v22
v_mul_f32 v51, v52, v49
v_mul_f32 v55, v56, v49
v_mul_f32 v47, v32, v23
v_fma_f32 v50, -v53, v49, v50
v_fma_f32 v54, -v57, v49, v54
v_fma_f32 v46, -v33, v23, v46
v_fma_f32 v51, v53, v48, v51
v_fma_f32 v55, v57, v48, v55
v_fma_f32 v47, v33, v22, v47
v_cvt_pk_bf16_f32 v138, v50, -v51
v_cvt_pk_bf16_f32 v139, v54, -v55
v_cvt_pk_bf16_f32 v91, v46, v47
v_mul_f32 v52, v50, v48
v_mul_f32 v56, v54, v48
v_mul_f32 v44, v32, v26
v_mul_f32 v53, v50, v49
v_mul_f32 v57, v54, v49
v_mul_f32 v45, v32, v27
v_fma_f32 v52, -v51, v49, v52
v_fma_f32 v56, -v55, v49, v56
v_fma_f32 v44, -v33, v27, v44
v_fma_f32 v53, v51, v48, v53
v_fma_f32 v57, v55, v48, v57
v_fma_f32 v45, v33, v26, v45
v_cvt_pk_bf16_f32 v140, v52, -v53
v_cvt_pk_bf16_f32 v141, v56, -v57
v_cvt_pk_bf16_f32 v92, v44, v45
v_mul_f32 v50, v52, v48
v_mul_f32 v54, v56, v48
v_mul_f32 v46, v34, v22
v_mul_f32 v51, v52, v49
v_mul_f32 v55, v56, v49
v_mul_f32 v47, v34, v23
v_fma_f32 v50, -v53, v49, v50
v_fma_f32 v54, -v57, v49, v54
v_fma_f32 v46, -v35, v23, v46
v_fma_f32 v51, v53, v48, v51
v_fma_f32 v55, v57, v48, v55
v_fma_f32 v47, v35, v22, v47
v_cvt_pk_bf16_f32 v142, v50, -v51
v_cvt_pk_bf16_f32 v143, v54, -v55
v_cvt_pk_bf16_f32 v94, v46, v47
v_mul_f32 v52, v50, v48
v_mul_f32 v56, v54, v48
v_mul_f32 v44, v36, v22
v_mul_f32 v53, v50, v49
v_mul_f32 v57, v54, v49
v_mul_f32 v45, v36, v23
v_fma_f32 v52, -v51, v49, v52
v_fma_f32 v56, -v55, v49, v56
v_fma_f32 v44, -v37, v23, v44
v_fma_f32 v53, v51, v48, v53
v_fma_f32 v57, v55, v48, v57
v_fma_f32 v45, v37, v22, v45
v_cvt_pk_bf16_f32 v144, v52, -v53
v_cvt_pk_bf16_f32 v145, v56, -v57
v_cvt_pk_bf16_f32 v96, v44, v45
s_barrier
v_mul_f32 v50, v52, v48
v_mul_f32 v54, v56, v48
v_mul_f32 v51, v52, v49
v_mul_f32 v55, v56, v49
v_fma_f32 v50, -v53, v49, v50
v_fma_f32 v54, -v57, v49, v54
v_fma_f32 v51, v53, v48, v51
v_fma_f32 v55, v57, v48, v55
v_cvt_pk_bf16_f32 v146, v50, -v51
v_cvt_pk_bf16_f32 v147, v54, -v55
v_mul_f32 v52, v50, v48
v_mul_f32 v56, v54, v48
v_mul_f32 v53, v50, v49
v_mul_f32 v57, v54, v49
v_fma_f32 v52, -v51, v49, v52
v_fma_f32 v56, -v55, v49, v56
v_fma_f32 v53, v51, v48, v53
v_fma_f32 v57, v55, v48, v57
v_cvt_pk_bf16_f32 v148, v52, -v53
v_cvt_pk_bf16_f32 v149, v56, -v57
v_mul_f32 v50, v52, v48
v_mul_f32 v54, v56, v48
v_mul_f32 v51, v52, v49
v_mul_f32 v55, v56, v49
v_fma_f32 v50, -v53, v49, v50
v_fma_f32 v54, -v57, v49, v54
v_fma_f32 v51, v53, v48, v51
v_fma_f32 v55, v57, v48, v55
v_cvt_pk_bf16_f32 v150, v50, -v51
v_cvt_pk_bf16_f32 v151, v54, -v55
v_mul_f32 v52, v50, v48
v_mul_f32 v56, v54, v48
v_mul_f32 v53, v50, v49
v_mul_f32 v57, v54, v49
v_fma_f32 v52, -v51, v49, v52
v_fma_f32 v56, -v55, v49, v56
v_fma_f32 v53, v51, v48, v53
v_fma_f32 v57, v55, v48, v57
v_cvt_pk_bf16_f32 v152, v52, -v53
v_cvt_pk_bf16_f32 v153, v56, -v57
v_mul_f32 v50, v52, v48
v_mul_f32 v54, v56, v48
v_mul_f32 v51, v52, v49
v_mul_f32 v55, v56, v49
v_fma_f32 v50, -v53, v49, v50
v_fma_f32 v54, -v57, v49, v54
v_fma_f32 v51, v53, v48, v51
v_fma_f32 v55, v57, v48, v55
v_cvt_pk_bf16_f32 v154, v50, -v51
v_cvt_pk_bf16_f32 v155, v54, -v55
v_mul_f32 v52, v50, v48
v_mul_f32 v56, v54, v48
v_mul_f32 v53, v50, v49
v_mul_f32 v57, v54, v49
v_fma_f32 v52, -v51, v49, v52
v_fma_f32 v56, -v55, v49, v56
v_fma_f32 v53, v51, v48, v53
v_fma_f32 v57, v55, v48, v57
v_cvt_pk_bf16_f32 v156, v52, -v53
v_cvt_pk_bf16_f32 v157, v56, -v57
v_mul_f32 v50, v52, v48
v_mul_f32 v54, v56, v48
v_mul_f32 v51, v52, v49
v_mul_f32 v55, v56, v49
v_fma_f32 v50, -v53, v49, v50
v_fma_f32 v54, -v57, v49, v54
v_fma_f32 v51, v53, v48, v51
v_fma_f32 v55, v57, v48, v55
v_cvt_pk_bf16_f32 v158, v50, -v51
v_cvt_pk_bf16_f32 v159, v54, -v55
v_mul_f32 v52, v50, v48
v_mul_f32 v56, v54, v48
v_mul_f32 v53, v50, v49
v_mul_f32 v57, v54, v49
v_fma_f32 v52, -v51, v49, v52
v_fma_f32 v56, -v55, v49, v56
v_fma_f32 v53, v51, v48, v53
v_fma_f32 v57, v55, v48, v57
v_cvt_pk_bf16_f32 v160, v52, -v53
v_cvt_pk_bf16_f32 v161, v56, -v57
v_mul_f32 v50, v52, v48
v_mul_f32 v54, v56, v48
v_mul_f32 v51, v52, v49
v_mul_f32 v55, v56, v49
v_fma_f32 v50, -v53, v49, v50
v_fma_f32 v54, -v57, v49, v54
v_fma_f32 v51, v53, v48, v51
v_fma_f32 v55, v57, v48, v55
v_cvt_pk_bf16_f32 v162, v50, -v51
v_cvt_pk_bf16_f32 v163, v54, -v55
v_mul_f32 v52, v50, v48
v_mul_f32 v56, v54, v48
v_mul_f32 v53, v50, v49
v_mul_f32 v57, v54, v49
v_fma_f32 v52, -v51, v49, v52
v_fma_f32 v56, -v55, v49, v56
v_fma_f32 v53, v51, v48, v53
v_fma_f32 v57, v55, v48, v57
v_cvt_pk_bf16_f32 v164, v52, -v53
v_cvt_pk_bf16_f32 v165, v56, -v57
s_barrier
v_lshlrev_b32 v58, 2, v1
v_add_u32 v58, s65, v58
v_xor_b32 v2, 0, v58
v_xor_b32 v3, 16, v58
v_xor_b32 v4, 32, v58
v_xor_b32 v5, 48, v58
v_xor_b32 v6, 64, v58
v_xor_b32 v7, 80, v58
v_xor_b32 v8, 96, v58
v_xor_b32 v9, 112, v58
v_xor_b32 v10, 128, v58
v_xor_b32 v11, 144, v58
v_xor_b32 v12, 160, v58
v_xor_b32 v13, 176, v58
v_xor_b32 v14, 192, v58
v_xor_b32 v15, 208, v58
v_xor_b32 v16, 224, v58
v_xor_b32 v17, 240, v58
v_mov_b32 v61, 0x3f80
ds_write2st64_b32 v2, v61, v77 offset0:0 offset1:16
ds_write2st64_b32 v3, v62, v78 offset0:1 offset1:17
ds_write2st64_b32 v4, v63, v79 offset0:2 offset1:18
ds_write2st64_b32 v5, v64, v80 offset0:3 offset1:19
ds_write2st64_b32 v6, v65, v81 offset0:4 offset1:20
ds_write_b32 v7, v66 offset:1280
ds_write_b32 v8, v67 offset:1536
ds_write_b32 v9, v68 offset:1792
ds_write_b32 v10, v69 offset:2048
ds_write_b32 v11, v70 offset:2304
ds_write_b32 v12, v71 offset:2560
ds_write_b32 v13, v72 offset:2816
ds_write_b32 v14, v73 offset:3072
ds_write_b32 v15, v74 offset:3328
ds_write_b32 v16, v75 offset:3584
ds_write_b32 v17, v76 offset:3840
ds_write2st64_b32 v2, v102, v118 offset0:32 offset1:48
ds_write2st64_b32 v3, v103, v119 offset0:33 offset1:49
ds_write2st64_b32 v4, v104, v120 offset0:34 offset1:50
ds_write2st64_b32 v5, v105, v121 offset0:35 offset1:51
ds_write2st64_b32 v6, v106, v122 offset0:36 offset1:52
ds_write2st64_b32 v7, v107, v123 offset0:37 offset1:53
ds_write2st64_b32 v8, v108, v124 offset0:38 offset1:54
ds_write2st64_b32 v9, v109, v125 offset0:39 offset1:55
ds_write2st64_b32 v10, v110, v126 offset0:40 offset1:56
ds_write2st64_b32 v11, v111, v127 offset0:41 offset1:57
ds_write2st64_b32 v12, v112, v128 offset0:42 offset1:58
ds_write2st64_b32 v13, v113, v129 offset0:43 offset1:59
ds_write2st64_b32 v14, v114, v130 offset0:44 offset1:60
ds_write2st64_b32 v15, v115, v131 offset0:45 offset1:61
ds_write2st64_b32 v16, v116, v132 offset0:46 offset1:62
ds_write2st64_b32 v17, v117, v133 offset0:47 offset1:63
v_and_b32 v58, 31, v1
v_lshrrev_b32 v59, 5, v1
v_and_b32 v60, 15, v1
v_xor_b32 v60, v60, v59
v_lshlrev_b32 v60, 4, v60
v_lshl_add_u32 v60, v58, 8, v60
v_add_u32 v60, s65, v60
v_xor_b32 v18, 0, v60
v_xor_b32 v19, 32, v60
v_xor_b32 v20, 64, v60
v_xor_b32 v21, 96, v60
v_xor_b32 v22, 128, v60
v_xor_b32 v23, 160, v60
v_xor_b32 v24, 192, v60
v_xor_b32 v25, 224, v60
s_waitcnt lgkmcnt(0)
ds_read_b128 v[26:29], v18
ds_read_b128 v[34:37], v18 offset:8192
ds_read_b128 v[30:33], v19
ds_read_b128 v[38:41], v19 offset:8192
s_waitcnt lgkmcnt(2)
v_mfma_f32_32x32x16_bf16 v[42:57], v[26:29], v[34:37], 0
ds_read_b128 v[26:29], v20
ds_read_b128 v[34:37], v20 offset:8192
s_waitcnt lgkmcnt(2)
v_mfma_f32_32x32x16_bf16 v[42:57], v[30:33], v[38:41], v[42:57]
ds_read_b128 v[30:33], v21
ds_read_b128 v[38:41], v21 offset:8192
s_waitcnt lgkmcnt(2)
v_mfma_f32_32x32x16_bf16 v[42:57], v[26:29], v[34:37], v[42:57]
ds_read_b128 v[26:29], v22
ds_read_b128 v[34:37], v22 offset:8192
s_waitcnt lgkmcnt(2)
v_mfma_f32_32x32x16_bf16 v[42:57], v[30:33], v[38:41], v[42:57]
ds_read_b128 v[30:33], v23
ds_read_b128 v[38:41], v23 offset:8192
s_waitcnt lgkmcnt(2)
v_mfma_f32_32x32x16_bf16 v[42:57], v[26:29], v[34:37], v[42:57]
ds_read_b128 v[26:29], v24
ds_read_b128 v[34:37], v24 offset:8192
s_waitcnt lgkmcnt(2)
v_mfma_f32_32x32x16_bf16 v[42:57], v[30:33], v[38:41], v[42:57]
ds_read_b128 v[30:33], v25
ds_read_b128 v[38:41], v25 offset:8192
s_waitcnt lgkmcnt(2)
v_mfma_f32_32x32x16_bf16 v[42:57], v[26:29], v[34:37], v[42:57]
s_waitcnt lgkmcnt(0)
v_mfma_f32_32x32x16_bf16 v[42:57], v[30:33], v[38:41], v[42:57]
v_mov_b32 v61, 0x3f80
ds_write2st64_b32 v2, v61, v97 offset0:0 offset1:16
ds_write2st64_b32 v3, v82, v98 offset0:1 offset1:17
ds_write2st64_b32 v4, v83, v99 offset0:2 offset1:18
ds_write2st64_b32 v5, v84, v100 offset0:3 offset1:19
ds_write2st64_b32 v6, v85, v101 offset0:4 offset1:20
ds_write_b32 v7, v86 offset:1280
ds_write_b32 v8, v87 offset:1536
ds_write_b32 v9, v88 offset:1792
ds_write_b32 v10, v89 offset:2048
ds_write_b32 v11, v90 offset:2304
ds_write_b32 v12, v91 offset:2560
ds_write_b32 v13, v92 offset:2816
ds_write_b32 v14, v93 offset:3072
ds_write_b32 v15, v94 offset:3328
ds_write_b32 v16, v95 offset:3584
ds_write_b32 v17, v96 offset:3840
ds_write2st64_b32 v2, v134, v150 offset0:32 offset1:48
ds_write2st64_b32 v3, v135, v151 offset0:33 offset1:49
ds_write2st64_b32 v4, v136, v152 offset0:34 offset1:50
ds_write2st64_b32 v5, v137, v153 offset0:35 offset1:51
ds_write2st64_b32 v6, v138, v154 offset0:36 offset1:52
ds_write2st64_b32 v7, v139, v155 offset0:37 offset1:53
ds_write2st64_b32 v8, v140, v156 offset0:38 offset1:54
ds_write2st64_b32 v9, v141, v157 offset0:39 offset1:55
ds_write2st64_b32 v10, v142, v158 offset0:40 offset1:56
ds_write2st64_b32 v11, v143, v159 offset0:41 offset1:57
ds_write2st64_b32 v12, v144, v160 offset0:42 offset1:58
ds_write2st64_b32 v13, v145, v161 offset0:43 offset1:59
ds_write2st64_b32 v14, v146, v162 offset0:44 offset1:60
ds_write2st64_b32 v15, v147, v163 offset0:45 offset1:61
ds_write2st64_b32 v16, v148, v164 offset0:46 offset1:62
ds_write2st64_b32 v17, v149, v165 offset0:47 offset1:63
s_waitcnt lgkmcnt(0)
ds_read_b128 v[26:29], v18
ds_read_b128 v[34:37], v18 offset:8192
ds_read_b128 v[30:33], v19
ds_read_b128 v[38:41], v19 offset:8192
s_waitcnt lgkmcnt(2)
v_mfma_f32_32x32x16_bf16 v[42:57], v[26:29], v[34:37], v[42:57]
ds_read_b128 v[26:29], v20
ds_read_b128 v[34:37], v20 offset:8192
s_waitcnt lgkmcnt(2)
v_mfma_f32_32x32x16_bf16 v[42:57], v[30:33], v[38:41], v[42:57]
ds_read_b128 v[30:33], v21
ds_read_b128 v[38:41], v21 offset:8192
s_waitcnt lgkmcnt(2)
v_mfma_f32_32x32x16_bf16 v[42:57], v[26:29], v[34:37], v[42:57]
ds_read_b128 v[26:29], v22
ds_read_b128 v[34:37], v22 offset:8192
s_waitcnt lgkmcnt(2)
v_mfma_f32_32x32x16_bf16 v[42:57], v[30:33], v[38:41], v[42:57]
ds_read_b128 v[30:33], v23
ds_read_b128 v[38:41], v23 offset:8192
s_waitcnt lgkmcnt(2)
v_mfma_f32_32x32x16_bf16 v[42:57], v[26:29], v[34:37], v[42:57]
ds_read_b128 v[26:29], v24
ds_read_b128 v[34:37], v24 offset:8192
s_waitcnt lgkmcnt(2)
v_mfma_f32_32x32x16_bf16 v[42:57], v[30:33], v[38:41], v[42:57]
ds_read_b128 v[30:33], v25
ds_read_b128 v[38:41], v25 offset:8192
s_waitcnt lgkmcnt(2)
v_mfma_f32_32x32x16_bf16 v[42:57], v[26:29], v[34:37], v[42:57]
s_waitcnt lgkmcnt(0)
v_mfma_f32_32x32x16_bf16 v[42:57], v[30:33], v[38:41], v[42:57]
s_nop 11
v_cvt_pk_bf16_f32 v62, v42, v43
v_cvt_pk_bf16_f32 v63, v44, v45
v_cvt_pk_bf16_f32 v64, v46, v47
v_cvt_pk_bf16_f32 v65, v48, v49
v_cvt_pk_bf16_f32 v66, v50, v51
v_cvt_pk_bf16_f32 v67, v52, v53
v_lshlrev_b32 v2, 4, v1
v_lshlrev_b32 v3, 3, v1
buffer_store_dwordx4 v[62:65], v2, s[12:15], s66 offen sc0 sc1
buffer_store_dwordx2 v[66:67], v3, s[12:15], s66 offen offset:1024 sc0 sc1
s_branch l1_kernel_fin
l1_kernel_spare:
v_lshrrev_b32 v1, 6, v0
s_nop 0
v_readfirstlane_b32 s6, v1
s_nop 3
s_cmp_ge_u32 s6, 8
s_cbranch_scc1 l1_kernel_fin
s_lshl_b32 s4, s20, 2
s_sub_u32 s21, s21, 28
s_add_u32 s4, s4, s21
s_getpc_b64 s[52:53]
l1_kernel_ct_pc:
s_sub_u32 s52, s52, l1_kernel_ct_pc-l1_kernel
s_subb_u32 s53, s53, 0
s_lshl_b32 s54, s6, 6
v_and_b32 v24, 63, v0
v_add_u32 v24, s54, v24
v_lshlrev_b32 v24, 7, v24
s_mov_b32 s54, l2_code_end-l1_kernel
l1_kernel_ct_tl:
v_cmp_gt_u32 vcc, s54, v24
s_nop 3
s_cmp_eq_u64 vcc, 0
s_cbranch_scc1 l1_kernel_ct_tl_done
v_mov_b32 v27, s53
v_add_co_u32 v26, vcc, s52, v24
s_nop 1
v_addc_co_u32 v27, vcc, 0, v27, vcc
v_cmp_gt_u32 vcc, s54, v24
s_nop 3
s_and_saveexec_b64 s[56:57], vcc
global_load_dword v25, v[26:27], off
s_mov_b64 exec, s[56:57]
v_add_u32 v24, 65536, v24
s_branch l1_kernel_ct_tl
l1_kernel_ct_tl_done:
s_load_dwordx2 s[26:27], s[0:1], 96
s_load_dwordx2 s[30:31], s[0:1], 72
v_lshrrev_b32 v1, 6, v0
s_nop 0
v_readfirstlane_b32 s5, v1
v_and_b32 v1, 63, v0
v_lshrrev_b32 v2, 4, v1
v_and_b32 v3, 15, v1
v_lshrrev_b32 v8, 1, v3
v_and_b32 v9, 1, v3
v_xor_b32 v10, v8, v2
v_xor_b32 v11, 4, v10
v_mul_u32_u24 v12, 1280, v2
v_lshlrev_b32 v10, 5, v10
v_lshl_add_u32 v10, v9, 4, v10
v_add_u32 v10, v10, v12
v_lshlrev_b32 v11, 5, v11
v_lshl_add_u32 v11, v9, 4, v11
v_add_u32 v11, v11, v12
s_lshl_b32 s39, s4, 3
s_add_u32 s39, s39, s5
s_lshl_b32 s40, s5, 14
v_lshrrev_b32 v96, 2, v3
v_and_b32 v97, 3, v3
v_and_b32 v98, 1, v2
v_lshrrev_b32 v99, 1, v2
v_lshl_add_u32 v14, v99, 2, v96
v_lshl_add_u32 v14, v98, 4, v14
v_lshlrev_b32 v14, 8, v14
v_lshl_add_u32 v14, v97, 3, v14
v_lshl_or_b32 v98, v98, 2, v96
v_lshl_add_u32 v14, v98, 5, v14
v_add_u32 v14, s40, v14
v_lshlrev_b32 v15, 4, v1
s_waitcnt lgkmcnt(0)
s_mov_b32 s12, s26
s_and_b32 s13, s27, 0xffff
s_mov_b32 s14, 0x1090000
s_mov_b32 s15, 0x20000
s_mov_b32 s20, s30
s_and_b32 s21, s31, 0xffff
s_mov_b32 s22, 0x21c000
s_mov_b32 s23, 0x20000
s_lshl_b32 s43, s4, 3
s_add_u32 s43, s43, s5
s_mul_i32 s43, s43, 10240
s_add_u32 s43, s43, 14745600
v_mov_b32 v20, -1
v_mov_b32 v21, -1
v_mov_b32 v22, -1
v_mov_b32 v23, -1
s_mul_i32 s41, s39, 52429
s_lshr_b32 s41, s41, 18
s_mul_i32 s42, s41, 5
s_sub_u32 s42, s39, s42
s_mul_i32 s43, s41, 40960
s_lshl_b32 s44, s42, 8
s_add_u32 s43, s43, s44
s_add_u32 m0, s40, 0
s_nop 0
buffer_load_dwordx4 v10, s[20:23], s43 offen lds
s_add_u32 s43, s43, 5120
s_add_u32 m0, s40, 1024
s_nop 0
buffer_load_dwordx4 v10, s[20:23], s43 offen lds
s_add_u32 s43, s43, 5120
s_add_u32 m0, s40, 2048
s_nop 0
buffer_load_dwordx4 v10, s[20:23], s43 offen lds
s_add_u32 s43, s43, 5120
s_add_u32 m0, s40, 3072
s_nop 0
buffer_load_dwordx4 v10, s[20:23], s43 offen lds
s_add_u32 s43, s43, 5120
s_add_u32 m0, s40, 4096
s_nop 0
buffer_load_dwordx4 v11, s[20:23], s43 offen lds
s_add_u32 s43, s43, 5120
s_add_u32 m0, s40, 5120
s_nop 0
buffer_load_dwordx4 v11, s[20:23], s43 offen lds
s_add_u32 s43, s43, 5120
s_add_u32 m0, s40, 6144
s_nop 0
buffer_load_dwordx4 v11, s[20:23], s43 offen lds
s_add_u32 s43, s43, 5120
s_add_u32 m0, s40, 7168
s_nop 0
buffer_load_dwordx4 v11, s[20:23], s43 offen lds
s_cmp_lt_u32 s39, 14
s_cbranch_scc1 l1_kernel_sp_two
s_waitcnt vmcnt(0)
v_xor_b32 v140, 0, v14
v_xor_b32 v141, 32, v14
v_xor_b32 v142, 64, v14
v_xor_b32 v143, 96, v14
v_xor_b32 v144, 128, v14
v_xor_b32 v145, 160, v14
v_xor_b32 v146, 192, v14
v_xor_b32 v147, 224, v14
ds_read_b64_tr_b16 v[100:101], v140 offset:0
ds_read_b64_tr_b16 v[102:103], v140 offset:2048
ds_read_b64_tr_b16 v[104:105], v141 offset:0
ds_read_b64_tr_b16 v[106:107], v141 offset:2048
ds_read_b64_tr_b16 v[108:109], v142 offset:0
ds_read_b64_tr_b16 v[110:111], v142 offset:2048
ds_read_b64_tr_b16 v[112:113], v143 offset:0
ds_read_b64_tr_b16 v[114:115], v143 offset:2048
ds_read_b64_tr_b16 v[116:117], v144 offset:0
ds_read_b64_tr_b16 v[118:119], v144 offset:2048
ds_read_b64_tr_b16 v[120:121], v145 offset:0
ds_read_b64_tr_b16 v[122:123], v145 offset:2048
ds_read_b64_tr_b16 v[124:125], v146 offset:0
ds_read_b64_tr_b16 v[126:127], v146 offset:2048
ds_read_b64_tr_b16 v[128:129], v147 offset:0
ds_read_b64_tr_b16 v[130:131], v147 offset:2048
s_lshl_b32 s44, s42, 3
s_add_u32 s44, s44, 0
s_mul_i32 s45, s44, 52429
s_lshr_b32 s45, s45, 18
s_mul_i32 s46, s45, 5
s_sub_u32 s46, s44, s46
s_mul_i32 s45, s45, 54
s_add_u32 s45, s45, s41
s_mul_i32 s45, s45, 5
s_add_u32 s45, s45, s46
s_lshl_b32 s45, s45, 10
s_add_u32 s45, s45, 5439488
s_waitcnt lgkmcnt(14)
buffer_store_dwordx4 v[100:103], v15, s[12:15], s45 offen sc0 sc1
s_lshl_b32 s44, s42, 3
s_add_u32 s44, s44, 1
s_mul_i32 s45, s44, 52429
s_lshr_b32 s45, s45, 18
s_mul_i32 s46, s45, 5
s_sub_u32 s46, s44, s46
s_mul_i32 s45, s45, 54
s_add_u32 s45, s45, s41
s_mul_i32 s45, s45, 5
s_add_u32 s45, s45, s46
s_lshl_b32 s45, s45, 10
s_add_u32 s45, s45, 5439488
s_waitcnt lgkmcnt(12)
buffer_store_dwordx4 v[104:107], v15, s[12:15], s45 offen sc0 sc1
s_lshl_b32 s44, s42, 3
s_add_u32 s44, s44, 2
s_mul_i32 s45, s44, 52429
s_lshr_b32 s45, s45, 18
s_mul_i32 s46, s45, 5
s_sub_u32 s46, s44, s46
s_mul_i32 s45, s45, 54
s_add_u32 s45, s45, s41
s_mul_i32 s45, s45, 5
s_add_u32 s45, s45, s46
s_lshl_b32 s45, s45, 10
s_add_u32 s45, s45, 5439488
s_waitcnt lgkmcnt(10)
buffer_store_dwordx4 v[108:111], v15, s[12:15], s45 offen sc0 sc1
s_lshl_b32 s44, s42, 3
s_add_u32 s44, s44, 3
s_mul_i32 s45, s44, 52429
s_lshr_b32 s45, s45, 18
s_mul_i32 s46, s45, 5
s_sub_u32 s46, s44, s46
s_mul_i32 s45, s45, 54
s_add_u32 s45, s45, s41
s_mul_i32 s45, s45, 5
s_add_u32 s45, s45, s46
s_lshl_b32 s45, s45, 10
s_add_u32 s45, s45, 5439488
s_waitcnt lgkmcnt(8)
buffer_store_dwordx4 v[112:115], v15, s[12:15], s45 offen sc0 sc1
s_lshl_b32 s44, s42, 3
s_add_u32 s44, s44, 4
s_mul_i32 s45, s44, 52429
s_lshr_b32 s45, s45, 18
s_mul_i32 s46, s45, 5
s_sub_u32 s46, s44, s46
s_mul_i32 s45, s45, 54
s_add_u32 s45, s45, s41
s_mul_i32 s45, s45, 5
s_add_u32 s45, s45, s46
s_lshl_b32 s45, s45, 10
s_add_u32 s45, s45, 5439488
s_waitcnt lgkmcnt(6)
buffer_store_dwordx4 v[116:119], v15, s[12:15], s45 offen sc0 sc1
s_lshl_b32 s44, s42, 3
s_add_u32 s44, s44, 5
s_mul_i32 s45, s44, 52429
s_lshr_b32 s45, s45, 18
s_mul_i32 s46, s45, 5
s_sub_u32 s46, s44, s46
s_mul_i32 s45, s45, 54
s_add_u32 s45, s45, s41
s_mul_i32 s45, s45, 5
s_add_u32 s45, s45, s46
s_lshl_b32 s45, s45, 10
s_add_u32 s45, s45, 5439488
s_waitcnt lgkmcnt(4)
buffer_store_dwordx4 v[120:123], v15, s[12:15], s45 offen sc0 sc1
s_lshl_b32 s44, s42, 3
s_add_u32 s44, s44, 6
s_mul_i32 s45, s44, 52429
s_lshr_b32 s45, s45, 18
s_mul_i32 s46, s45, 5
s_sub_u32 s46, s44, s46
s_mul_i32 s45, s45, 54
s_add_u32 s45, s45, s41
s_mul_i32 s45, s45, 5
s_add_u32 s45, s45, s46
s_lshl_b32 s45, s45, 10
s_add_u32 s45, s45, 5439488
s_waitcnt lgkmcnt(2)
buffer_store_dwordx4 v[124:127], v15, s[12:15], s45 offen sc0 sc1
s_lshl_b32 s44, s42, 3
s_add_u32 s44, s44, 7
s_mul_i32 s45, s44, 52429
s_lshr_b32 s45, s45, 18
s_mul_i32 s46, s45, 5
s_sub_u32 s46, s44, s46
s_mul_i32 s45, s45, 54
s_add_u32 s45, s45, s41
s_mul_i32 s45, s45, 5
s_add_u32 s45, s45, s46
s_lshl_b32 s45, s45, 10
s_add_u32 s45, s45, 5439488
s_waitcnt lgkmcnt(0)
buffer_store_dwordx4 v[128:131], v15, s[12:15], s45 offen sc0 sc1
s_branch l1_kernel_sp_done
l1_kernel_sp_two:
s_add_u32 s39, s39, 256
s_mul_i32 s47, s39, 52429
s_lshr_b32 s47, s47, 18
s_mul_i32 s48, s47, 5
s_sub_u32 s48, s39, s48
s_mul_i32 s43, s47, 40960
s_lshl_b32 s44, s48, 8
s_add_u32 s43, s43, s44
s_add_u32 m0, s40, 8192
s_nop 0
buffer_load_dwordx4 v10, s[20:23], s43 offen lds
s_add_u32 s43, s43, 5120
s_add_u32 m0, s40, 9216
s_nop 0
buffer_load_dwordx4 v10, s[20:23], s43 offen lds
s_add_u32 s43, s43, 5120
s_add_u32 m0, s40, 10240
s_nop 0
buffer_load_dwordx4 v10, s[20:23], s43 offen lds
s_add_u32 s43, s43, 5120
s_add_u32 m0, s40, 11264
s_nop 0
buffer_load_dwordx4 v10, s[20:23], s43 offen lds
s_add_u32 s43, s43, 5120
s_add_u32 m0, s40, 12288
s_nop 0
buffer_load_dwordx4 v11, s[20:23], s43 offen lds
s_add_u32 s43, s43, 5120
s_add_u32 m0, s40, 13312
s_nop 0
buffer_load_dwordx4 v11, s[20:23], s43 offen lds
s_add_u32 s43, s43, 5120
s_add_u32 m0, s40, 14336
s_nop 0
buffer_load_dwordx4 v11, s[20:23], s43 offen lds
s_add_u32 s43, s43, 5120
s_add_u32 m0, s40, 15360
s_nop 0
buffer_load_dwordx4 v11, s[20:23], s43 offen lds
s_waitcnt vmcnt(8)
v_xor_b32 v140, 0, v14
v_xor_b32 v141, 32, v14
v_xor_b32 v142, 64, v14
v_xor_b32 v143, 96, v14
v_xor_b32 v144, 128, v14
v_xor_b32 v145, 160, v14
v_xor_b32 v146, 192, v14
v_xor_b32 v147, 224, v14
ds_read_b64_tr_b16 v[100:101], v140 offset:0
ds_read_b64_tr_b16 v[102:103], v140 offset:2048
ds_read_b64_tr_b16 v[104:105], v141 offset:0
ds_read_b64_tr_b16 v[106:107], v141 offset:2048
ds_read_b64_tr_b16 v[108:109], v142 offset:0
ds_read_b64_tr_b16 v[110:111], v142 offset:2048
ds_read_b64_tr_b16 v[112:113], v143 offset:0
ds_read_b64_tr_b16 v[114:115], v143 offset:2048
ds_read_b64_tr_b16 v[116:117], v144 offset:0
ds_read_b64_tr_b16 v[118:119], v144 offset:2048
ds_read_b64_tr_b16 v[120:121], v145 offset:0
ds_read_b64_tr_b16 v[122:123], v145 offset:2048
ds_read_b64_tr_b16 v[124:125], v146 offset:0
ds_read_b64_tr_b16 v[126:127], v146 offset:2048
ds_read_b64_tr_b16 v[128:129], v147 offset:0
ds_read_b64_tr_b16 v[130:131], v147 offset:2048
s_lshl_b32 s44, s42, 3
s_add_u32 s44, s44, 0
s_mul_i32 s45, s44, 52429
s_lshr_b32 s45, s45, 18
s_mul_i32 s46, s45, 5
s_sub_u32 s46, s44, s46
s_mul_i32 s45, s45, 54
s_add_u32 s45, s45, s41
s_mul_i32 s45, s45, 5
s_add_u32 s45, s45, s46
s_lshl_b32 s45, s45, 10
s_add_u32 s45, s45, 5439488
s_waitcnt lgkmcnt(14)
buffer_store_dwordx4 v[100:103], v15, s[12:15], s45 offen sc0 sc1
s_lshl_b32 s44, s42, 3
s_add_u32 s44, s44, 1
s_mul_i32 s45, s44, 52429
s_lshr_b32 s45, s45, 18
s_mul_i32 s46, s45, 5
s_sub_u32 s46, s44, s46
s_mul_i32 s45, s45, 54
s_add_u32 s45, s45, s41
s_mul_i32 s45, s45, 5
s_add_u32 s45, s45, s46
s_lshl_b32 s45, s45, 10
s_add_u32 s45, s45, 5439488
s_waitcnt lgkmcnt(12)
buffer_store_dwordx4 v[104:107], v15, s[12:15], s45 offen sc0 sc1
s_lshl_b32 s44, s42, 3
s_add_u32 s44, s44, 2
s_mul_i32 s45, s44, 52429
s_lshr_b32 s45, s45, 18
s_mul_i32 s46, s45, 5
s_sub_u32 s46, s44, s46
s_mul_i32 s45, s45, 54
s_add_u32 s45, s45, s41
s_mul_i32 s45, s45, 5
s_add_u32 s45, s45, s46
s_lshl_b32 s45, s45, 10
s_add_u32 s45, s45, 5439488
s_waitcnt lgkmcnt(10)
buffer_store_dwordx4 v[108:111], v15, s[12:15], s45 offen sc0 sc1
s_lshl_b32 s44, s42, 3
s_add_u32 s44, s44, 3
s_mul_i32 s45, s44, 52429
s_lshr_b32 s45, s45, 18
s_mul_i32 s46, s45, 5
s_sub_u32 s46, s44, s46
s_mul_i32 s45, s45, 54
s_add_u32 s45, s45, s41
s_mul_i32 s45, s45, 5
s_add_u32 s45, s45, s46
s_lshl_b32 s45, s45, 10
s_add_u32 s45, s45, 5439488
s_waitcnt lgkmcnt(8)
buffer_store_dwordx4 v[112:115], v15, s[12:15], s45 offen sc0 sc1
s_lshl_b32 s44, s42, 3
s_add_u32 s44, s44, 4
s_mul_i32 s45, s44, 52429
s_lshr_b32 s45, s45, 18
s_mul_i32 s46, s45, 5
s_sub_u32 s46, s44, s46
s_mul_i32 s45, s45, 54
s_add_u32 s45, s45, s41
s_mul_i32 s45, s45, 5
s_add_u32 s45, s45, s46
s_lshl_b32 s45, s45, 10
s_add_u32 s45, s45, 5439488
s_waitcnt lgkmcnt(6)
buffer_store_dwordx4 v[116:119], v15, s[12:15], s45 offen sc0 sc1
s_lshl_b32 s44, s42, 3
s_add_u32 s44, s44, 5
s_mul_i32 s45, s44, 52429
s_lshr_b32 s45, s45, 18
s_mul_i32 s46, s45, 5
s_sub_u32 s46, s44, s46
s_mul_i32 s45, s45, 54
s_add_u32 s45, s45, s41
s_mul_i32 s45, s45, 5
s_add_u32 s45, s45, s46
s_lshl_b32 s45, s45, 10
s_add_u32 s45, s45, 5439488
s_waitcnt lgkmcnt(4)
buffer_store_dwordx4 v[120:123], v15, s[12:15], s45 offen sc0 sc1
s_lshl_b32 s44, s42, 3
s_add_u32 s44, s44, 6
s_mul_i32 s45, s44, 52429
s_lshr_b32 s45, s45, 18
s_mul_i32 s46, s45, 5
s_sub_u32 s46, s44, s46
s_mul_i32 s45, s45, 54
s_add_u32 s45, s45, s41
s_mul_i32 s45, s45, 5
s_add_u32 s45, s45, s46
s_lshl_b32 s45, s45, 10
s_add_u32 s45, s45, 5439488
s_waitcnt lgkmcnt(2)
buffer_store_dwordx4 v[124:127], v15, s[12:15], s45 offen sc0 sc1
s_lshl_b32 s44, s42, 3
s_add_u32 s44, s44, 7
s_mul_i32 s45, s44, 52429
s_lshr_b32 s45, s45, 18
s_mul_i32 s46, s45, 5
s_sub_u32 s46, s44, s46
s_mul_i32 s45, s45, 54
s_add_u32 s45, s45, s41
s_mul_i32 s45, s45, 5
s_add_u32 s45, s45, s46
s_lshl_b32 s45, s45, 10
s_add_u32 s45, s45, 5439488
s_waitcnt lgkmcnt(0)
buffer_store_dwordx4 v[128:131], v15, s[12:15], s45 offen sc0 sc1
s_waitcnt vmcnt(8)
v_xor_b32 v140, 0, v14
v_xor_b32 v141, 32, v14
v_xor_b32 v142, 64, v14
v_xor_b32 v143, 96, v14
v_xor_b32 v144, 128, v14
v_xor_b32 v145, 160, v14
v_xor_b32 v146, 192, v14
v_xor_b32 v147, 224, v14
ds_read_b64_tr_b16 v[100:101], v140 offset:8192
ds_read_b64_tr_b16 v[102:103], v140 offset:10240
ds_read_b64_tr_b16 v[104:105], v141 offset:8192
ds_read_b64_tr_b16 v[106:107], v141 offset:10240
ds_read_b64_tr_b16 v[108:109], v142 offset:8192
ds_read_b64_tr_b16 v[110:111], v142 offset:10240
ds_read_b64_tr_b16 v[112:113], v143 offset:8192
ds_read_b64_tr_b16 v[114:115], v143 offset:10240
ds_read_b64_tr_b16 v[116:117], v144 offset:8192
ds_read_b64_tr_b16 v[118:119], v144 offset:10240
ds_read_b64_tr_b16 v[120:121], v145 offset:8192
ds_read_b64_tr_b16 v[122:123], v145 offset:10240
ds_read_b64_tr_b16 v[124:125], v146 offset:8192
ds_read_b64_tr_b16 v[126:127], v146 offset:10240
ds_read_b64_tr_b16 v[128:129], v147 offset:8192
ds_read_b64_tr_b16 v[130:131], v147 offset:10240
s_lshl_b32 s44, s48, 3
s_add_u32 s44, s44, 0
s_mul_i32 s45, s44, 52429
s_lshr_b32 s45, s45, 18
s_mul_i32 s46, s45, 5
s_sub_u32 s46, s44, s46
s_mul_i32 s45, s45, 54
s_add_u32 s45, s45, s47
s_mul_i32 s45, s45, 5
s_add_u32 s45, s45, s46
s_lshl_b32 s45, s45, 10
s_add_u32 s45, s45, 5439488
s_waitcnt lgkmcnt(14)
buffer_store_dwordx4 v[100:103], v15, s[12:15], s45 offen sc0 sc1
s_lshl_b32 s44, s48, 3
s_add_u32 s44, s44, 1
s_mul_i32 s45, s44, 52429
s_lshr_b32 s45, s45, 18
s_mul_i32 s46, s45, 5
s_sub_u32 s46, s44, s46
s_mul_i32 s45, s45, 54
s_add_u32 s45, s45, s47
s_mul_i32 s45, s45, 5
s_add_u32 s45, s45, s46
s_lshl_b32 s45, s45, 10
s_add_u32 s45, s45, 5439488
s_waitcnt lgkmcnt(12)
buffer_store_dwordx4 v[104:107], v15, s[12:15], s45 offen sc0 sc1
s_lshl_b32 s44, s48, 3
s_add_u32 s44, s44, 2
s_mul_i32 s45, s44, 52429
s_lshr_b32 s45, s45, 18
s_mul_i32 s46, s45, 5
s_sub_u32 s46, s44, s46
s_mul_i32 s45, s45, 54
s_add_u32 s45, s45, s47
s_mul_i32 s45, s45, 5
s_add_u32 s45, s45, s46
s_lshl_b32 s45, s45, 10
s_add_u32 s45, s45, 5439488
s_waitcnt lgkmcnt(10)
buffer_store_dwordx4 v[108:111], v15, s[12:15], s45 offen sc0 sc1
s_lshl_b32 s44, s48, 3
s_add_u32 s44, s44, 3
s_mul_i32 s45, s44, 52429
s_lshr_b32 s45, s45, 18
s_mul_i32 s46, s45, 5
s_sub_u32 s46, s44, s46
s_mul_i32 s45, s45, 54
s_add_u32 s45, s45, s47
s_mul_i32 s45, s45, 5
s_add_u32 s45, s45, s46
s_lshl_b32 s45, s45, 10
s_add_u32 s45, s45, 5439488
s_waitcnt lgkmcnt(8)
buffer_store_dwordx4 v[112:115], v15, s[12:15], s45 offen sc0 sc1
s_lshl_b32 s44, s48, 3
s_add_u32 s44, s44, 4
s_mul_i32 s45, s44, 52429
s_lshr_b32 s45, s45, 18
s_mul_i32 s46, s45, 5
s_sub_u32 s46, s44, s46
s_mul_i32 s45, s45, 54
s_add_u32 s45, s45, s47
s_mul_i32 s45, s45, 5
s_add_u32 s45, s45, s46
s_lshl_b32 s45, s45, 10
s_add_u32 s45, s45, 5439488
s_waitcnt lgkmcnt(6)
buffer_store_dwordx4 v[116:119], v15, s[12:15], s45 offen sc0 sc1
s_lshl_b32 s44, s48, 3
s_add_u32 s44, s44, 5
s_mul_i32 s45, s44, 52429
s_lshr_b32 s45, s45, 18
s_mul_i32 s46, s45, 5
s_sub_u32 s46, s44, s46
s_mul_i32 s45, s45, 54
s_add_u32 s45, s45, s47
s_mul_i32 s45, s45, 5
s_add_u32 s45, s45, s46
s_lshl_b32 s45, s45, 10
s_add_u32 s45, s45, 5439488
s_waitcnt lgkmcnt(4)
buffer_store_dwordx4 v[120:123], v15, s[12:15], s45 offen sc0 sc1
s_lshl_b32 s44, s48, 3
s_add_u32 s44, s44, 6
s_mul_i32 s45, s44, 52429
s_lshr_b32 s45, s45, 18
s_mul_i32 s46, s45, 5
s_sub_u32 s46, s44, s46
s_mul_i32 s45, s45, 54
s_add_u32 s45, s45, s47
s_mul_i32 s45, s45, 5
s_add_u32 s45, s45, s46
s_lshl_b32 s45, s45, 10
s_add_u32 s45, s45, 5439488
s_waitcnt lgkmcnt(2)
buffer_store_dwordx4 v[124:127], v15, s[12:15], s45 offen sc0 sc1
s_lshl_b32 s44, s48, 3
s_add_u32 s44, s44, 7
s_mul_i32 s45, s44, 52429
s_lshr_b32 s45, s45, 18
s_mul_i32 s46, s45, 5
s_sub_u32 s46, s44, s46
s_mul_i32 s45, s45, 54
s_add_u32 s45, s45, s47
s_mul_i32 s45, s45, 5
s_add_u32 s45, s45, s46
s_lshl_b32 s45, s45, 10
s_add_u32 s45, s45, 5439488
s_waitcnt lgkmcnt(0)
buffer_store_dwordx4 v[128:131], v15, s[12:15], s45 offen sc0 sc1
l1_kernel_sp_done:
s_lshl_b32 s43, s4, 3
s_add_u32 s43, s43, s5
s_mul_i32 s43, s43, 10240
s_add_u32 s43, s43, 14745600
buffer_store_dwordx4 v[20:23], v15, s[12:15], s43 offen sc0 sc1
s_add_u32 s43, s43, 1024
buffer_store_dwordx4 v[20:23], v15, s[12:15], s43 offen sc0 sc1
s_add_u32 s43, s43, 1024
buffer_store_dwordx4 v[20:23], v15, s[12:15], s43 offen sc0 sc1
s_add_u32 s43, s43, 1024
buffer_store_dwordx4 v[20:23], v15, s[12:15], s43 offen sc0 sc1
s_add_u32 s43, s43, 1024
buffer_store_dwordx4 v[20:23], v15, s[12:15], s43 offen sc0 sc1
s_add_u32 s43, s43, 1024
buffer_store_dwordx4 v[20:23], v15, s[12:15], s43 offen sc0 sc1
s_add_u32 s43, s43, 1024
buffer_store_dwordx4 v[20:23], v15, s[12:15], s43 offen sc0 sc1
s_add_u32 s43, s43, 1024
buffer_store_dwordx4 v[20:23], v15, s[12:15], s43 offen sc0 sc1
s_add_u32 s43, s43, 1024
buffer_store_dwordx4 v[20:23], v15, s[12:15], s43 offen sc0 sc1
s_add_u32 s43, s43, 1024
buffer_store_dwordx4 v[20:23], v15, s[12:15], s43 offen sc0 sc1
l1_kernel_fin:
l1_kernel_end:
s_endpgm

.section .rodata,"a"
.p2align 6
.amdhsa_kernel l1_kernel
  .amdhsa_next_free_vgpr 168
  .amdhsa_next_free_sgpr 102
  .amdhsa_accum_offset 168
  .amdhsa_group_segment_fixed_size 0
  .amdhsa_kernarg_size 104
  .amdhsa_user_sgpr_count 2
  .amdhsa_user_sgpr_kernarg_segment_ptr 1
  .amdhsa_system_sgpr_workgroup_id_x 1
.end_amdhsa_kernel
.text
.globl l2_kernel
.p2align 8
.type l2_kernel,@function
l2_kernel:
s_cmp_ge_u32 s2, 256
s_cbranch_scc1 l2_kernel_end
s_load_dwordx2 s[24:25], s[0:1], 96
s_load_dwordx2 s[26:27], s[0:1], 0
s_load_dwordx2 s[28:29], s[0:1], 80
s_load_dwordx2 s[30:31], s[0:1], 48
v_lshrrev_b32 v1, 6, v0
s_nop 0
v_readfirstlane_b32 s6, v1
v_and_b32 v1, 63, v0
s_and_b32 s20, s2, 7
s_lshr_b32 s21, s2, 3
s_lshr_b32 s4, s20, 1
s_lshl_b32 s4, s4, 3
s_and_b32 s5, s21, 7
s_add_u32 s4, s4, s5
s_and_b32 s5, s20, 1
s_lshl_b32 s5, s5, 2
s_lshr_b32 s21, s21, 3
s_add_u32 s5, s5, s21
s_cmp_lt_u32 s6, 4
s_cbranch_scc1 l2_kernel_gemm
s_sub_u32 s11, s6, 4
s_setprio 2
s_and_b32 s7, s2, 1
s_lshr_b32 s10, s2, 1
s_mul_i32 s10, s10, 5
s_mul_i32 s8, s7, 3
s_add_u32 s8, s8, s10
s_add_u32 s9, s8, 1
s_add_u32 s10, s10, 2
v_and_b32 v14, 15, v1
v_lshrrev_b32 v15, 4, v1
v_lshrrev_b32 v16, 1, v14
v_lshlrev_b32 v16, 2, v16
v_lshlrev_b32 v17, 4, v15
v_sub_u32 v18, v17, v16
v_and_b32 v19, 1, v14
v_cmp_eq_u32 vcc, 1, v19
v_mov_b32 v20, 78876
v_mov_b32 v21, 74716
v_cndmask_b32 v20, v20, v21, vcc
v_add_u32 v2, v18, v20
v_lshl_add_u32 v3, v14, 5, v17
v_add_u32 v3, 70112, v3
v_lshlrev_b32 v14, 2, v1
v_add_u32 v14, 153856, v14
v_mov_b32 v15, 0
v_cmp_gt_u32 vcc, 16, v1
s_nop 3
s_and_saveexec_b64 s[60:61], vcc
ds_write_b32 v14, v15
s_mov_b64 exec, s[60:61]
s_waitcnt lgkmcnt(0)
s_mov_b32 s32, s24
s_and_b32 s33, s25, 0xffff
s_mov_b32 s34, 0x1090000
s_mov_b32 s35, 0x20000
s_mov_b32 s44, s30
s_and_b32 s45, s31, 0xffff
s_mov_b32 s46, 0x500
s_mov_b32 s47, 0x20000
s_cmp_ge_u32 s11, 3
s_cbranch_scc1 kl_1
s_cmp_eq_u32 s11, 1
s_cselect_b32 s21, s9, s8
s_cmp_eq_u32 s11, 2
s_cselect_b32 s21, s10, s21
s_mul_i32 s21, s21, 1536
s_add_u32 s21, s21, 2686976
v_lshlrev_b32 v18, 4, v1
v_lshlrev_b32 v19, 3, v1
buffer_load_dwordx4 v[160:163], v18, s[32:35], s21 offen
buffer_load_dwordx2 v[164:165], v19, s[32:35], s21 offen offset:1024
kl_1:
v_lshlrev_b32 v14, 4, v1
s_lshl_b32 s20, s11, 10
s_lshl_b32 s22, s8, 12
s_add_u32 s22, s22, s20
s_add_u32 s22, s22, 65536
s_add_u32 m0, s20, 70144
s_nop 0
buffer_load_dwordx4 v14, s[32:35], s22 offen lds
s_lshl_b32 s22, s9, 12
s_add_u32 s22, s22, s20
s_add_u32 s22, s22, 65536
s_add_u32 m0, s20, 83200
s_nop 0
buffer_load_dwordx4 v14, s[32:35], s22 offen lds
s_lshl_b32 s22, s10, 12
s_add_u32 s22, s22, s20
s_add_u32 s22, s22, 65536
s_add_u32 m0, s20, 96256
s_nop 0
buffer_load_dwordx4 v14, s[32:35], s22 offen lds
s_cmp_ge_u32 s11, 3
s_cbranch_scc1 cz_2
s_mul_i32 s21, s11, 13056
s_add_u32 s21, s21, 69632
v_mov_b32 v16, 0
v_mov_b32 v17, 0
v_lshlrev_b32 v15, 3, v1
v_add_u32 v15, s21, v15
ds_write_b64 v15, v[16:17] offset:0
v_and_b32 v15, 7, v1
v_lshlrev_b32 v15, 2, v15
v_add_u32 v15, s21, v15
ds_write_b32 v15, v16 offset:8704
ds_write_b32 v15, v16 offset:12864
cz_2:
v_mov_b32 v247, 0
s_lshl_b32 s20, s8, 1
buffer_load_ushort v244, v247, s[44:47], s20 offen
s_lshl_b32 s20, s9, 1
buffer_load_ushort v245, v247, s[44:47], s20 offen
s_lshl_b32 s20, s10, 1
buffer_load_ushort v246, v247, s[44:47], s20 offen
s_waitcnt lgkmcnt(0)
s_barrier
s_mov_b32 s36, s26
s_and_b32 s37, s27, 0xffff
s_mov_b32 s38, 0x280000
s_mov_b32 s39, 0x20000
s_mul_i32 s20, s4, 81920
s_mul_i32 s21, s5, 160
s_add_u32 s56, s20, s21
s_add_u32 s20, s11, 0
s_lshl_b32 s20, s20, 6
v_add_u32 v14, s20, v1
v_mul_u32_u24 v15, 0x199a, v14
v_lshrrev_b32 v15, 16, v15
v_mul_u32_u24 v16, 10, v15
v_sub_u32 v16, v14, v16
v_mul_u32_u24 v15, 1280, v15
v_lshl_add_u32 v248, v16, 4, v15
s_add_u32 s20, s11, 4
s_lshl_b32 s20, s20, 6
v_add_u32 v14, s20, v1
v_mul_u32_u24 v15, 0x199a, v14
v_lshrrev_b32 v15, 16, v15
v_mul_u32_u24 v16, 10, v15
v_sub_u32 v16, v14, v16
v_mul_u32_u24 v15, 1280, v15
v_lshl_add_u32 v249, v16, 4, v15
s_add_u32 s20, s11, 8
s_lshl_b32 s20, s20, 6
v_add_u32 v14, s20, v1
v_mul_u32_u24 v15, 0x199a, v14
v_lshrrev_b32 v15, 16, v15
v_mul_u32_u24 v16, 10, v15
v_sub_u32 v16, v14, v16
v_mul_u32_u24 v15, 1280, v15
v_lshl_add_u32 v250, v16, 4, v15
s_waitcnt vmcnt(3) lgkmcnt(0)
s_cmp_ge_u32 s11, 3
s_cbranch_scc1 kx_3
s_mul_i32 s20, s11, 13056
s_add_u32 s21, s20, 78400
s_add_u32 s22, s20, 74240
v_and_b32 v170, 31, v1
v_lshrrev_b32 v171, 5, v1
v_cmp_gt_u32 vcc, 32, v1
v_lshlrev_b32 v172, 4, v170
v_lshl_add_u32 v172, v171, 3, v172
v_add_u32 v172, s21, v172
v_lshlrev_b32 v173, 3, v170
v_add_u32 v173, 512, v173
v_lshlrev_b32 v174, 2, v170
v_add_u32 v174, 768, v174
v_cndmask_b32 v173, v174, v173, vcc
v_add_u32 v173, s21, v173
v_mov_b32 v174, 0x80
v_cndmask_b32 v174, v174, 4, vcc
v_add_u32 v174, v173, v174
v_lshlrev_b32 v175, 1, v170
v_lshl_add_u32 v175, v171, 8, v175
v_add_u32 v175, s21, v175
ds_write_b16 v172, v160 offset:0
ds_write_b16_d16_hi v172, v160 offset:2
ds_write_b16 v172, v161 offset:4
ds_write_b16_d16_hi v172, v161 offset:6
ds_write_b16 v173, v162
ds_write_b16_d16_hi v173, v162 offset:2
ds_write_b16 v174, v163
ds_write_b16_d16_hi v174, v163 offset:2
ds_write_b16 v175, v164 offset:1024
ds_write_b16_d16_hi v175, v164 offset:1088
ds_write_b16 v175, v165 offset:1152
ds_write_b16_d16_hi v175, v165 offset:1216
v_lshlrev_b32 v172, 4, v1
v_lshlrev_b32 v173, 3, v1
v_add_u32 v173, 256, v173
v_cndmask_b32 v172, v173, v172, vcc
v_add_u32 v172, s21, v172
v_cndmask_b32 v178, 0, 0, vcc
v_add_u32 v178, v178, v172
v_cndmask_b32 v179, 0, 2, vcc
v_add_u32 v179, v179, v172
v_cndmask_b32 v180, 2, 4, vcc
v_add_u32 v180, v180, v172
v_cndmask_b32 v181, 4, 6, vcc
v_add_u32 v181, v181, v172
v_cndmask_b32 v182, 4, 8, vcc
v_add_u32 v182, v182, v172
v_cndmask_b32 v183, 4, 10, vcc
v_add_u32 v183, v183, v172
v_cndmask_b32 v184, 6, 12, vcc
v_add_u32 v184, v184, v172
v_cndmask_b32 v185, 8, 14, vcc
v_add_u32 v185, v185, v172
v_lshlrev_b32 v173, 2, v1
v_add_u32 v173, s21, v173
v_lshlrev_b32 v174, 1, v1
v_add_u32 v174, s21, v174
s_waitcnt lgkmcnt(0)
ds_read_u16 v186, v178
ds_read_u16 v187, v179
ds_read_u16 v188, v180
ds_read_u16 v189, v181
ds_read_u16 v190, v182
ds_read_u16 v191, v183
ds_read_u16 v192, v184
ds_read_u16 v193, v185
ds_read_u16 v194, v173 offset:768
ds_read_u16 v195, v173 offset:770
ds_read_u16 v196, v173 offset:772
ds_read_u16 v197, v174 offset:1024
ds_read_u16 v198, v174 offset:1026
ds_read_u16 v199, v174 offset:1152
ds_read_u16 v200, v174 offset:1154
s_mov_b32 s60, 0xaaaaaaaa
s_mov_b32 s61, 0xaaaaaaaa
v_lshlrev_b32 v176, 4, v1
v_sub_u32 v176, 1008, v176
v_add_u32 v176, s22, v176
s_waitcnt lgkmcnt(7)
v_lshl_or_b32 v204, v192, 16, v193
v_lshl_or_b32 v205, v190, 16, v191
v_lshl_or_b32 v206, v188, 16, v189
v_lshl_or_b32 v207, v186, 16, v187
ds_write_b128 v176, v[204:207] offset:3072
s_waitcnt lgkmcnt(5)
v_lshl_or_b32 v208, v196, 16, v196
v_lshl_or_b32 v209, v195, 16, v195
v_lshl_or_b32 v210, v194, 16, v195
v_lshl_or_b32 v211, v194, 16, v194
ds_write_b128 v176, v[208:211] offset:2048
s_waitcnt lgkmcnt(2)
v_cndmask_b32 v177, v197, v198, s[60:61]
v_lshl_or_b32 v212, v198, 16, v198
v_lshl_or_b32 v213, v177, 16, v198
v_lshl_or_b32 v214, v197, 16, v197
v_mov_b32 v215, v214
ds_write_b128 v176, v[212:215] offset:1024
v_cndmask_b32 v177, v199, v200, s[60:61]
v_lshl_or_b32 v216, v200, 16, v200
v_lshl_or_b32 v217, v177, 16, v200
v_lshl_or_b32 v218, v199, 16, v199
v_mov_b32 v219, v218
ds_write_b128 v176, v[216:219] offset:0
kx_3:
s_waitcnt lgkmcnt(0)
s_lshl_b32 s58, s11, 2
s_add_u32 s58, s58, 153856
v_mov_b32 v14, s58
v_mov_b32 v15, 1
ds_write_b32 v14, v15
v_mov_b32 v14, 153856
s_mov_b32 s59, 0
l2_kernel_s1:
ds_read_b128 v[16:19], v14
s_waitcnt lgkmcnt(0)
v_min_u32 v16, v16, v17
v_min_u32 v18, v18, v19
v_min_u32 v16, v16, v18
s_nop 0
v_readfirstlane_b32 s58, v16
s_nop 3
s_cmp_ge_u32 s58, 1
s_cbranch_scc1 l2_kernel_s1_ok
s_add_u32 s59, s59, 1
s_cmp_lt_u32 s59, 0x100000
s_cbranch_scc1 l2_kernel_s1
l2_kernel_s1_ok:
s_lshl_b32 s20, s11, 10
s_add_u32 s20, s20, 69632
v_lshlrev_b32 v14, 4, v1
v_add_u32 v14, s20, v14
ds_read_b128 v[92:95], v14 offset:4608
ds_read_b32 v96, v14 offset:4624
ds_read_b128 v[100:103], v14 offset:17664
ds_read_b32 v104, v14 offset:17680
ds_read_b128 v[108:111], v14 offset:30720
ds_read_b32 v112, v14 offset:30736
s_waitcnt lgkmcnt(4)
v_alignbit_b32 v124, v93, v92, 16
v_alignbit_b32 v125, v94, v93, 16
v_alignbit_b32 v126, v95, v94, 16
v_alignbit_b32 v127, v96, v95, 16
ds_write_b128 v14, v[124:127] offset:8768
s_waitcnt lgkmcnt(3)
v_alignbit_b32 v128, v101, v100, 16
v_alignbit_b32 v129, v102, v101, 16
v_alignbit_b32 v130, v103, v102, 16
v_alignbit_b32 v131, v104, v103, 16
ds_write_b128 v14, v[128:131] offset:21824
s_waitcnt lgkmcnt(2)
v_alignbit_b32 v132, v109, v108, 16
v_alignbit_b32 v133, v110, v109, 16
v_alignbit_b32 v134, v111, v110, 16
v_alignbit_b32 v135, v112, v111, 16
ds_write_b128 v14, v[132:135] offset:34880
s_waitcnt lgkmcnt(0)
s_lshl_b32 s58, s11, 2
s_add_u32 s58, s58, 153856
v_mov_b32 v14, s58
v_mov_b32 v15, 2
ds_write_b32 v14, v15
v_mov_b32 v14, 153856
s_mov_b32 s59, 0
l2_kernel_s2:
ds_read_b128 v[16:19], v14
s_waitcnt lgkmcnt(0)
v_min_u32 v16, v16, v17
v_min_u32 v18, v18, v19
v_min_u32 v16, v16, v18
s_nop 0
v_readfirstlane_b32 s58, v16
s_nop 3
s_cmp_ge_u32 s58, 2
s_cbranch_scc1 l2_kernel_s2_ok
s_add_u32 s59, s59, 1
s_cmp_lt_u32 s59, 0x100000
s_cbranch_scc1 l2_kernel_s2
l2_kernel_s2_ok:
s_cmp_eq_u32 s11, 1
s_cbranch_scc1 l2_kernel_cv_w1
s_cmp_eq_u32 s11, 2
s_cbranch_scc1 l2_kernel_cv_w2
s_cmp_eq_u32 s11, 3
s_cbranch_scc1 l2_kernel_cv_w3
v_add_u32 v4, 0, v2
v_add_u32 v5, 1024, v2
v_add_u32 v6, 2048, v2
v_add_u32 v7, 3072, v2
v_add_u32 v12, 0, v3
ds_read_b128 v[92:95], v12 offset:0
ds_read_b128 v[96:99], v12 offset:512
ds_read_b128 v[100:103], v12 offset:1024
ds_read_b128 v[104:107], v12 offset:1536
ds_read_b128 v[108:111], v12 offset:2048
ds_read_b128 v[112:115], v12 offset:2560
ds_read_b128 v[116:119], v12 offset:3072
ds_read_b128 v[120:123], v12 offset:3584
ds_read2_b32 v[156:157], v7 offset0:128 offset1:129
ds_read2_b32 v[158:159], v7 offset0:130 offset1:131
ds_read2_b32 v[160:161], v7 offset0:0 offset1:1
ds_read2_b32 v[162:163], v7 offset0:2 offset1:3
ds_read2_b32 v[164:165], v6 offset0:128 offset1:129
ds_read2_b32 v[166:167], v6 offset0:130 offset1:131
ds_read2_b32 v[168:169], v6 offset0:0 offset1:1
ds_read2_b32 v[170:171], v6 offset0:2 offset1:3
ds_read2_b32 v[172:173], v5 offset0:128 offset1:129
ds_read2_b32 v[174:175], v5 offset0:130 offset1:131
ds_read2_b32 v[176:177], v5 offset0:0 offset1:1
ds_read2_b32 v[178:179], v5 offset0:2 offset1:3
ds_read2_b32 v[180:181], v4 offset0:128 offset1:129
ds_read2_b32 v[182:183], v4 offset0:130 offset1:131
ds_read2_b32 v[184:185], v4 offset0:0 offset1:1
ds_read2_b32 v[186:187], v4 offset0:2 offset1:3
v_add_u32 v8, 4294967232, v2
v_add_u32 v9, 960, v2
v_add_u32 v10, 1984, v2
v_add_u32 v11, 3008, v2
v_add_u32 v13, 4294967232, v3
s_waitcnt lgkmcnt(14)
v_mfma_f32_16x16x32_bf16 v[28:31], v[156:159], v[92:95], 0
ds_read_b128 v[124:127], v13 offset:0
v_mfma_f32_16x16x32_bf16 v[32:35], v[156:159], v[96:99], 0
ds_read_b128 v[128:131], v13 offset:512
v_mfma_f32_16x16x32_bf16 v[36:39], v[156:159], v[100:103], 0
v_mfma_f32_16x16x32_bf16 v[40:43], v[156:159], v[104:107], 0
v_mfma_f32_16x16x32_bf16 v[44:47], v[156:159], v[108:111], 0
v_mfma_f32_16x16x32_bf16 v[48:51], v[156:159], v[112:115], 0
v_mfma_f32_16x16x32_bf16 v[52:55], v[156:159], v[116:119], 0
v_mfma_f32_16x16x32_bf16 v[56:59], v[156:159], v[120:123], 0
ds_read2_b32 v[156:157], v11 offset0:128 offset1:129
ds_read2_b32 v[158:159], v11 offset0:130 offset1:131
s_waitcnt lgkmcnt(15)
v_mfma_f32_16x16x32_bf16 v[32:35], v[160:163], v[92:95], v[32:35]
ds_read_b128 v[132:135], v13 offset:1024
v_mfma_f32_16x16x32_bf16 v[36:39], v[160:163], v[96:99], v[36:39]
ds_read_b128 v[136:139], v13 offset:1536
v_mfma_f32_16x16x32_bf16 v[40:43], v[160:163], v[100:103], v[40:43]
v_mfma_f32_16x16x32_bf16 v[44:47], v[160:163], v[104:107], v[44:47]
v_mfma_f32_16x16x32_bf16 v[48:51], v[160:163], v[108:111], v[48:51]
v_mfma_f32_16x16x32_bf16 v[52:55], v[160:163], v[112:115], v[52:55]
v_mfma_f32_16x16x32_bf16 v[56:59], v[160:163], v[116:119], v[56:59]
ds_read2_b32 v[160:161], v11 offset0:0 offset1:1
ds_read2_b32 v[162:163], v11 offset0:2 offset1:3
s_waitcnt lgkmcnt(15)
v_mfma_f32_16x16x32_bf16 v[36:39], v[164:167], v[92:95], v[36:39]
ds_read_b128 v[140:143], v13 offset:2048
v_mfma_f32_16x16x32_bf16 v[40:43], v[164:167], v[96:99], v[40:43]
ds_read_b128 v[144:147], v13 offset:2560
v_mfma_f32_16x16x32_bf16 v[44:47], v[164:167], v[100:103], v[44:47]
v_mfma_f32_16x16x32_bf16 v[48:51], v[164:167], v[104:107], v[48:51]
v_mfma_f32_16x16x32_bf16 v[52:55], v[164:167], v[108:111], v[52:55]
v_mfma_f32_16x16x32_bf16 v[56:59], v[164:167], v[112:115], v[56:59]
ds_read2_b32 v[164:165], v10 offset0:128 offset1:129
ds_read2_b32 v[166:167], v10 offset0:130 offset1:131
s_waitcnt lgkmcnt(15)
v_mfma_f32_16x16x32_bf16 v[40:43], v[168:171], v[92:95], v[40:43]
ds_read_b128 v[148:151], v13 offset:3072
v_mfma_f32_16x16x32_bf16 v[44:47], v[168:171], v[96:99], v[44:47]
ds_read_b128 v[152:155], v13 offset:3584
v_mfma_f32_16x16x32_bf16 v[48:51], v[168:171], v[100:103], v[48:51]
v_mfma_f32_16x16x32_bf16 v[52:55], v[168:171], v[104:107], v[52:55]
v_mfma_f32_16x16x32_bf16 v[56:59], v[168:171], v[108:111], v[56:59]
ds_read2_b32 v[168:169], v10 offset0:0 offset1:1
ds_read2_b32 v[170:171], v10 offset0:2 offset1:3
s_waitcnt lgkmcnt(15)
v_mfma_f32_16x16x32_bf16 v[44:47], v[172:175], v[92:95], v[44:47]
v_mfma_f32_16x16x32_bf16 v[48:51], v[172:175], v[96:99], v[48:51]
v_mfma_f32_16x16x32_bf16 v[52:55], v[172:175], v[100:103], v[52:55]
v_mfma_f32_16x16x32_bf16 v[56:59], v[172:175], v[104:107], v[56:59]
ds_read2_b32 v[172:173], v9 offset0:128 offset1:129
ds_read2_b32 v[174:175], v9 offset0:130 offset1:131
s_waitcnt lgkmcnt(15)
v_mfma_f32_16x16x32_bf16 v[48:51], v[176:179], v[92:95], v[48:51]
v_mfma_f32_16x16x32_bf16 v[52:55], v[176:179], v[96:99], v[52:55]
v_mfma_f32_16x16x32_bf16 v[56:59], v[176:179], v[100:103], v[56:59]
ds_read2_b32 v[176:177], v9 offset0:0 offset1:1
ds_read2_b32 v[178:179], v9 offset0:2 offset1:3
s_waitcnt lgkmcnt(15)
v_mfma_f32_16x16x32_bf16 v[52:55], v[180:183], v[92:95], v[52:55]
v_mfma_f32_16x16x32_bf16 v[56:59], v[180:183], v[96:99], v[56:59]
ds_read2_b32 v[180:181], v8 offset0:128 offset1:129
ds_read2_b32 v[182:183], v8 offset0:130 offset1:131
s_waitcnt lgkmcnt(15)
v_mfma_f32_16x16x32_bf16 v[56:59], v[184:187], v[92:95], v[56:59]
ds_read2_b32 v[184:185], v8 offset0:0 offset1:1
ds_read2_b32 v[186:187], v8 offset0:2 offset1:3
v_add_u32 v4, 4294967168, v2
v_add_u32 v5, 896, v2
v_add_u32 v6, 1920, v2
v_add_u32 v7, 2944, v2
v_add_u32 v12, 4294967168, v3
s_waitcnt lgkmcnt(10)
v_mfma_f32_16x16x32_bf16 v[28:31], v[156:159], v[124:127], v[28:31]
ds_read_b128 v[92:95], v12 offset:0
v_mfma_f32_16x16x32_bf16 v[32:35], v[156:159], v[128:131], v[32:35]
ds_read_b128 v[96:99], v12 offset:512
v_mfma_f32_16x16x32_bf16 v[36:39], v[156:159], v[132:135], v[36:39]
v_mfma_f32_16x16x32_bf16 v[40:43], v[156:159], v[136:139], v[40:43]
v_mfma_f32_16x16x32_bf16 v[44:47], v[156:159], v[140:143], v[44:47]
v_mfma_f32_16x16x32_bf16 v[48:51], v[156:159], v[144:147], v[48:51]
v_mfma_f32_16x16x32_bf16 v[52:55], v[156:159], v[148:151], v[52:55]
v_mfma_f32_16x16x32_bf16 v[56:59], v[156:159], v[152:155], v[56:59]
ds_read2_b32 v[156:157], v7 offset0:128 offset1:129
ds_read2_b32 v[158:159], v7 offset0:130 offset1:131
s_waitcnt lgkmcnt(15)
v_mfma_f32_16x16x32_bf16 v[32:35], v[160:163], v[124:127], v[32:35]
ds_read_b128 v[100:103], v12 offset:1024
v_mfma_f32_16x16x32_bf16 v[36:39], v[160:163], v[128:131], v[36:39]
ds_read_b128 v[104:107], v12 offset:1536
v_mfma_f32_16x16x32_bf16 v[40:43], v[160:163], v[132:135], v[40:43]
v_mfma_f32_16x16x32_bf16 v[44:47], v[160:163], v[136:139], v[44:47]
v_mfma_f32_16x16x32_bf16 v[48:51], v[160:163], v[140:143], v[48:51]
v_mfma_f32_16x16x32_bf16 v[52:55], v[160:163], v[144:147], v[52:55]
v_mfma_f32_16x16x32_bf16 v[56:59], v[160:163], v[148:151], v[56:59]
ds_read2_b32 v[160:161], v7 offset0:0 offset1:1
ds_read2_b32 v[162:163], v7 offset0:2 offset1:3
s_waitcnt lgkmcnt(15)
v_mfma_f32_16x16x32_bf16 v[36:39], v[164:167], v[124:127], v[36:39]
ds_read_b128 v[108:111], v12 offset:2048
v_mfma_f32_16x16x32_bf16 v[40:43], v[164:167], v[128:131], v[40:43]
ds_read_b128 v[112:115], v12 offset:2560
v_mfma_f32_16x16x32_bf16 v[44:47], v[164:167], v[132:135], v[44:47]
v_mfma_f32_16x16x32_bf16 v[48:51], v[164:167], v[136:139], v[48:51]
v_mfma_f32_16x16x32_bf16 v[52:55], v[164:167], v[140:143], v[52:55]
v_mfma_f32_16x16x32_bf16 v[56:59], v[164:167], v[144:147], v[56:59]
ds_read2_b32 v[164:165], v6 offset0:128 offset1:129
ds_read2_b32 v[166:167], v6 offset0:130 offset1:131
s_waitcnt lgkmcnt(15)
v_mfma_f32_16x16x32_bf16 v[40:43], v[168:171], v[124:127], v[40:43]
ds_read_b128 v[116:119], v12 offset:3072
v_mfma_f32_16x16x32_bf16 v[44:47], v[168:171], v[128:131], v[44:47]
ds_read_b128 v[120:123], v12 offset:3584
v_mfma_f32_16x16x32_bf16 v[48:51], v[168:171], v[132:135], v[48:51]
v_mfma_f32_16x16x32_bf16 v[52:55], v[168:171], v[136:139], v[52:55]
v_mfma_f32_16x16x32_bf16 v[56:59], v[168:171], v[140:143], v[56:59]
ds_read2_b32 v[168:169], v6 offset0:0 offset1:1
ds_read2_b32 v[170:171], v6 offset0:2 offset1:3
s_waitcnt lgkmcnt(15)
v_mfma_f32_16x16x32_bf16 v[44:47], v[172:175], v[124:127], v[44:47]
v_mfma_f32_16x16x32_bf16 v[48:51], v[172:175], v[128:131], v[48:51]
v_mfma_f32_16x16x32_bf16 v[52:55], v[172:175], v[132:135], v[52:55]
v_mfma_f32_16x16x32_bf16 v[56:59], v[172:175], v[136:139], v[56:59]
ds_read2_b32 v[172:173], v5 offset0:128 offset1:129
ds_read2_b32 v[174:175], v5 offset0:130 offset1:131
s_waitcnt lgkmcnt(15)
v_mfma_f32_16x16x32_bf16 v[48:51], v[176:179], v[124:127], v[48:51]
v_mfma_f32_16x16x32_bf16 v[52:55], v[176:179], v[128:131], v[52:55]
v_mfma_f32_16x16x32_bf16 v[56:59], v[176:179], v[132:135], v[56:59]
ds_read2_b32 v[176:177], v5 offset0:0 offset1:1
ds_read2_b32 v[178:179], v5 offset0:2 offset1:3
s_waitcnt lgkmcnt(15)
v_mfma_f32_16x16x32_bf16 v[52:55], v[180:183], v[124:127], v[52:55]
v_mfma_f32_16x16x32_bf16 v[56:59], v[180:183], v[128:131], v[56:59]
ds_read2_b32 v[180:181], v4 offset0:128 offset1:129
ds_read2_b32 v[182:183], v4 offset0:130 offset1:131
s_waitcnt lgkmcnt(15)
v_mfma_f32_16x16x32_bf16 v[56:59], v[184:187], v[124:127], v[56:59]
ds_read2_b32 v[184:185], v4 offset0:0 offset1:1
ds_read2_b32 v[186:187], v4 offset0:2 offset1:3
v_add_u32 v8, 4294967104, v2
v_add_u32 v9, 832, v2
v_add_u32 v10, 1856, v2
v_add_u32 v11, 2880, v2
v_add_u32 v13, 4294967104, v3
s_waitcnt lgkmcnt(10)
v_mfma_f32_16x16x32_bf16 v[28:31], v[156:159], v[92:95], v[28:31]
ds_read_b128 v[124:127], v13 offset:0
v_mfma_f32_16x16x32_bf16 v[32:35], v[156:159], v[96:99], v[32:35]
ds_read_b128 v[128:131], v13 offset:512
v_mfma_f32_16x16x32_bf16 v[36:39], v[156:159], v[100:103], v[36:39]
v_mfma_f32_16x16x32_bf16 v[40:43], v[156:159], v[104:107], v[40:43]
v_mfma_f32_16x16x32_bf16 v[44:47], v[156:159], v[108:111], v[44:47]
v_mfma_f32_16x16x32_bf16 v[48:51], v[156:159], v[112:115], v[48:51]
v_mfma_f32_16x16x32_bf16 v[52:55], v[156:159], v[116:119], v[52:55]
v_mfma_f32_16x16x32_bf16 v[56:59], v[156:159], v[120:123], v[56:59]
ds_read2_b32 v[156:157], v11 offset0:128 offset1:129
ds_read2_b32 v[158:159], v11 offset0:130 offset1:131
s_waitcnt lgkmcnt(15)
v_mfma_f32_16x16x32_bf16 v[32:35], v[160:163], v[92:95], v[32:35]
ds_read_b128 v[132:135], v13 offset:1024
v_mfma_f32_16x16x32_bf16 v[36:39], v[160:163], v[96:99], v[36:39]
ds_read_b128 v[136:139], v13 offset:1536
v_mfma_f32_16x16x32_bf16 v[40:43], v[160:163], v[100:103], v[40:43]
v_mfma_f32_16x16x32_bf16 v[44:47], v[160:163], v[104:107], v[44:47]
v_mfma_f32_16x16x32_bf16 v[48:51], v[160:163], v[108:111], v[48:51]
v_mfma_f32_16x16x32_bf16 v[52:55], v[160:163], v[112:115], v[52:55]
v_mfma_f32_16x16x32_bf16 v[56:59], v[160:163], v[116:119], v[56:59]
ds_read2_b32 v[160:161], v11 offset0:0 offset1:1
ds_read2_b32 v[162:163], v11 offset0:2 offset1:3
s_waitcnt lgkmcnt(15)
v_mfma_f32_16x16x32_bf16 v[36:39], v[164:167], v[92:95], v[36:39]
ds_read_b128 v[140:143], v13 offset:2048
v_mfma_f32_16x16x32_bf16 v[40:43], v[164:167], v[96:99], v[40:43]
ds_read_b128 v[144:147], v13 offset:2560
v_mfma_f32_16x16x32_bf16 v[44:47], v[164:167], v[100:103], v[44:47]
v_mfma_f32_16x16x32_bf16 v[48:51], v[164:167], v[104:107], v[48:51]
v_mfma_f32_16x16x32_bf16 v[52:55], v[164:167], v[108:111], v[52:55]
v_mfma_f32_16x16x32_bf16 v[56:59], v[164:167], v[112:115], v[56:59]
ds_read2_b32 v[164:165], v10 offset0:128 offset1:129
ds_read2_b32 v[166:167], v10 offset0:130 offset1:131
s_waitcnt lgkmcnt(15)
v_mfma_f32_16x16x32_bf16 v[40:43], v[168:171], v[92:95], v[40:43]
ds_read_b128 v[148:151], v13 offset:3072
v_mfma_f32_16x16x32_bf16 v[44:47], v[168:171], v[96:99], v[44:47]
ds_read_b128 v[152:155], v13 offset:3584
v_mfma_f32_16x16x32_bf16 v[48:51], v[168:171], v[100:103], v[48:51]
v_mfma_f32_16x16x32_bf16 v[52:55], v[168:171], v[104:107], v[52:55]
v_mfma_f32_16x16x32_bf16 v[56:59], v[168:171], v[108:111], v[56:59]
ds_read2_b32 v[168:169], v10 offset0:0 offset1:1
ds_read2_b32 v[170:171], v10 offset0:2 offset1:3
s_waitcnt lgkmcnt(15)
v_mfma_f32_16x16x32_bf16 v[44:47], v[172:175], v[92:95], v[44:47]
v_mfma_f32_16x16x32_bf16 v[48:51], v[172:175], v[96:99], v[48:51]
v_mfma_f32_16x16x32_bf16 v[52:55], v[172:175], v[100:103], v[52:55]
v_mfma_f32_16x16x32_bf16 v[56:59], v[172:175], v[104:107], v[56:59]
ds_read2_b32 v[172:173], v9 offset0:128 offset1:129
ds_read2_b32 v[174:175], v9 offset0:130 offset1:131
s_waitcnt lgkmcnt(15)
v_mfma_f32_16x16x32_bf16 v[48:51], v[176:179], v[92:95], v[48:51]
v_mfma_f32_16x16x32_bf16 v[52:55], v[176:179], v[96:99], v[52:55]
v_mfma_f32_16x16x32_bf16 v[56:59], v[176:179], v[100:103], v[56:59]
ds_read2_b32 v[176:177], v9 offset0:0 offset1:1
ds_read2_b32 v[178:179], v9 offset0:2 offset1:3
s_waitcnt lgkmcnt(15)
v_mfma_f32_16x16x32_bf16 v[52:55], v[180:183], v[92:95], v[52:55]
v_mfma_f32_16x16x32_bf16 v[56:59], v[180:183], v[96:99], v[56:59]
ds_read2_b32 v[180:181], v8 offset0:128 offset1:129
ds_read2_b32 v[182:183], v8 offset0:130 offset1:131
s_waitcnt lgkmcnt(15)
v_mfma_f32_16x16x32_bf16 v[56:59], v[184:187], v[92:95], v[56:59]
ds_read2_b32 v[184:185], v8 offset0:0 offset1:1
ds_read2_b32 v[186:187], v8 offset0:2 offset1:3
v_add_u32 v4, 4294967040, v2
v_add_u32 v5, 768, v2
v_add_u32 v6, 1792, v2
v_add_u32 v7, 2816, v2
v_add_u32 v12, 4294967040, v3
s_waitcnt lgkmcnt(10)
v_mfma_f32_16x16x32_bf16 v[28:31], v[156:159], v[124:127], v[28:31]
ds_read_b128 v[92:95], v12 offset:0
v_mfma_f32_16x16x32_bf16 v[32:35], v[156:159], v[128:131], v[32:35]
ds_read_b128 v[96:99], v12 offset:512
v_mfma_f32_16x16x32_bf16 v[36:39], v[156:159], v[132:135], v[36:39]
v_mfma_f32_16x16x32_bf16 v[40:43], v[156:159], v[136:139], v[40:43]
v_mfma_f32_16x16x32_bf16 v[44:47], v[156:159], v[140:143], v[44:47]
v_mfma_f32_16x16x32_bf16 v[48:51], v[156:159], v[144:147], v[48:51]
v_mfma_f32_16x16x32_bf16 v[52:55], v[156:159], v[148:151], v[52:55]
v_mfma_f32_16x16x32_bf16 v[56:59], v[156:159], v[152:155], v[56:59]
ds_read2_b32 v[156:157], v7 offset0:128 offset1:129
ds_read2_b32 v[158:159], v7 offset0:130 offset1:131
s_waitcnt lgkmcnt(15)
v_mfma_f32_16x16x32_bf16 v[32:35], v[160:163], v[124:127], v[32:35]
ds_read_b128 v[100:103], v12 offset:1024
v_mfma_f32_16x16x32_bf16 v[36:39], v[160:163], v[128:131], v[36:39]
ds_read_b128 v[104:107], v12 offset:1536
v_mfma_f32_16x16x32_bf16 v[40:43], v[160:163], v[132:135], v[40:43]
v_mfma_f32_16x16x32_bf16 v[44:47], v[160:163], v[136:139], v[44:47]
v_mfma_f32_16x16x32_bf16 v[48:51], v[160:163], v[140:143], v[48:51]
v_mfma_f32_16x16x32_bf16 v[52:55], v[160:163], v[144:147], v[52:55]
v_mfma_f32_16x16x32_bf16 v[56:59], v[160:163], v[148:151], v[56:59]
ds_read2_b32 v[160:161], v7 offset0:0 offset1:1
ds_read2_b32 v[162:163], v7 offset0:2 offset1:3
s_waitcnt lgkmcnt(15)
v_mfma_f32_16x16x32_bf16 v[36:39], v[164:167], v[124:127], v[36:39]
ds_read_b128 v[108:111], v12 offset:2048
v_mfma_f32_16x16x32_bf16 v[40:43], v[164:167], v[128:131], v[40:43]
ds_read_b128 v[112:115], v12 offset:2560
v_mfma_f32_16x16x32_bf16 v[44:47], v[164:167], v[132:135], v[44:47]
v_mfma_f32_16x16x32_bf16 v[48:51], v[164:167], v[136:139], v[48:51]
v_mfma_f32_16x16x32_bf16 v[52:55], v[164:167], v[140:143], v[52:55]
v_mfma_f32_16x16x32_bf16 v[56:59], v[164:167], v[144:147], v[56:59]
ds_read2_b32 v[164:165], v6 offset0:128 offset1:129
ds_read2_b32 v[166:167], v6 offset0:130 offset1:131
s_waitcnt lgkmcnt(15)
v_mfma_f32_16x16x32_bf16 v[40:43], v[168:171], v[124:127], v[40:43]
ds_read_b128 v[116:119], v12 offset:3072
v_mfma_f32_16x16x32_bf16 v[44:47], v[168:171], v[128:131], v[44:47]
ds_read_b128 v[120:123], v12 offset:3584
v_mfma_f32_16x16x32_bf16 v[48:51], v[168:171], v[132:135], v[48:51]
v_mfma_f32_16x16x32_bf16 v[52:55], v[168:171], v[136:139], v[52:55]
v_mfma_f32_16x16x32_bf16 v[56:59], v[168:171], v[140:143], v[56:59]
ds_read2_b32 v[168:169], v6 offset0:0 offset1:1
ds_read2_b32 v[170:171], v6 offset0:2 offset1:3
s_waitcnt lgkmcnt(15)
v_mfma_f32_16x16x32_bf16 v[44:47], v[172:175], v[124:127], v[44:47]
v_mfma_f32_16x16x32_bf16 v[48:51], v[172:175], v[128:131], v[48:51]
v_mfma_f32_16x16x32_bf16 v[52:55], v[172:175], v[132:135], v[52:55]
v_mfma_f32_16x16x32_bf16 v[56:59], v[172:175], v[136:139], v[56:59]
ds_read2_b32 v[172:173], v5 offset0:128 offset1:129
ds_read2_b32 v[174:175], v5 offset0:130 offset1:131
s_waitcnt lgkmcnt(15)
v_mfma_f32_16x16x32_bf16 v[48:51], v[176:179], v[124:127], v[48:51]
v_mfma_f32_16x16x32_bf16 v[52:55], v[176:179], v[128:131], v[52:55]
v_mfma_f32_16x16x32_bf16 v[56:59], v[176:179], v[132:135], v[56:59]
ds_read2_b32 v[176:177], v5 offset0:0 offset1:1
ds_read2_b32 v[178:179], v5 offset0:2 offset1:3
s_waitcnt lgkmcnt(15)
v_mfma_f32_16x16x32_bf16 v[52:55], v[180:183], v[124:127], v[52:55]
v_mfma_f32_16x16x32_bf16 v[56:59], v[180:183], v[128:131], v[56:59]
ds_read2_b32 v[180:181], v4 offset0:128 offset1:129
ds_read2_b32 v[182:183], v4 offset0:130 offset1:131
s_waitcnt lgkmcnt(15)
v_mfma_f32_16x16x32_bf16 v[56:59], v[184:187], v[124:127], v[56:59]
ds_read2_b32 v[184:185], v4 offset0:0 offset1:1
ds_read2_b32 v[186:187], v4 offset0:2 offset1:3
s_waitcnt lgkmcnt(10)
v_mfma_f32_16x16x32_bf16 v[28:31], v[156:159], v[92:95], v[28:31]
v_mfma_f32_16x16x32_bf16 v[32:35], v[156:159], v[96:99], v[32:35]
v_mfma_f32_16x16x32_bf16 v[36:39], v[156:159], v[100:103], v[36:39]
v_mfma_f32_16x16x32_bf16 v[40:43], v[156:159], v[104:107], v[40:43]
v_mfma_f32_16x16x32_bf16 v[44:47], v[156:159], v[108:111], v[44:47]
v_mfma_f32_16x16x32_bf16 v[48:51], v[156:159], v[112:115], v[48:51]
v_mfma_f32_16x16x32_bf16 v[52:55], v[156:159], v[116:119], v[52:55]
v_mfma_f32_16x16x32_bf16 v[56:59], v[156:159], v[120:123], v[56:59]
s_waitcnt lgkmcnt(11)
v_mfma_f32_16x16x32_bf16 v[32:35], v[160:163], v[92:95], v[32:35]
v_mfma_f32_16x16x32_bf16 v[36:39], v[160:163], v[96:99], v[36:39]
v_mfma_f32_16x16x32_bf16 v[40:43], v[160:163], v[100:103], v[40:43]
v_mfma_f32_16x16x32_bf16 v[44:47], v[160:163], v[104:107], v[44:47]
v_mfma_f32_16x16x32_bf16 v[48:51], v[160:163], v[108:111], v[48:51]
v_mfma_f32_16x16x32_bf16 v[52:55], v[160:163], v[112:115], v[52:55]
v_mfma_f32_16x16x32_bf16 v[56:59], v[160:163], v[116:119], v[56:59]
s_waitcnt lgkmcnt(12)
v_mfma_f32_16x16x32_bf16 v[36:39], v[164:167], v[92:95], v[36:39]
v_mfma_f32_16x16x32_bf16 v[40:43], v[164:167], v[96:99], v[40:43]
v_mfma_f32_16x16x32_bf16 v[44:47], v[164:167], v[100:103], v[44:47]
v_mfma_f32_16x16x32_bf16 v[48:51], v[164:167], v[104:107], v[48:51]
v_mfma_f32_16x16x32_bf16 v[52:55], v[164:167], v[108:111], v[52:55]
v_mfma_f32_16x16x32_bf16 v[56:59], v[164:167], v[112:115], v[56:59]
s_waitcnt lgkmcnt(8)
v_mfma_f32_16x16x32_bf16 v[40:43], v[168:171], v[92:95], v[40:43]
v_mfma_f32_16x16x32_bf16 v[44:47], v[168:171], v[96:99], v[44:47]
v_mfma_f32_16x16x32_bf16 v[48:51], v[168:171], v[100:103], v[48:51]
v_mfma_f32_16x16x32_bf16 v[52:55], v[168:171], v[104:107], v[52:55]
v_mfma_f32_16x16x32_bf16 v[56:59], v[168:171], v[108:111], v[56:59]
s_waitcnt lgkmcnt(6)
v_mfma_f32_16x16x32_bf16 v[44:47], v[172:175], v[92:95], v[44:47]
v_mfma_f32_16x16x32_bf16 v[48:51], v[172:175], v[96:99], v[48:51]
v_mfma_f32_16x16x32_bf16 v[52:55], v[172:175], v[100:103], v[52:55]
v_mfma_f32_16x16x32_bf16 v[56:59], v[172:175], v[104:107], v[56:59]
s_waitcnt lgkmcnt(4)
v_mfma_f32_16x16x32_bf16 v[48:51], v[176:179], v[92:95], v[48:51]
v_mfma_f32_16x16x32_bf16 v[52:55], v[176:179], v[96:99], v[52:55]
v_mfma_f32_16x16x32_bf16 v[56:59], v[176:179], v[100:103], v[56:59]
s_waitcnt lgkmcnt(2)
v_mfma_f32_16x16x32_bf16 v[52:55], v[180:183], v[92:95], v[52:55]
v_mfma_f32_16x16x32_bf16 v[56:59], v[180:183], v[96:99], v[56:59]
s_waitcnt lgkmcnt(0)
v_mfma_f32_16x16x32_bf16 v[56:59], v[184:187], v[92:95], v[56:59]
s_waitcnt vmcnt(0)
v_lshlrev_b32 v244, 16, v244
v_lshlrev_b32 v245, 16, v245
v_lshlrev_b32 v246, 16, v246
v_mov_b32 v14, 153860
s_mov_b32 s59, 0
l2_kernel_p0:
ds_read_b32 v15, v14
s_waitcnt lgkmcnt(0)
v_readfirstlane_b32 s58, v15
s_nop 3
s_cmp_ge_u32 s58, 3
s_cbranch_scc1 l2_kernel_p0_ok
s_add_u32 s59, s59, 1
s_cmp_lt_u32 s59, 0x100000
s_cbranch_scc1 l2_kernel_p0
l2_kernel_p0_ok:
v_lshlrev_b32 v14, 4, v1
v_add_u32 v15, 108800, v14
ds_read_b128 v[92:95], v15 offset:0
ds_read_b128 v[96:99], v15 offset:1024
ds_read_b128 v[100:103], v15 offset:2048
ds_read_b128 v[104:107], v15 offset:3072
ds_read_b128 v[108:111], v15 offset:4096
ds_read_b128 v[112:115], v15 offset:5120
ds_read_b128 v[116:119], v15 offset:6144
ds_read_b128 v[120:123], v15 offset:7168
v_and_b32 v16, 15, v1
v_lshrrev_b32 v17, 4, v1
v_lshlrev_b32 v18, 5, v16
v_lshl_add_u32 v19, v17, 3, v18
v_add_u32 v19, 70144, v19
ds_read_b64 v[156:157], v19 offset:0
ds_read_b64 v[158:159], v19 offset:512
ds_read_b64 v[160:161], v19 offset:1024
ds_read_b64 v[162:163], v19 offset:1536
ds_read_b64 v[164:165], v19 offset:2048
ds_read_b64 v[166:167], v19 offset:2560
ds_read_b64 v[168:169], v19 offset:3072
ds_read_b64 v[170:171], v19 offset:3584
v_lshrrev_b32 v20, 1, v17
v_lshl_add_u32 v20, v20, 4, v18
v_and_b32 v21, 1, v17
v_mul_u32_u24 v22, 512, v21
v_add_u32 v22, v22, v20
s_lshl_b32 s20, s8, 12
s_add_u32 s20, s20, 14745600
s_waitcnt lgkmcnt(0)
v_add_f32 v28, v28, v92
v_add_f32 v29, v29, v93
v_add_f32 v30, v30, v94
v_add_f32 v31, v31, v95
v_add_f32 v32, v32, v96
v_add_f32 v33, v33, v97
v_add_f32 v34, v34, v98
v_add_f32 v35, v35, v99
v_add_f32 v36, v36, v100
v_add_f32 v37, v37, v101
v_add_f32 v38, v38, v102
v_add_f32 v39, v39, v103
v_add_f32 v40, v40, v104
v_add_f32 v41, v41, v105
v_add_f32 v42, v42, v106
v_add_f32 v43, v43, v107
v_add_f32 v44, v44, v108
v_add_f32 v45, v45, v109
v_add_f32 v46, v46, v110
v_add_f32 v47, v47, v111
v_add_f32 v48, v48, v112
v_add_f32 v49, v49, v113
v_add_f32 v50, v50, v114
v_add_f32 v51, v51, v115
v_add_f32 v52, v52, v116
v_add_f32 v53, v53, v117
v_add_f32 v54, v54, v118
v_add_f32 v55, v55, v119
v_add_f32 v56, v56, v120
v_add_f32 v57, v57, v121
v_add_f32 v58, v58, v122
v_add_f32 v59, v59, v123
v_lshlrev_b32 v196, 16, v156
v_and_b32 v197, 0xffff0000, v156
v_lshlrev_b32 v198, 16, v157
v_and_b32 v199, 0xffff0000, v157
v_fma_f32 v28, v196, v244, v28
v_fma_f32 v29, v197, v244, v29
v_fma_f32 v30, v198, v244, v30
v_fma_f32 v31, v199, v244, v31
v_cvt_pk_bf16_f32 v188, v28, v29
v_cvt_pk_bf16_f32 v189, v30, v31
v_lshlrev_b32 v200, 16, v158
v_and_b32 v201, 0xffff0000, v158
v_lshlrev_b32 v202, 16, v159
v_and_b32 v203, 0xffff0000, v159
v_fma_f32 v32, v200, v244, v32
v_fma_f32 v33, v201, v244, v33
v_fma_f32 v34, v202, v244, v34
v_fma_f32 v35, v203, v244, v35
v_cvt_pk_bf16_f32 v190, v32, v33
v_cvt_pk_bf16_f32 v191, v34, v35
s_nop 0
v_permlane16_swap_b32 v188, v190
v_permlane16_swap_b32 v189, v191
buffer_store_dwordx4 v[188:191], v22, s[32:35], s20 offen offset:0 sc0 sc1
v_lshlrev_b32 v196, 16, v160
v_and_b32 v197, 0xffff0000, v160
v_lshlrev_b32 v198, 16, v161
v_and_b32 v199, 0xffff0000, v161
v_fma_f32 v36, v196, v244, v36
v_fma_f32 v37, v197, v244, v37
v_fma_f32 v38, v198, v244, v38
v_fma_f32 v39, v199, v244, v39
v_cvt_pk_bf16_f32 v192, v36, v37
v_cvt_pk_bf16_f32 v193, v38, v39
v_lshlrev_b32 v200, 16, v162
v_and_b32 v201, 0xffff0000, v162
v_lshlrev_b32 v202, 16, v163
v_and_b32 v203, 0xffff0000, v163
v_fma_f32 v40, v200, v244, v40
v_fma_f32 v41, v201, v244, v41
v_fma_f32 v42, v202, v244, v42
v_fma_f32 v43, v203, v244, v43
v_cvt_pk_bf16_f32 v194, v40, v41
v_cvt_pk_bf16_f32 v195, v42, v43
s_nop 0
v_permlane16_swap_b32 v192, v194
v_permlane16_swap_b32 v193, v195
buffer_store_dwordx4 v[192:195], v22, s[32:35], s20 offen offset:1024 sc0 sc1
v_lshlrev_b32 v196, 16, v164
v_and_b32 v197, 0xffff0000, v164
v_lshlrev_b32 v198, 16, v165
v_and_b32 v199, 0xffff0000, v165
v_fma_f32 v44, v196, v244, v44
v_fma_f32 v45, v197, v244, v45
v_fma_f32 v46, v198, v244, v46
v_fma_f32 v47, v199, v244, v47
v_cvt_pk_bf16_f32 v188, v44, v45
v_cvt_pk_bf16_f32 v189, v46, v47
v_lshlrev_b32 v200, 16, v166
v_and_b32 v201, 0xffff0000, v166
v_lshlrev_b32 v202, 16, v167
v_and_b32 v203, 0xffff0000, v167
v_fma_f32 v48, v200, v244, v48
v_fma_f32 v49, v201, v244, v49
v_fma_f32 v50, v202, v244, v50
v_fma_f32 v51, v203, v244, v51
v_cvt_pk_bf16_f32 v190, v48, v49
v_cvt_pk_bf16_f32 v191, v50, v51
s_nop 0
v_permlane16_swap_b32 v188, v190
v_permlane16_swap_b32 v189, v191
buffer_store_dwordx4 v[188:191], v22, s[32:35], s20 offen offset:2048 sc0 sc1
v_lshlrev_b32 v196, 16, v168
v_and_b32 v197, 0xffff0000, v168
v_lshlrev_b32 v198, 16, v169
v_and_b32 v199, 0xffff0000, v169
v_fma_f32 v52, v196, v244, v52
v_fma_f32 v53, v197, v244, v53
v_fma_f32 v54, v198, v244, v54
v_fma_f32 v55, v199, v244, v55
v_cvt_pk_bf16_f32 v192, v52, v53
v_cvt_pk_bf16_f32 v193, v54, v55
v_lshlrev_b32 v200, 16, v170
v_and_b32 v201, 0xffff0000, v170
v_lshlrev_b32 v202, 16, v171
v_and_b32 v203, 0xffff0000, v171
v_fma_f32 v56, v200, v244, v56
v_fma_f32 v57, v201, v244, v57
v_fma_f32 v58, v202, v244, v58
v_fma_f32 v59, v203, v244, v59
v_cvt_pk_bf16_f32 v194, v56, v57
v_cvt_pk_bf16_f32 v195, v58, v59
s_nop 0
v_permlane16_swap_b32 v192, v194
v_permlane16_swap_b32 v193, v195
buffer_store_dwordx4 v[192:195], v22, s[32:35], s20 offen offset:3072 sc0 sc1
s_branch l2_kernel_cv_cend
l2_kernel_cv_w1:
v_add_u32 v4, 4294966976, v2
v_add_u32 v5, 704, v2
v_add_u32 v6, 1728, v2
v_add_u32 v7, 2752, v2
v_add_u32 v12, 4294966976, v3
ds_read_b128 v[92:95], v12 offset:0
ds_read_b128 v[96:99], v12 offset:512
ds_read_b128 v[100:103], v12 offset:1024
ds_read_b128 v[104:107], v12 offset:1536
ds_read_b128 v[108:111], v12 offset:2048
ds_read_b128 v[112:115], v12 offset:2560
ds_read_b128 v[116:119], v12 offset:3072
ds_read_b128 v[120:123], v12 offset:3584
ds_read2_b32 v[156:157], v7 offset0:128 offset1:129
ds_read2_b32 v[158:159], v7 offset0:130 offset1:131
ds_read2_b32 v[160:161], v7 offset0:0 offset1:1
ds_read2_b32 v[162:163], v7 offset0:2 offset1:3
ds_read2_b32 v[164:165], v6 offset0:128 offset1:129
ds_read2_b32 v[166:167], v6 offset0:130 offset1:131
ds_read2_b32 v[168:169], v6 offset0:0 offset1:1
ds_read2_b32 v[170:171], v6 offset0:2 offset1:3
ds_read2_b32 v[172:173], v5 offset0:128 offset1:129
ds_read2_b32 v[174:175], v5 offset0:130 offset1:131
ds_read2_b32 v[176:177], v5 offset0:0 offset1:1
ds_read2_b32 v[178:179], v5 offset0:2 offset1:3
ds_read2_b32 v[180:181], v4 offset0:128 offset1:129
ds_read2_b32 v[182:183], v4 offset0:130 offset1:131
ds_read2_b32 v[184:185], v4 offset0:0 offset1:1
ds_read2_b32 v[186:187], v4 offset0:2 offset1:3
v_add_u32 v8, 4294966912, v2
v_add_u32 v9, 640, v2
v_add_u32 v10, 1664, v2
v_add_u32 v11, 2688, v2
v_add_u32 v13, 4294966912, v3
s_waitcnt lgkmcnt(14)
v_mfma_f32_16x16x32_bf16 v[28:31], v[156:159], v[92:95], 0
ds_read_b128 v[124:127], v13 offset:0
v_mfma_f32_16x16x32_bf16 v[32:35], v[156:159], v[96:99], 0
ds_read_b128 v[128:131], v13 offset:512
v_mfma_f32_16x16x32_bf16 v[36:39], v[156:159], v[100:103], 0
v_mfma_f32_16x16x32_bf16 v[40:43], v[156:159], v[104:107], 0
v_mfma_f32_16x16x32_bf16 v[44:47], v[156:159], v[108:111], 0
v_mfma_f32_16x16x32_bf16 v[48:51], v[156:159], v[112:115], 0
v_mfma_f32_16x16x32_bf16 v[52:55], v[156:159], v[116:119], 0
v_mfma_f32_16x16x32_bf16 v[56:59], v[156:159], v[120:123], 0
ds_read2_b32 v[156:157], v11 offset0:128 offset1:129
ds_read2_b32 v[158:159], v11 offset0:130 offset1:131
s_waitcnt lgkmcnt(15)
v_mfma_f32_16x16x32_bf16 v[32:35], v[160:163], v[92:95], v[32:35]
ds_read_b128 v[132:135], v13 offset:1024
v_mfma_f32_16x16x32_bf16 v[36:39], v[160:163], v[96:99], v[36:39]
ds_read_b128 v[136:139], v13 offset:1536
v_mfma_f32_16x16x32_bf16 v[40:43], v[160:163], v[100:103], v[40:43]
v_mfma_f32_16x16x32_bf16 v[44:47], v[160:163], v[104:107], v[44:47]
v_mfma_f32_16x16x32_bf16 v[48:51], v[160:163], v[108:111], v[48:51]
v_mfma_f32_16x16x32_bf16 v[52:55], v[160:163], v[112:115], v[52:55]
v_mfma_f32_16x16x32_bf16 v[56:59], v[160:163], v[116:119], v[56:59]
ds_read2_b32 v[160:161], v11 offset0:0 offset1:1
ds_read2_b32 v[162:163], v11 offset0:2 offset1:3
s_waitcnt lgkmcnt(15)
v_mfma_f32_16x16x32_bf16 v[36:39], v[164:167], v[92:95], v[36:39]
ds_read_b128 v[140:143], v13 offset:2048
v_mfma_f32_16x16x32_bf16 v[40:43], v[164:167], v[96:99], v[40:43]
ds_read_b128 v[144:147], v13 offset:2560
v_mfma_f32_16x16x32_bf16 v[44:47], v[164:167], v[100:103], v[44:47]
v_mfma_f32_16x16x32_bf16 v[48:51], v[164:167], v[104:107], v[48:51]
v_mfma_f32_16x16x32_bf16 v[52:55], v[164:167], v[108:111], v[52:55]
v_mfma_f32_16x16x32_bf16 v[56:59], v[164:167], v[112:115], v[56:59]
ds_read2_b32 v[164:165], v10 offset0:128 offset1:129
ds_read2_b32 v[166:167], v10 offset0:130 offset1:131
s_waitcnt lgkmcnt(15)
v_mfma_f32_16x16x32_bf16 v[40:43], v[168:171], v[92:95], v[40:43]
ds_read_b128 v[148:151], v13 offset:3072
v_mfma_f32_16x16x32_bf16 v[44:47], v[168:171], v[96:99], v[44:47]
ds_read_b128 v[152:155], v13 offset:3584
v_mfma_f32_16x16x32_bf16 v[48:51], v[168:171], v[100:103], v[48:51]
v_mfma_f32_16x16x32_bf16 v[52:55], v[168:171], v[104:107], v[52:55]
v_mfma_f32_16x16x32_bf16 v[56:59], v[168:171], v[108:111], v[56:59]
ds_read2_b32 v[168:169], v10 offset0:0 offset1:1
ds_read2_b32 v[170:171], v10 offset0:2 offset1:3
s_waitcnt lgkmcnt(15)
v_mfma_f32_16x16x32_bf16 v[44:47], v[172:175], v[92:95], v[44:47]
v_mfma_f32_16x16x32_bf16 v[48:51], v[172:175], v[96:99], v[48:51]
v_mfma_f32_16x16x32_bf16 v[52:55], v[172:175], v[100:103], v[52:55]
v_mfma_f32_16x16x32_bf16 v[56:59], v[172:175], v[104:107], v[56:59]
ds_read2_b32 v[172:173], v9 offset0:128 offset1:129
ds_read2_b32 v[174:175], v9 offset0:130 offset1:131
s_waitcnt lgkmcnt(15)
v_mfma_f32_16x16x32_bf16 v[48:51], v[176:179], v[92:95], v[48:51]
v_mfma_f32_16x16x32_bf16 v[52:55], v[176:179], v[96:99], v[52:55]
v_mfma_f32_16x16x32_bf16 v[56:59], v[176:179], v[100:103], v[56:59]
ds_read2_b32 v[176:177], v9 offset0:0 offset1:1
ds_read2_b32 v[178:179], v9 offset0:2 offset1:3
s_waitcnt lgkmcnt(15)
v_mfma_f32_16x16x32_bf16 v[52:55], v[180:183], v[92:95], v[52:55]
v_mfma_f32_16x16x32_bf16 v[56:59], v[180:183], v[96:99], v[56:59]
ds_read2_b32 v[180:181], v8 offset0:128 offset1:129
ds_read2_b32 v[182:183], v8 offset0:130 offset1:131
s_waitcnt lgkmcnt(15)
v_mfma_f32_16x16x32_bf16 v[56:59], v[184:187], v[92:95], v[56:59]
ds_read2_b32 v[184:185], v8 offset0:0 offset1:1
ds_read2_b32 v[186:187], v8 offset0:2 offset1:3
v_add_u32 v4, 4294966848, v2
v_add_u32 v5, 576, v2
v_add_u32 v6, 1600, v2
v_add_u32 v7, 2624, v2
v_add_u32 v12, 4294966848, v3
s_waitcnt lgkmcnt(10)
v_mfma_f32_16x16x32_bf16 v[28:31], v[156:159], v[124:127], v[28:31]
ds_read_b128 v[92:95], v12 offset:0
v_mfma_f32_16x16x32_bf16 v[32:35], v[156:159], v[128:131], v[32:35]
ds_read_b128 v[96:99], v12 offset:512
v_mfma_f32_16x16x32_bf16 v[36:39], v[156:159], v[132:135], v[36:39]
v_mfma_f32_16x16x32_bf16 v[40:43], v[156:159], v[136:139], v[40:43]
v_mfma_f32_16x16x32_bf16 v[44:47], v[156:159], v[140:143], v[44:47]
v_mfma_f32_16x16x32_bf16 v[48:51], v[156:159], v[144:147], v[48:51]
v_mfma_f32_16x16x32_bf16 v[52:55], v[156:159], v[148:151], v[52:55]
v_mfma_f32_16x16x32_bf16 v[56:59], v[156:159], v[152:155], v[56:59]
ds_read2_b32 v[156:157], v7 offset0:128 offset1:129
ds_read2_b32 v[158:159], v7 offset0:130 offset1:131
s_waitcnt lgkmcnt(15)
v_mfma_f32_16x16x32_bf16 v[32:35], v[160:163], v[124:127], v[32:35]
ds_read_b128 v[100:103], v12 offset:1024
v_mfma_f32_16x16x32_bf16 v[36:39], v[160:163], v[128:131], v[36:39]
ds_read_b128 v[104:107], v12 offset:1536
v_mfma_f32_16x16x32_bf16 v[40:43], v[160:163], v[132:135], v[40:43]
v_mfma_f32_16x16x32_bf16 v[44:47], v[160:163], v[136:139], v[44:47]
v_mfma_f32_16x16x32_bf16 v[48:51], v[160:163], v[140:143], v[48:51]
v_mfma_f32_16x16x32_bf16 v[52:55], v[160:163], v[144:147], v[52:55]
v_mfma_f32_16x16x32_bf16 v[56:59], v[160:163], v[148:151], v[56:59]
ds_read2_b32 v[160:161], v7 offset0:0 offset1:1
ds_read2_b32 v[162:163], v7 offset0:2 offset1:3
s_waitcnt lgkmcnt(15)
v_mfma_f32_16x16x32_bf16 v[36:39], v[164:167], v[124:127], v[36:39]
ds_read_b128 v[108:111], v12 offset:2048
v_mfma_f32_16x16x32_bf16 v[40:43], v[164:167], v[128:131], v[40:43]
ds_read_b128 v[112:115], v12 offset:2560
v_mfma_f32_16x16x32_bf16 v[44:47], v[164:167], v[132:135], v[44:47]
v_mfma_f32_16x16x32_bf16 v[48:51], v[164:167], v[136:139], v[48:51]
v_mfma_f32_16x16x32_bf16 v[52:55], v[164:167], v[140:143], v[52:55]
v_mfma_f32_16x16x32_bf16 v[56:59], v[164:167], v[144:147], v[56:59]
ds_read2_b32 v[164:165], v6 offset0:128 offset1:129
ds_read2_b32 v[166:167], v6 offset0:130 offset1:131
s_waitcnt lgkmcnt(15)
v_mfma_f32_16x16x32_bf16 v[40:43], v[168:171], v[124:127], v[40:43]
ds_read_b128 v[116:119], v12 offset:3072
v_mfma_f32_16x16x32_bf16 v[44:47], v[168:171], v[128:131], v[44:47]
ds_read_b128 v[120:123], v12 offset:3584
v_mfma_f32_16x16x32_bf16 v[48:51], v[168:171], v[132:135], v[48:51]
v_mfma_f32_16x16x32_bf16 v[52:55], v[168:171], v[136:139], v[52:55]
v_mfma_f32_16x16x32_bf16 v[56:59], v[168:171], v[140:143], v[56:59]
ds_read2_b32 v[168:169], v6 offset0:0 offset1:1
ds_read2_b32 v[170:171], v6 offset0:2 offset1:3
s_waitcnt lgkmcnt(15)
v_mfma_f32_16x16x32_bf16 v[44:47], v[172:175], v[124:127], v[44:47]
v_mfma_f32_16x16x32_bf16 v[48:51], v[172:175], v[128:131], v[48:51]
v_mfma_f32_16x16x32_bf16 v[52:55], v[172:175], v[132:135], v[52:55]
v_mfma_f32_16x16x32_bf16 v[56:59], v[172:175], v[136:139], v[56:59]
ds_read2_b32 v[172:173], v5 offset0:128 offset1:129
ds_read2_b32 v[174:175], v5 offset0:130 offset1:131
s_waitcnt lgkmcnt(15)
v_mfma_f32_16x16x32_bf16 v[48:51], v[176:179], v[124:127], v[48:51]
v_mfma_f32_16x16x32_bf16 v[52:55], v[176:179], v[128:131], v[52:55]
v_mfma_f32_16x16x32_bf16 v[56:59], v[176:179], v[132:135], v[56:59]
ds_read2_b32 v[176:177], v5 offset0:0 offset1:1
ds_read2_b32 v[178:179], v5 offset0:2 offset1:3
s_waitcnt lgkmcnt(15)
v_mfma_f32_16x16x32_bf16 v[52:55], v[180:183], v[124:127], v[52:55]
v_mfma_f32_16x16x32_bf16 v[56:59], v[180:183], v[128:131], v[56:59]
ds_read2_b32 v[180:181], v4 offset0:128 offset1:129
ds_read2_b32 v[182:183], v4 offset0:130 offset1:131
s_waitcnt lgkmcnt(15)
v_mfma_f32_16x16x32_bf16 v[56:59], v[184:187], v[124:127], v[56:59]
ds_read2_b32 v[184:185], v4 offset0:0 offset1:1
ds_read2_b32 v[186:187], v4 offset0:2 offset1:3
v_add_u32 v8, 13056, v2
v_add_u32 v9, 14080, v2
v_add_u32 v10, 15104, v2
v_add_u32 v11, 16128, v2
v_add_u32 v13, 13056, v3
s_waitcnt lgkmcnt(10)
v_mfma_f32_16x16x32_bf16 v[28:31], v[156:159], v[92:95], v[28:31]
ds_read_b128 v[124:127], v13 offset:0
v_mfma_f32_16x16x32_bf16 v[32:35], v[156:159], v[96:99], v[32:35]
ds_read_b128 v[128:131], v13 offset:512
v_mfma_f32_16x16x32_bf16 v[36:39], v[156:159], v[100:103], v[36:39]
v_mfma_f32_16x16x32_bf16 v[40:43], v[156:159], v[104:107], v[40:43]
v_mfma_f32_16x16x32_bf16 v[44:47], v[156:159], v[108:111], v[44:47]
v_mfma_f32_16x16x32_bf16 v[48:51], v[156:159], v[112:115], v[48:51]
v_mfma_f32_16x16x32_bf16 v[52:55], v[156:159], v[116:119], v[52:55]
v_mfma_f32_16x16x32_bf16 v[56:59], v[156:159], v[120:123], v[56:59]
ds_read2_b32 v[156:157], v11 offset0:128 offset1:129
ds_read2_b32 v[158:159], v11 offset0:130 offset1:131
s_waitcnt lgkmcnt(15)
v_mfma_f32_16x16x32_bf16 v[32:35], v[160:163], v[92:95], v[32:35]
ds_read_b128 v[132:135], v13 offset:1024
v_mfma_f32_16x16x32_bf16 v[36:39], v[160:163], v[96:99], v[36:39]
ds_read_b128 v[136:139], v13 offset:1536
v_mfma_f32_16x16x32_bf16 v[40:43], v[160:163], v[100:103], v[40:43]
v_mfma_f32_16x16x32_bf16 v[44:47], v[160:163], v[104:107], v[44:47]
v_mfma_f32_16x16x32_bf16 v[48:51], v[160:163], v[108:111], v[48:51]
v_mfma_f32_16x16x32_bf16 v[52:55], v[160:163], v[112:115], v[52:55]
v_mfma_f32_16x16x32_bf16 v[56:59], v[160:163], v[116:119], v[56:59]
ds_read2_b32 v[160:161], v11 offset0:0 offset1:1
ds_read2_b32 v[162:163], v11 offset0:2 offset1:3
s_waitcnt lgkmcnt(15)
v_mfma_f32_16x16x32_bf16 v[36:39], v[164:167], v[92:95], v[36:39]
ds_read_b128 v[140:143], v13 offset:2048
v_mfma_f32_16x16x32_bf16 v[40:43], v[164:167], v[96:99], v[40:43]
ds_read_b128 v[144:147], v13 offset:2560
v_mfma_f32_16x16x32_bf16 v[44:47], v[164:167], v[100:103], v[44:47]
v_mfma_f32_16x16x32_bf16 v[48:51], v[164:167], v[104:107], v[48:51]
v_mfma_f32_16x16x32_bf16 v[52:55], v[164:167], v[108:111], v[52:55]
v_mfma_f32_16x16x32_bf16 v[56:59], v[164:167], v[112:115], v[56:59]
ds_read2_b32 v[164:165], v10 offset0:128 offset1:129
ds_read2_b32 v[166:167], v10 offset0:130 offset1:131
s_waitcnt lgkmcnt(15)
v_mfma_f32_16x16x32_bf16 v[40:43], v[168:171], v[92:95], v[40:43]
ds_read_b128 v[148:151], v13 offset:3072
v_mfma_f32_16x16x32_bf16 v[44:47], v[168:171], v[96:99], v[44:47]
ds_read_b128 v[152:155], v13 offset:3584
v_mfma_f32_16x16x32_bf16 v[48:51], v[168:171], v[100:103], v[48:51]
v_mfma_f32_16x16x32_bf16 v[52:55], v[168:171], v[104:107], v[52:55]
v_mfma_f32_16x16x32_bf16 v[56:59], v[168:171], v[108:111], v[56:59]
ds_read2_b32 v[168:169], v10 offset0:0 offset1:1
ds_read2_b32 v[170:171], v10 offset0:2 offset1:3
s_waitcnt lgkmcnt(15)
v_mfma_f32_16x16x32_bf16 v[44:47], v[172:175], v[92:95], v[44:47]
v_mfma_f32_16x16x32_bf16 v[48:51], v[172:175], v[96:99], v[48:51]
v_mfma_f32_16x16x32_bf16 v[52:55], v[172:175], v[100:103], v[52:55]
v_mfma_f32_16x16x32_bf16 v[56:59], v[172:175], v[104:107], v[56:59]
ds_read2_b32 v[172:173], v9 offset0:128 offset1:129
ds_read2_b32 v[174:175], v9 offset0:130 offset1:131
s_waitcnt lgkmcnt(15)
v_mfma_f32_16x16x32_bf16 v[48:51], v[176:179], v[92:95], v[48:51]
v_mfma_f32_16x16x32_bf16 v[52:55], v[176:179], v[96:99], v[52:55]
v_mfma_f32_16x16x32_bf16 v[56:59], v[176:179], v[100:103], v[56:59]
ds_read2_b32 v[176:177], v9 offset0:0 offset1:1
ds_read2_b32 v[178:179], v9 offset0:2 offset1:3
s_waitcnt lgkmcnt(15)
v_mfma_f32_16x16x32_bf16 v[52:55], v[180:183], v[92:95], v[52:55]
v_mfma_f32_16x16x32_bf16 v[56:59], v[180:183], v[96:99], v[56:59]
ds_read2_b32 v[180:181], v8 offset0:128 offset1:129
ds_read2_b32 v[182:183], v8 offset0:130 offset1:131
s_waitcnt lgkmcnt(15)
v_mfma_f32_16x16x32_bf16 v[56:59], v[184:187], v[92:95], v[56:59]
ds_read2_b32 v[184:185], v8 offset0:0 offset1:1
ds_read2_b32 v[186:187], v8 offset0:2 offset1:3
v_lshlrev_b32 v22, 4, v1
v_add_u32 v22, 108800, v22
ds_write_b128 v22, v[28:31] offset:0
ds_write_b128 v22, v[32:35] offset:1024
ds_write_b128 v22, v[36:39] offset:2048
ds_write_b128 v22, v[40:43] offset:3072
ds_write_b128 v22, v[44:47] offset:4096
ds_write_b128 v22, v[48:51] offset:5120
ds_write_b128 v22, v[52:55] offset:6144
ds_write_b128 v22, v[56:59] offset:7168
v_add_u32 v4, 12992, v2
v_add_u32 v5, 14016, v2
v_add_u32 v6, 15040, v2
v_add_u32 v7, 16064, v2
v_add_u32 v12, 12992, v3
s_waitcnt lgkmcnt(15)
v_mfma_f32_16x16x32_bf16 v[60:63], v[156:159], v[124:127], 0
ds_read_b128 v[92:95], v12 offset:0
v_mfma_f32_16x16x32_bf16 v[64:67], v[156:159], v[128:131], 0
ds_read_b128 v[96:99], v12 offset:512
v_mfma_f32_16x16x32_bf16 v[68:71], v[156:159], v[132:135], 0
v_mfma_f32_16x16x32_bf16 v[72:75], v[156:159], v[136:139], 0
v_mfma_f32_16x16x32_bf16 v[76:79], v[156:159], v[140:143], 0
v_mfma_f32_16x16x32_bf16 v[80:83], v[156:159], v[144:147], 0
v_mfma_f32_16x16x32_bf16 v[84:87], v[156:159], v[148:151], 0
v_mfma_f32_16x16x32_bf16 v[88:91], v[156:159], v[152:155], 0
ds_read2_b32 v[156:157], v7 offset0:128 offset1:129
ds_read2_b32 v[158:159], v7 offset0:130 offset1:131
s_waitcnt lgkmcnt(15)
v_mfma_f32_16x16x32_bf16 v[64:67], v[160:163], v[124:127], v[64:67]
ds_read_b128 v[100:103], v12 offset:1024
v_mfma_f32_16x16x32_bf16 v[68:71], v[160:163], v[128:131], v[68:71]
ds_read_b128 v[104:107], v12 offset:1536
v_mfma_f32_16x16x32_bf16 v[72:75], v[160:163], v[132:135], v[72:75]
v_mfma_f32_16x16x32_bf16 v[76:79], v[160:163], v[136:139], v[76:79]
v_mfma_f32_16x16x32_bf16 v[80:83], v[160:163], v[140:143], v[80:83]
v_mfma_f32_16x16x32_bf16 v[84:87], v[160:163], v[144:147], v[84:87]
v_mfma_f32_16x16x32_bf16 v[88:91], v[160:163], v[148:151], v[88:91]
ds_read2_b32 v[160:161], v7 offset0:0 offset1:1
ds_read2_b32 v[162:163], v7 offset0:2 offset1:3
s_waitcnt lgkmcnt(15)
v_mfma_f32_16x16x32_bf16 v[68:71], v[164:167], v[124:127], v[68:71]
ds_read_b128 v[108:111], v12 offset:2048
v_mfma_f32_16x16x32_bf16 v[72:75], v[164:167], v[128:131], v[72:75]
ds_read_b128 v[112:115], v12 offset:2560
v_mfma_f32_16x16x32_bf16 v[76:79], v[164:167], v[132:135], v[76:79]
v_mfma_f32_16x16x32_bf16 v[80:83], v[164:167], v[136:139], v[80:83]
v_mfma_f32_16x16x32_bf16 v[84:87], v[164:167], v[140:143], v[84:87]
v_mfma_f32_16x16x32_bf16 v[88:91], v[164:167], v[144:147], v[88:91]
ds_read2_b32 v[164:165], v6 offset0:128 offset1:129
ds_read2_b32 v[166:167], v6 offset0:130 offset1:131
s_waitcnt lgkmcnt(15)
v_mfma_f32_16x16x32_bf16 v[72:75], v[168:171], v[124:127], v[72:75]
ds_read_b128 v[116:119], v12 offset:3072
v_mfma_f32_16x16x32_bf16 v[76:79], v[168:171], v[128:131], v[76:79]
ds_read_b128 v[120:123], v12 offset:3584
v_mfma_f32_16x16x32_bf16 v[80:83], v[168:171], v[132:135], v[80:83]
v_mfma_f32_16x16x32_bf16 v[84:87], v[168:171], v[136:139], v[84:87]
v_mfma_f32_16x16x32_bf16 v[88:91], v[168:171], v[140:143], v[88:91]
ds_read2_b32 v[168:169], v6 offset0:0 offset1:1
ds_read2_b32 v[170:171], v6 offset0:2 offset1:3
s_waitcnt lgkmcnt(15)
v_mfma_f32_16x16x32_bf16 v[76:79], v[172:175], v[124:127], v[76:79]
v_mfma_f32_16x16x32_bf16 v[80:83], v[172:175], v[128:131], v[80:83]
v_mfma_f32_16x16x32_bf16 v[84:87], v[172:175], v[132:135], v[84:87]
v_mfma_f32_16x16x32_bf16 v[88:91], v[172:175], v[136:139], v[88:91]
ds_read2_b32 v[172:173], v5 offset0:128 offset1:129
ds_read2_b32 v[174:175], v5 offset0:130 offset1:131
s_waitcnt lgkmcnt(15)
v_mfma_f32_16x16x32_bf16 v[80:83], v[176:179], v[124:127], v[80:83]
v_mfma_f32_16x16x32_bf16 v[84:87], v[176:179], v[128:131], v[84:87]
v_mfma_f32_16x16x32_bf16 v[88:91], v[176:179], v[132:135], v[88:91]
ds_read2_b32 v[176:177], v5 offset0:0 offset1:1
ds_read2_b32 v[178:179], v5 offset0:2 offset1:3
s_waitcnt lgkmcnt(15)
v_mfma_f32_16x16x32_bf16 v[84:87], v[180:183], v[124:127], v[84:87]
v_mfma_f32_16x16x32_bf16 v[88:91], v[180:183], v[128:131], v[88:91]
ds_read2_b32 v[180:181], v4 offset0:128 offset1:129
ds_read2_b32 v[182:183], v4 offset0:130 offset1:131
s_waitcnt lgkmcnt(15)
v_mfma_f32_16x16x32_bf16 v[88:91], v[184:187], v[124:127], v[88:91]
ds_read2_b32 v[184:185], v4 offset0:0 offset1:1
ds_read2_b32 v[186:187], v4 offset0:2 offset1:3
s_waitcnt lgkmcnt(10)
v_mfma_f32_16x16x32_bf16 v[60:63], v[156:159], v[92:95], v[60:63]
v_mfma_f32_16x16x32_bf16 v[64:67], v[156:159], v[96:99], v[64:67]
v_mfma_f32_16x16x32_bf16 v[68:71], v[156:159], v[100:103], v[68:71]
v_mfma_f32_16x16x32_bf16 v[72:75], v[156:159], v[104:107], v[72:75]
v_mfma_f32_16x16x32_bf16 v[76:79], v[156:159], v[108:111], v[76:79]
v_mfma_f32_16x16x32_bf16 v[80:83], v[156:159], v[112:115], v[80:83]
v_mfma_f32_16x16x32_bf16 v[84:87], v[156:159], v[116:119], v[84:87]
v_mfma_f32_16x16x32_bf16 v[88:91], v[156:159], v[120:123], v[88:91]
s_waitcnt lgkmcnt(11)
v_mfma_f32_16x16x32_bf16 v[64:67], v[160:163], v[92:95], v[64:67]
v_mfma_f32_16x16x32_bf16 v[68:71], v[160:163], v[96:99], v[68:71]
v_mfma_f32_16x16x32_bf16 v[72:75], v[160:163], v[100:103], v[72:75]
v_mfma_f32_16x16x32_bf16 v[76:79], v[160:163], v[104:107], v[76:79]
v_mfma_f32_16x16x32_bf16 v[80:83], v[160:163], v[108:111], v[80:83]
v_mfma_f32_16x16x32_bf16 v[84:87], v[160:163], v[112:115], v[84:87]
v_mfma_f32_16x16x32_bf16 v[88:91], v[160:163], v[116:119], v[88:91]
s_waitcnt lgkmcnt(12)
v_mfma_f32_16x16x32_bf16 v[68:71], v[164:167], v[92:95], v[68:71]
v_mfma_f32_16x16x32_bf16 v[72:75], v[164:167], v[96:99], v[72:75]
v_mfma_f32_16x16x32_bf16 v[76:79], v[164:167], v[100:103], v[76:79]
v_mfma_f32_16x16x32_bf16 v[80:83], v[164:167], v[104:107], v[80:83]
v_mfma_f32_16x16x32_bf16 v[84:87], v[164:167], v[108:111], v[84:87]
v_mfma_f32_16x16x32_bf16 v[88:91], v[164:167], v[112:115], v[88:91]
s_waitcnt lgkmcnt(8)
v_mfma_f32_16x16x32_bf16 v[72:75], v[168:171], v[92:95], v[72:75]
v_mfma_f32_16x16x32_bf16 v[76:79], v[168:171], v[96:99], v[76:79]
v_mfma_f32_16x16x32_bf16 v[80:83], v[168:171], v[100:103], v[80:83]
v_mfma_f32_16x16x32_bf16 v[84:87], v[168:171], v[104:107], v[84:87]
v_mfma_f32_16x16x32_bf16 v[88:91], v[168:171], v[108:111], v[88:91]
s_waitcnt lgkmcnt(6)
v_mfma_f32_16x16x32_bf16 v[76:79], v[172:175], v[92:95], v[76:79]
v_mfma_f32_16x16x32_bf16 v[80:83], v[172:175], v[96:99], v[80:83]
v_mfma_f32_16x16x32_bf16 v[84:87], v[172:175], v[100:103], v[84:87]
v_mfma_f32_16x16x32_bf16 v[88:91], v[172:175], v[104:107], v[88:91]
s_waitcnt lgkmcnt(4)
v_mfma_f32_16x16x32_bf16 v[80:83], v[176:179], v[92:95], v[80:83]
v_mfma_f32_16x16x32_bf16 v[84:87], v[176:179], v[96:99], v[84:87]
v_mfma_f32_16x16x32_bf16 v[88:91], v[176:179], v[100:103], v[88:91]
s_waitcnt lgkmcnt(2)
v_mfma_f32_16x16x32_bf16 v[84:87], v[180:183], v[92:95], v[84:87]
v_mfma_f32_16x16x32_bf16 v[88:91], v[180:183], v[96:99], v[88:91]
s_waitcnt lgkmcnt(0)
v_mfma_f32_16x16x32_bf16 v[88:91], v[184:187], v[92:95], v[88:91]
v_lshlrev_b32 v22, 4, v1
v_add_u32 v22, 116992, v22
ds_write_b128 v22, v[60:63] offset:0
ds_write_b128 v22, v[64:67] offset:1024
ds_write_b128 v22, v[68:71] offset:2048
ds_write_b128 v22, v[72:75] offset:3072
ds_write_b128 v22, v[76:79] offset:4096
ds_write_b128 v22, v[80:83] offset:5120
ds_write_b128 v22, v[84:87] offset:6144
ds_write_b128 v22, v[88:91] offset:7168
s_waitcnt lgkmcnt(0)
s_waitcnt vmcnt(0)
v_lshlrev_b32 v244, 16, v244
v_lshlrev_b32 v245, 16, v245
v_lshlrev_b32 v246, 16, v246
s_waitcnt lgkmcnt(0)
v_mov_b32 v14, 153860
v_mov_b32 v15, 3
ds_write_b32 v14, v15
s_branch l2_kernel_cv_cend
l2_kernel_cv_w2:
v_add_u32 v4, 12928, v2
v_add_u32 v5, 13952, v2
v_add_u32 v6, 14976, v2
v_add_u32 v7, 16000, v2
v_add_u32 v12, 12928, v3
ds_read_b128 v[92:95], v12 offset:0
ds_read_b128 v[96:99], v12 offset:512
ds_read_b128 v[100:103], v12 offset:1024
ds_read_b128 v[104:107], v12 offset:1536
ds_read_b128 v[108:111], v12 offset:2048
ds_read_b128 v[112:115], v12 offset:2560
ds_read_b128 v[116:119], v12 offset:3072
ds_read_b128 v[120:123], v12 offset:3584
ds_read2_b32 v[156:157], v7 offset0:128 offset1:129
ds_read2_b32 v[158:159], v7 offset0:130 offset1:131
ds_read2_b32 v[160:161], v7 offset0:0 offset1:1
ds_read2_b32 v[162:163], v7 offset0:2 offset1:3
ds_read2_b32 v[164:165], v6 offset0:128 offset1:129
ds_read2_b32 v[166:167], v6 offset0:130 offset1:131
ds_read2_b32 v[168:169], v6 offset0:0 offset1:1
ds_read2_b32 v[170:171], v6 offset0:2 offset1:3
ds_read2_b32 v[172:173], v5 offset0:128 offset1:129
ds_read2_b32 v[174:175], v5 offset0:130 offset1:131
ds_read2_b32 v[176:177], v5 offset0:0 offset1:1
ds_read2_b32 v[178:179], v5 offset0:2 offset1:3
ds_read2_b32 v[180:181], v4 offset0:128 offset1:129
ds_read2_b32 v[182:183], v4 offset0:130 offset1:131
ds_read2_b32 v[184:185], v4 offset0:0 offset1:1
ds_read2_b32 v[186:187], v4 offset0:2 offset1:3
v_add_u32 v8, 12864, v2
v_add_u32 v9, 13888, v2
v_add_u32 v10, 14912, v2
v_add_u32 v11, 15936, v2
v_add_u32 v13, 12864, v3
s_waitcnt lgkmcnt(14)
v_mfma_f32_16x16x32_bf16 v[28:31], v[156:159], v[92:95], 0
ds_read_b128 v[124:127], v13 offset:0
v_mfma_f32_16x16x32_bf16 v[32:35], v[156:159], v[96:99], 0
ds_read_b128 v[128:131], v13 offset:512
v_mfma_f32_16x16x32_bf16 v[36:39], v[156:159], v[100:103], 0
v_mfma_f32_16x16x32_bf16 v[40:43], v[156:159], v[104:107], 0
v_mfma_f32_16x16x32_bf16 v[44:47], v[156:159], v[108:111], 0
v_mfma_f32_16x16x32_bf16 v[48:51], v[156:159], v[112:115], 0
v_mfma_f32_16x16x32_bf16 v[52:55], v[156:159], v[116:119], 0
v_mfma_f32_16x16x32_bf16 v[56:59], v[156:159], v[120:123], 0
ds_read2_b32 v[156:157], v11 offset0:128 offset1:129
ds_read2_b32 v[158:159], v11 offset0:130 offset1:131
s_waitcnt lgkmcnt(15)
v_mfma_f32_16x16x32_bf16 v[32:35], v[160:163], v[92:95], v[32:35]
ds_read_b128 v[132:135], v13 offset:1024
v_mfma_f32_16x16x32_bf16 v[36:39], v[160:163], v[96:99], v[36:39]
ds_read_b128 v[136:139], v13 offset:1536
v_mfma_f32_16x16x32_bf16 v[40:43], v[160:163], v[100:103], v[40:43]
v_mfma_f32_16x16x32_bf16 v[44:47], v[160:163], v[104:107], v[44:47]
v_mfma_f32_16x16x32_bf16 v[48:51], v[160:163], v[108:111], v[48:51]
v_mfma_f32_16x16x32_bf16 v[52:55], v[160:163], v[112:115], v[52:55]
v_mfma_f32_16x16x32_bf16 v[56:59], v[160:163], v[116:119], v[56:59]
ds_read2_b32 v[160:161], v11 offset0:0 offset1:1
ds_read2_b32 v[162:163], v11 offset0:2 offset1:3
s_waitcnt lgkmcnt(15)
v_mfma_f32_16x16x32_bf16 v[36:39], v[164:167], v[92:95], v[36:39]
ds_read_b128 v[140:143], v13 offset:2048
v_mfma_f32_16x16x32_bf16 v[40:43], v[164:167], v[96:99], v[40:43]
ds_read_b128 v[144:147], v13 offset:2560
v_mfma_f32_16x16x32_bf16 v[44:47], v[164:167], v[100:103], v[44:47]
v_mfma_f32_16x16x32_bf16 v[48:51], v[164:167], v[104:107], v[48:51]
v_mfma_f32_16x16x32_bf16 v[52:55], v[164:167], v[108:111], v[52:55]
v_mfma_f32_16x16x32_bf16 v[56:59], v[164:167], v[112:115], v[56:59]
ds_read2_b32 v[164:165], v10 offset0:128 offset1:129
ds_read2_b32 v[166:167], v10 offset0:130 offset1:131
s_waitcnt lgkmcnt(15)
v_mfma_f32_16x16x32_bf16 v[40:43], v[168:171], v[92:95], v[40:43]
ds_read_b128 v[148:151], v13 offset:3072
v_mfma_f32_16x16x32_bf16 v[44:47], v[168:171], v[96:99], v[44:47]
ds_read_b128 v[152:155], v13 offset:3584
v_mfma_f32_16x16x32_bf16 v[48:51], v[168:171], v[100:103], v[48:51]
v_mfma_f32_16x16x32_bf16 v[52:55], v[168:171], v[104:107], v[52:55]
v_mfma_f32_16x16x32_bf16 v[56:59], v[168:171], v[108:111], v[56:59]
ds_read2_b32 v[168:169], v10 offset0:0 offset1:1
ds_read2_b32 v[170:171], v10 offset0:2 offset1:3
s_waitcnt lgkmcnt(15)
v_mfma_f32_16x16x32_bf16 v[44:47], v[172:175], v[92:95], v[44:47]
v_mfma_f32_16x16x32_bf16 v[48:51], v[172:175], v[96:99], v[48:51]
v_mfma_f32_16x16x32_bf16 v[52:55], v[172:175], v[100:103], v[52:55]
v_mfma_f32_16x16x32_bf16 v[56:59], v[172:175], v[104:107], v[56:59]
ds_read2_b32 v[172:173], v9 offset0:128 offset1:129
ds_read2_b32 v[174:175], v9 offset0:130 offset1:131
s_waitcnt lgkmcnt(15)
v_mfma_f32_16x16x32_bf16 v[48:51], v[176:179], v[92:95], v[48:51]
v_mfma_f32_16x16x32_bf16 v[52:55], v[176:179], v[96:99], v[52:55]
v_mfma_f32_16x16x32_bf16 v[56:59], v[176:179], v[100:103], v[56:59]
ds_read2_b32 v[176:177], v9 offset0:0 offset1:1
ds_read2_b32 v[178:179], v9 offset0:2 offset1:3
s_waitcnt lgkmcnt(15)
v_mfma_f32_16x16x32_bf16 v[52:55], v[180:183], v[92:95], v[52:55]
v_mfma_f32_16x16x32_bf16 v[56:59], v[180:183], v[96:99], v[56:59]
ds_read2_b32 v[180:181], v8 offset0:128 offset1:129
ds_read2_b32 v[182:183], v8 offset0:130 offset1:131
s_waitcnt lgkmcnt(15)
v_mfma_f32_16x16x32_bf16 v[56:59], v[184:187], v[92:95], v[56:59]
ds_read2_b32 v[184:185], v8 offset0:0 offset1:1
ds_read2_b32 v[186:187], v8 offset0:2 offset1:3
v_add_u32 v4, 12800, v2
v_add_u32 v5, 13824, v2
v_add_u32 v6, 14848, v2
v_add_u32 v7, 15872, v2
v_add_u32 v12, 12800, v3
s_waitcnt lgkmcnt(10)
v_mfma_f32_16x16x32_bf16 v[28:31], v[156:159], v[124:127], v[28:31]
ds_read_b128 v[92:95], v12 offset:0
v_mfma_f32_16x16x32_bf16 v[32:35], v[156:159], v[128:131], v[32:35]
ds_read_b128 v[96:99], v12 offset:512
v_mfma_f32_16x16x32_bf16 v[36:39], v[156:159], v[132:135], v[36:39]
v_mfma_f32_16x16x32_bf16 v[40:43], v[156:159], v[136:139], v[40:43]
v_mfma_f32_16x16x32_bf16 v[44:47], v[156:159], v[140:143], v[44:47]
v_mfma_f32_16x16x32_bf16 v[48:51], v[156:159], v[144:147], v[48:51]
v_mfma_f32_16x16x32_bf16 v[52:55], v[156:159], v[148:151], v[52:55]
v_mfma_f32_16x16x32_bf16 v[56:59], v[156:159], v[152:155], v[56:59]
ds_read2_b32 v[156:157], v7 offset0:128 offset1:129
ds_read2_b32 v[158:159], v7 offset0:130 offset1:131
s_waitcnt lgkmcnt(15)
v_mfma_f32_16x16x32_bf16 v[32:35], v[160:163], v[124:127], v[32:35]
ds_read_b128 v[100:103], v12 offset:1024
v_mfma_f32_16x16x32_bf16 v[36:39], v[160:163], v[128:131], v[36:39]
ds_read_b128 v[104:107], v12 offset:1536
v_mfma_f32_16x16x32_bf16 v[40:43], v[160:163], v[132:135], v[40:43]
v_mfma_f32_16x16x32_bf16 v[44:47], v[160:163], v[136:139], v[44:47]
v_mfma_f32_16x16x32_bf16 v[48:51], v[160:163], v[140:143], v[48:51]
v_mfma_f32_16x16x32_bf16 v[52:55], v[160:163], v[144:147], v[52:55]
v_mfma_f32_16x16x32_bf16 v[56:59], v[160:163], v[148:151], v[56:59]
ds_read2_b32 v[160:161], v7 offset0:0 offset1:1
ds_read2_b32 v[162:163], v7 offset0:2 offset1:3
s_waitcnt lgkmcnt(15)
v_mfma_f32_16x16x32_bf16 v[36:39], v[164:167], v[124:127], v[36:39]
ds_read_b128 v[108:111], v12 offset:2048
v_mfma_f32_16x16x32_bf16 v[40:43], v[164:167], v[128:131], v[40:43]
ds_read_b128 v[112:115], v12 offset:2560
v_mfma_f32_16x16x32_bf16 v[44:47], v[164:167], v[132:135], v[44:47]
v_mfma_f32_16x16x32_bf16 v[48:51], v[164:167], v[136:139], v[48:51]
v_mfma_f32_16x16x32_bf16 v[52:55], v[164:167], v[140:143], v[52:55]
v_mfma_f32_16x16x32_bf16 v[56:59], v[164:167], v[144:147], v[56:59]
ds_read2_b32 v[164:165], v6 offset0:128 offset1:129
ds_read2_b32 v[166:167], v6 offset0:130 offset1:131
s_waitcnt lgkmcnt(15)
v_mfma_f32_16x16x32_bf16 v[40:43], v[168:171], v[124:127], v[40:43]
ds_read_b128 v[116:119], v12 offset:3072
v_mfma_f32_16x16x32_bf16 v[44:47], v[168:171], v[128:131], v[44:47]
ds_read_b128 v[120:123], v12 offset:3584
v_mfma_f32_16x16x32_bf16 v[48:51], v[168:171], v[132:135], v[48:51]
v_mfma_f32_16x16x32_bf16 v[52:55], v[168:171], v[136:139], v[52:55]
v_mfma_f32_16x16x32_bf16 v[56:59], v[168:171], v[140:143], v[56:59]
ds_read2_b32 v[168:169], v6 offset0:0 offset1:1
ds_read2_b32 v[170:171], v6 offset0:2 offset1:3
s_waitcnt lgkmcnt(15)
v_mfma_f32_16x16x32_bf16 v[44:47], v[172:175], v[124:127], v[44:47]
v_mfma_f32_16x16x32_bf16 v[48:51], v[172:175], v[128:131], v[48:51]
v_mfma_f32_16x16x32_bf16 v[52:55], v[172:175], v[132:135], v[52:55]
v_mfma_f32_16x16x32_bf16 v[56:59], v[172:175], v[136:139], v[56:59]
ds_read2_b32 v[172:173], v5 offset0:128 offset1:129
ds_read2_b32 v[174:175], v5 offset0:130 offset1:131
s_waitcnt lgkmcnt(15)
v_mfma_f32_16x16x32_bf16 v[48:51], v[176:179], v[124:127], v[48:51]
v_mfma_f32_16x16x32_bf16 v[52:55], v[176:179], v[128:131], v[52:55]
v_mfma_f32_16x16x32_bf16 v[56:59], v[176:179], v[132:135], v[56:59]
ds_read2_b32 v[176:177], v5 offset0:0 offset1:1
ds_read2_b32 v[178:179], v5 offset0:2 offset1:3
s_waitcnt lgkmcnt(15)
v_mfma_f32_16x16x32_bf16 v[52:55], v[180:183], v[124:127], v[52:55]
v_mfma_f32_16x16x32_bf16 v[56:59], v[180:183], v[128:131], v[56:59]
ds_read2_b32 v[180:181], v4 offset0:128 offset1:129
ds_read2_b32 v[182:183], v4 offset0:130 offset1:131
s_waitcnt lgkmcnt(15)
v_mfma_f32_16x16x32_bf16 v[56:59], v[184:187], v[124:127], v[56:59]
ds_read2_b32 v[184:185], v4 offset0:0 offset1:1
ds_read2_b32 v[186:187], v4 offset0:2 offset1:3
v_add_u32 v8, 12736, v2
v_add_u32 v9, 13760, v2
v_add_u32 v10, 14784, v2
v_add_u32 v11, 15808, v2
v_add_u32 v13, 12736, v3
s_waitcnt lgkmcnt(10)
v_mfma_f32_16x16x32_bf16 v[28:31], v[156:159], v[92:95], v[28:31]
ds_read_b128 v[124:127], v13 offset:0
v_mfma_f32_16x16x32_bf16 v[32:35], v[156:159], v[96:99], v[32:35]
ds_read_b128 v[128:131], v13 offset:512
v_mfma_f32_16x16x32_bf16 v[36:39], v[156:159], v[100:103], v[36:39]
v_mfma_f32_16x16x32_bf16 v[40:43], v[156:159], v[104:107], v[40:43]
v_mfma_f32_16x16x32_bf16 v[44:47], v[156:159], v[108:111], v[44:47]
v_mfma_f32_16x16x32_bf16 v[48:51], v[156:159], v[112:115], v[48:51]
v_mfma_f32_16x16x32_bf16 v[52:55], v[156:159], v[116:119], v[52:55]
v_mfma_f32_16x16x32_bf16 v[56:59], v[156:159], v[120:123], v[56:59]
ds_read2_b32 v[156:157], v11 offset0:128 offset1:129
ds_read2_b32 v[158:159], v11 offset0:130 offset1:131
s_waitcnt lgkmcnt(15)
v_mfma_f32_16x16x32_bf16 v[32:35], v[160:163], v[92:95], v[32:35]
ds_read_b128 v[132:135], v13 offset:1024
v_mfma_f32_16x16x32_bf16 v[36:39], v[160:163], v[96:99], v[36:39]
ds_read_b128 v[136:139], v13 offset:1536
v_mfma_f32_16x16x32_bf16 v[40:43], v[160:163], v[100:103], v[40:43]
v_mfma_f32_16x16x32_bf16 v[44:47], v[160:163], v[104:107], v[44:47]
v_mfma_f32_16x16x32_bf16 v[48:51], v[160:163], v[108:111], v[48:51]
v_mfma_f32_16x16x32_bf16 v[52:55], v[160:163], v[112:115], v[52:55]
v_mfma_f32_16x16x32_bf16 v[56:59], v[160:163], v[116:119], v[56:59]
ds_read2_b32 v[160:161], v11 offset0:0 offset1:1
ds_read2_b32 v[162:163], v11 offset0:2 offset1:3
s_waitcnt lgkmcnt(15)
v_mfma_f32_16x16x32_bf16 v[36:39], v[164:167], v[92:95], v[36:39]
ds_read_b128 v[140:143], v13 offset:2048
v_mfma_f32_16x16x32_bf16 v[40:43], v[164:167], v[96:99], v[40:43]
ds_read_b128 v[144:147], v13 offset:2560
v_mfma_f32_16x16x32_bf16 v[44:47], v[164:167], v[100:103], v[44:47]
v_mfma_f32_16x16x32_bf16 v[48:51], v[164:167], v[104:107], v[48:51]
v_mfma_f32_16x16x32_bf16 v[52:55], v[164:167], v[108:111], v[52:55]
v_mfma_f32_16x16x32_bf16 v[56:59], v[164:167], v[112:115], v[56:59]
ds_read2_b32 v[164:165], v10 offset0:128 offset1:129
ds_read2_b32 v[166:167], v10 offset0:130 offset1:131
s_waitcnt lgkmcnt(15)
v_mfma_f32_16x16x32_bf16 v[40:43], v[168:171], v[92:95], v[40:43]
ds_read_b128 v[148:151], v13 offset:3072
v_mfma_f32_16x16x32_bf16 v[44:47], v[168:171], v[96:99], v[44:47]
ds_read_b128 v[152:155], v13 offset:3584
v_mfma_f32_16x16x32_bf16 v[48:51], v[168:171], v[100:103], v[48:51]
v_mfma_f32_16x16x32_bf16 v[52:55], v[168:171], v[104:107], v[52:55]
v_mfma_f32_16x16x32_bf16 v[56:59], v[168:171], v[108:111], v[56:59]
ds_read2_b32 v[168:169], v10 offset0:0 offset1:1
ds_read2_b32 v[170:171], v10 offset0:2 offset1:3
s_waitcnt lgkmcnt(15)
v_mfma_f32_16x16x32_bf16 v[44:47], v[172:175], v[92:95], v[44:47]
v_mfma_f32_16x16x32_bf16 v[48:51], v[172:175], v[96:99], v[48:51]
v_mfma_f32_16x16x32_bf16 v[52:55], v[172:175], v[100:103], v[52:55]
v_mfma_f32_16x16x32_bf16 v[56:59], v[172:175], v[104:107], v[56:59]
ds_read2_b32 v[172:173], v9 offset0:128 offset1:129
ds_read2_b32 v[174:175], v9 offset0:130 offset1:131
s_waitcnt lgkmcnt(15)
v_mfma_f32_16x16x32_bf16 v[48:51], v[176:179], v[92:95], v[48:51]
v_mfma_f32_16x16x32_bf16 v[52:55], v[176:179], v[96:99], v[52:55]
v_mfma_f32_16x16x32_bf16 v[56:59], v[176:179], v[100:103], v[56:59]
ds_read2_b32 v[176:177], v9 offset0:0 offset1:1
ds_read2_b32 v[178:179], v9 offset0:2 offset1:3
s_waitcnt lgkmcnt(15)
v_mfma_f32_16x16x32_bf16 v[52:55], v[180:183], v[92:95], v[52:55]
v_mfma_f32_16x16x32_bf16 v[56:59], v[180:183], v[96:99], v[56:59]
ds_read2_b32 v[180:181], v8 offset0:128 offset1:129
ds_read2_b32 v[182:183], v8 offset0:130 offset1:131
s_waitcnt lgkmcnt(15)
v_mfma_f32_16x16x32_bf16 v[56:59], v[184:187], v[92:95], v[56:59]
ds_read2_b32 v[184:185], v8 offset0:0 offset1:1
ds_read2_b32 v[186:187], v8 offset0:2 offset1:3
v_add_u32 v4, 12672, v2
v_add_u32 v5, 13696, v2
v_add_u32 v6, 14720, v2
v_add_u32 v7, 15744, v2
v_add_u32 v12, 12672, v3
s_waitcnt lgkmcnt(10)
v_mfma_f32_16x16x32_bf16 v[28:31], v[156:159], v[124:127], v[28:31]
ds_read_b128 v[92:95], v12 offset:0
v_mfma_f32_16x16x32_bf16 v[32:35], v[156:159], v[128:131], v[32:35]
ds_read_b128 v[96:99], v12 offset:512
v_mfma_f32_16x16x32_bf16 v[36:39], v[156:159], v[132:135], v[36:39]
v_mfma_f32_16x16x32_bf16 v[40:43], v[156:159], v[136:139], v[40:43]
v_mfma_f32_16x16x32_bf16 v[44:47], v[156:159], v[140:143], v[44:47]
v_mfma_f32_16x16x32_bf16 v[48:51], v[156:159], v[144:147], v[48:51]
v_mfma_f32_16x16x32_bf16 v[52:55], v[156:159], v[148:151], v[52:55]
v_mfma_f32_16x16x32_bf16 v[56:59], v[156:159], v[152:155], v[56:59]
ds_read2_b32 v[156:157], v7 offset0:128 offset1:129
ds_read2_b32 v[158:159], v7 offset0:130 offset1:131
s_waitcnt lgkmcnt(15)
v_mfma_f32_16x16x32_bf16 v[32:35], v[160:163], v[124:127], v[32:35]
ds_read_b128 v[100:103], v12 offset:1024
v_mfma_f32_16x16x32_bf16 v[36:39], v[160:163], v[128:131], v[36:39]
ds_read_b128 v[104:107], v12 offset:1536
v_mfma_f32_16x16x32_bf16 v[40:43], v[160:163], v[132:135], v[40:43]
v_mfma_f32_16x16x32_bf16 v[44:47], v[160:163], v[136:139], v[44:47]
v_mfma_f32_16x16x32_bf16 v[48:51], v[160:163], v[140:143], v[48:51]
v_mfma_f32_16x16x32_bf16 v[52:55], v[160:163], v[144:147], v[52:55]
v_mfma_f32_16x16x32_bf16 v[56:59], v[160:163], v[148:151], v[56:59]
ds_read2_b32 v[160:161], v7 offset0:0 offset1:1
ds_read2_b32 v[162:163], v7 offset0:2 offset1:3
s_waitcnt lgkmcnt(15)
v_mfma_f32_16x16x32_bf16 v[36:39], v[164:167], v[124:127], v[36:39]
ds_read_b128 v[108:111], v12 offset:2048
v_mfma_f32_16x16x32_bf16 v[40:43], v[164:167], v[128:131], v[40:43]
ds_read_b128 v[112:115], v12 offset:2560
v_mfma_f32_16x16x32_bf16 v[44:47], v[164:167], v[132:135], v[44:47]
v_mfma_f32_16x16x32_bf16 v[48:51], v[164:167], v[136:139], v[48:51]
v_mfma_f32_16x16x32_bf16 v[52:55], v[164:167], v[140:143], v[52:55]
v_mfma_f32_16x16x32_bf16 v[56:59], v[164:167], v[144:147], v[56:59]
ds_read2_b32 v[164:165], v6 offset0:128 offset1:129
ds_read2_b32 v[166:167], v6 offset0:130 offset1:131
s_waitcnt lgkmcnt(15)
v_mfma_f32_16x16x32_bf16 v[40:43], v[168:171], v[124:127], v[40:43]
ds_read_b128 v[116:119], v12 offset:3072
v_mfma_f32_16x16x32_bf16 v[44:47], v[168:171], v[128:131], v[44:47]
ds_read_b128 v[120:123], v12 offset:3584
v_mfma_f32_16x16x32_bf16 v[48:51], v[168:171], v[132:135], v[48:51]
v_mfma_f32_16x16x32_bf16 v[52:55], v[168:171], v[136:139], v[52:55]
v_mfma_f32_16x16x32_bf16 v[56:59], v[168:171], v[140:143], v[56:59]
ds_read2_b32 v[168:169], v6 offset0:0 offset1:1
ds_read2_b32 v[170:171], v6 offset0:2 offset1:3
s_waitcnt lgkmcnt(15)
v_mfma_f32_16x16x32_bf16 v[44:47], v[172:175], v[124:127], v[44:47]
v_mfma_f32_16x16x32_bf16 v[48:51], v[172:175], v[128:131], v[48:51]
v_mfma_f32_16x16x32_bf16 v[52:55], v[172:175], v[132:135], v[52:55]
v_mfma_f32_16x16x32_bf16 v[56:59], v[172:175], v[136:139], v[56:59]
ds_read2_b32 v[172:173], v5 offset0:128 offset1:129
ds_read2_b32 v[174:175], v5 offset0:130 offset1:131
s_waitcnt lgkmcnt(15)
v_mfma_f32_16x16x32_bf16 v[48:51], v[176:179], v[124:127], v[48:51]
v_mfma_f32_16x16x32_bf16 v[52:55], v[176:179], v[128:131], v[52:55]
v_mfma_f32_16x16x32_bf16 v[56:59], v[176:179], v[132:135], v[56:59]
ds_read2_b32 v[176:177], v5 offset0:0 offset1:1
ds_read2_b32 v[178:179], v5 offset0:2 offset1:3
s_waitcnt lgkmcnt(15)
v_mfma_f32_16x16x32_bf16 v[52:55], v[180:183], v[124:127], v[52:55]
v_mfma_f32_16x16x32_bf16 v[56:59], v[180:183], v[128:131], v[56:59]
ds_read2_b32 v[180:181], v4 offset0:128 offset1:129
ds_read2_b32 v[182:183], v4 offset0:130 offset1:131
s_waitcnt lgkmcnt(15)
v_mfma_f32_16x16x32_bf16 v[56:59], v[184:187], v[124:127], v[56:59]
ds_read2_b32 v[184:185], v4 offset0:0 offset1:1
ds_read2_b32 v[186:187], v4 offset0:2 offset1:3
s_waitcnt lgkmcnt(10)
v_mfma_f32_16x16x32_bf16 v[28:31], v[156:159], v[92:95], v[28:31]
v_mfma_f32_16x16x32_bf16 v[32:35], v[156:159], v[96:99], v[32:35]
v_mfma_f32_16x16x32_bf16 v[36:39], v[156:159], v[100:103], v[36:39]
v_mfma_f32_16x16x32_bf16 v[40:43], v[156:159], v[104:107], v[40:43]
v_mfma_f32_16x16x32_bf16 v[44:47], v[156:159], v[108:111], v[44:47]
v_mfma_f32_16x16x32_bf16 v[48:51], v[156:159], v[112:115], v[48:51]
v_mfma_f32_16x16x32_bf16 v[52:55], v[156:159], v[116:119], v[52:55]
v_mfma_f32_16x16x32_bf16 v[56:59], v[156:159], v[120:123], v[56:59]
s_waitcnt lgkmcnt(11)
v_mfma_f32_16x16x32_bf16 v[32:35], v[160:163], v[92:95], v[32:35]
v_mfma_f32_16x16x32_bf16 v[36:39], v[160:163], v[96:99], v[36:39]
v_mfma_f32_16x16x32_bf16 v[40:43], v[160:163], v[100:103], v[40:43]
v_mfma_f32_16x16x32_bf16 v[44:47], v[160:163], v[104:107], v[44:47]
v_mfma_f32_16x16x32_bf16 v[48:51], v[160:163], v[108:111], v[48:51]
v_mfma_f32_16x16x32_bf16 v[52:55], v[160:163], v[112:115], v[52:55]
v_mfma_f32_16x16x32_bf16 v[56:59], v[160:163], v[116:119], v[56:59]
s_waitcnt lgkmcnt(12)
v_mfma_f32_16x16x32_bf16 v[36:39], v[164:167], v[92:95], v[36:39]
v_mfma_f32_16x16x32_bf16 v[40:43], v[164:167], v[96:99], v[40:43]
v_mfma_f32_16x16x32_bf16 v[44:47], v[164:167], v[100:103], v[44:47]
v_mfma_f32_16x16x32_bf16 v[48:51], v[164:167], v[104:107], v[48:51]
v_mfma_f32_16x16x32_bf16 v[52:55], v[164:167], v[108:111], v[52:55]
v_mfma_f32_16x16x32_bf16 v[56:59], v[164:167], v[112:115], v[56:59]
s_waitcnt lgkmcnt(8)
v_mfma_f32_16x16x32_bf16 v[40:43], v[168:171], v[92:95], v[40:43]
v_mfma_f32_16x16x32_bf16 v[44:47], v[168:171], v[96:99], v[44:47]
v_mfma_f32_16x16x32_bf16 v[48:51], v[168:171], v[100:103], v[48:51]
v_mfma_f32_16x16x32_bf16 v[52:55], v[168:171], v[104:107], v[52:55]
v_mfma_f32_16x16x32_bf16 v[56:59], v[168:171], v[108:111], v[56:59]
s_waitcnt lgkmcnt(6)
v_mfma_f32_16x16x32_bf16 v[44:47], v[172:175], v[92:95], v[44:47]
v_mfma_f32_16x16x32_bf16 v[48:51], v[172:175], v[96:99], v[48:51]
v_mfma_f32_16x16x32_bf16 v[52:55], v[172:175], v[100:103], v[52:55]
v_mfma_f32_16x16x32_bf16 v[56:59], v[172:175], v[104:107], v[56:59]
s_waitcnt lgkmcnt(4)
v_mfma_f32_16x16x32_bf16 v[48:51], v[176:179], v[92:95], v[48:51]
v_mfma_f32_16x16x32_bf16 v[52:55], v[176:179], v[96:99], v[52:55]
v_mfma_f32_16x16x32_bf16 v[56:59], v[176:179], v[100:103], v[56:59]
s_waitcnt lgkmcnt(2)
v_mfma_f32_16x16x32_bf16 v[52:55], v[180:183], v[92:95], v[52:55]
v_mfma_f32_16x16x32_bf16 v[56:59], v[180:183], v[96:99], v[56:59]
s_waitcnt lgkmcnt(0)
v_mfma_f32_16x16x32_bf16 v[56:59], v[184:187], v[92:95], v[56:59]
s_waitcnt vmcnt(0)
v_lshlrev_b32 v244, 16, v244
v_lshlrev_b32 v245, 16, v245
v_lshlrev_b32 v246, 16, v246
v_mov_b32 v14, 153860
s_mov_b32 s59, 0
l2_kernel_p2a:
ds_read_b32 v15, v14
s_waitcnt lgkmcnt(0)
v_readfirstlane_b32 s58, v15
s_nop 3
s_cmp_ge_u32 s58, 3
s_cbranch_scc1 l2_kernel_p2a_ok
s_add_u32 s59, s59, 1
s_cmp_lt_u32 s59, 0x100000
s_cbranch_scc1 l2_kernel_p2a
l2_kernel_p2a_ok:
v_mov_b32 v14, 153868
s_mov_b32 s59, 0
l2_kernel_p2b:
ds_read_b32 v15, v14
s_waitcnt lgkmcnt(0)
v_readfirstlane_b32 s58, v15
s_nop 3
s_cmp_ge_u32 s58, 3
s_cbranch_scc1 l2_kernel_p2b_ok
s_add_u32 s59, s59, 1
s_cmp_lt_u32 s59, 0x100000
s_cbranch_scc1 l2_kernel_p2b
l2_kernel_p2b_ok:
v_lshlrev_b32 v14, 4, v1
v_add_u32 v15, 116992, v14
ds_read_b128 v[92:95], v15 offset:0
ds_read_b128 v[96:99], v15 offset:1024
ds_read_b128 v[100:103], v15 offset:2048
ds_read_b128 v[104:107], v15 offset:3072
ds_read_b128 v[108:111], v15 offset:4096
ds_read_b128 v[112:115], v15 offset:5120
ds_read_b128 v[116:119], v15 offset:6144
ds_read_b128 v[120:123], v15 offset:7168
v_add_u32 v15, 125184, v14
ds_read_b128 v[124:127], v15 offset:0
ds_read_b128 v[128:131], v15 offset:1024
ds_read_b128 v[132:135], v15 offset:2048
ds_read_b128 v[136:139], v15 offset:3072
ds_read_b128 v[140:143], v15 offset:4096
ds_read_b128 v[144:147], v15 offset:5120
ds_read_b128 v[148:151], v15 offset:6144
ds_read_b128 v[152:155], v15 offset:7168
v_and_b32 v16, 15, v1
v_lshrrev_b32 v17, 4, v1
v_lshlrev_b32 v18, 5, v16
v_lshl_add_u32 v19, v17, 3, v18
v_add_u32 v19, 83200, v19
ds_read_b64 v[156:157], v19 offset:0
ds_read_b64 v[158:159], v19 offset:512
ds_read_b64 v[160:161], v19 offset:1024
ds_read_b64 v[162:163], v19 offset:1536
ds_read_b64 v[164:165], v19 offset:2048
ds_read_b64 v[166:167], v19 offset:2560
ds_read_b64 v[168:169], v19 offset:3072
ds_read_b64 v[170:171], v19 offset:3584
v_lshrrev_b32 v20, 1, v17
v_lshl_add_u32 v20, v20, 4, v18
v_and_b32 v21, 1, v17
v_mul_u32_u24 v22, 512, v21
v_add_u32 v22, v22, v20
s_lshl_b32 s20, s9, 12
s_add_u32 s20, s20, 14745600
s_waitcnt lgkmcnt(0)
v_add_f32 v28, v28, v92
v_add_f32 v29, v29, v93
v_add_f32 v30, v30, v94
v_add_f32 v31, v31, v95
v_add_f32 v32, v32, v96
v_add_f32 v33, v33, v97
v_add_f32 v34, v34, v98
v_add_f32 v35, v35, v99
v_add_f32 v36, v36, v100
v_add_f32 v37, v37, v101
v_add_f32 v38, v38, v102
v_add_f32 v39, v39, v103
v_add_f32 v40, v40, v104
v_add_f32 v41, v41, v105
v_add_f32 v42, v42, v106
v_add_f32 v43, v43, v107
v_add_f32 v44, v44, v108
v_add_f32 v45, v45, v109
v_add_f32 v46, v46, v110
v_add_f32 v47, v47, v111
v_add_f32 v48, v48, v112
v_add_f32 v49, v49, v113
v_add_f32 v50, v50, v114
v_add_f32 v51, v51, v115
v_add_f32 v52, v52, v116
v_add_f32 v53, v53, v117
v_add_f32 v54, v54, v118
v_add_f32 v55, v55, v119
v_add_f32 v56, v56, v120
v_add_f32 v57, v57, v121
v_add_f32 v58, v58, v122
v_add_f32 v59, v59, v123
v_add_f32 v28, v28, v124
v_add_f32 v29, v29, v125
v_add_f32 v30, v30, v126
v_add_f32 v31, v31, v127
v_add_f32 v32, v32, v128
v_add_f32 v33, v33, v129
v_add_f32 v34, v34, v130
v_add_f32 v35, v35, v131
v_add_f32 v36, v36, v132
v_add_f32 v37, v37, v133
v_add_f32 v38, v38, v134
v_add_f32 v39, v39, v135
v_add_f32 v40, v40, v136
v_add_f32 v41, v41, v137
v_add_f32 v42, v42, v138
v_add_f32 v43, v43, v139
v_add_f32 v44, v44, v140
v_add_f32 v45, v45, v141
v_add_f32 v46, v46, v142
v_add_f32 v47, v47, v143
v_add_f32 v48, v48, v144
v_add_f32 v49, v49, v145
v_add_f32 v50, v50, v146
v_add_f32 v51, v51, v147
v_add_f32 v52, v52, v148
v_add_f32 v53, v53, v149
v_add_f32 v54, v54, v150
v_add_f32 v55, v55, v151
v_add_f32 v56, v56, v152
v_add_f32 v57, v57, v153
v_add_f32 v58, v58, v154
v_add_f32 v59, v59, v155
v_lshlrev_b32 v196, 16, v156
v_and_b32 v197, 0xffff0000, v156
v_lshlrev_b32 v198, 16, v157
v_and_b32 v199, 0xffff0000, v157
v_fma_f32 v28, v196, v245, v28
v_fma_f32 v29, v197, v245, v29
v_fma_f32 v30, v198, v245, v30
v_fma_f32 v31, v199, v245, v31
v_cvt_pk_bf16_f32 v188, v28, v29
v_cvt_pk_bf16_f32 v189, v30, v31
v_lshlrev_b32 v200, 16, v158
v_and_b32 v201, 0xffff0000, v158
v_lshlrev_b32 v202, 16, v159
v_and_b32 v203, 0xffff0000, v159
v_fma_f32 v32, v200, v245, v32
v_fma_f32 v33, v201, v245, v33
v_fma_f32 v34, v202, v245, v34
v_fma_f32 v35, v203, v245, v35
v_cvt_pk_bf16_f32 v190, v32, v33
v_cvt_pk_bf16_f32 v191, v34, v35
s_nop 0
v_permlane16_swap_b32 v188, v190
v_permlane16_swap_b32 v189, v191
buffer_store_dwordx4 v[188:191], v22, s[32:35], s20 offen offset:0 sc0 sc1
v_lshlrev_b32 v196, 16, v160
v_and_b32 v197, 0xffff0000, v160
v_lshlrev_b32 v198, 16, v161
v_and_b32 v199, 0xffff0000, v161
v_fma_f32 v36, v196, v245, v36
v_fma_f32 v37, v197, v245, v37
v_fma_f32 v38, v198, v245, v38
v_fma_f32 v39, v199, v245, v39
v_cvt_pk_bf16_f32 v192, v36, v37
v_cvt_pk_bf16_f32 v193, v38, v39
v_lshlrev_b32 v200, 16, v162
v_and_b32 v201, 0xffff0000, v162
v_lshlrev_b32 v202, 16, v163
v_and_b32 v203, 0xffff0000, v163
v_fma_f32 v40, v200, v245, v40
v_fma_f32 v41, v201, v245, v41
v_fma_f32 v42, v202, v245, v42
v_fma_f32 v43, v203, v245, v43
v_cvt_pk_bf16_f32 v194, v40, v41
v_cvt_pk_bf16_f32 v195, v42, v43
s_nop 0
v_permlane16_swap_b32 v192, v194
v_permlane16_swap_b32 v193, v195
buffer_store_dwordx4 v[192:195], v22, s[32:35], s20 offen offset:1024 sc0 sc1
v_lshlrev_b32 v196, 16, v164
v_and_b32 v197, 0xffff0000, v164
v_lshlrev_b32 v198, 16, v165
v_and_b32 v199, 0xffff0000, v165
v_fma_f32 v44, v196, v245, v44
v_fma_f32 v45, v197, v245, v45
v_fma_f32 v46, v198, v245, v46
v_fma_f32 v47, v199, v245, v47
v_cvt_pk_bf16_f32 v188, v44, v45
v_cvt_pk_bf16_f32 v189, v46, v47
v_lshlrev_b32 v200, 16, v166
v_and_b32 v201, 0xffff0000, v166
v_lshlrev_b32 v202, 16, v167
v_and_b32 v203, 0xffff0000, v167
v_fma_f32 v48, v200, v245, v48
v_fma_f32 v49, v201, v245, v49
v_fma_f32 v50, v202, v245, v50
v_fma_f32 v51, v203, v245, v51
v_cvt_pk_bf16_f32 v190, v48, v49
v_cvt_pk_bf16_f32 v191, v50, v51
s_nop 0
v_permlane16_swap_b32 v188, v190
v_permlane16_swap_b32 v189, v191
buffer_store_dwordx4 v[188:191], v22, s[32:35], s20 offen offset:2048 sc0 sc1
v_lshlrev_b32 v196, 16, v168
v_and_b32 v197, 0xffff0000, v168
v_lshlrev_b32 v198, 16, v169
v_and_b32 v199, 0xffff0000, v169
v_fma_f32 v52, v196, v245, v52
v_fma_f32 v53, v197, v245, v53
v_fma_f32 v54, v198, v245, v54
v_fma_f32 v55, v199, v245, v55
v_cvt_pk_bf16_f32 v192, v52, v53
v_cvt_pk_bf16_f32 v193, v54, v55
v_lshlrev_b32 v200, 16, v170
v_and_b32 v201, 0xffff0000, v170
v_lshlrev_b32 v202, 16, v171
v_and_b32 v203, 0xffff0000, v171
v_fma_f32 v56, v200, v245, v56
v_fma_f32 v57, v201, v245, v57
v_fma_f32 v58, v202, v245, v58
v_fma_f32 v59, v203, v245, v59
v_cvt_pk_bf16_f32 v194, v56, v57
v_cvt_pk_bf16_f32 v195, v58, v59
s_nop 0
v_permlane16_swap_b32 v192, v194
v_permlane16_swap_b32 v193, v195
buffer_store_dwordx4 v[192:195], v22, s[32:35], s20 offen offset:3072 sc0 sc1
s_branch l2_kernel_cv_cend
l2_kernel_cv_w3:
s_cmp_eq_u32 s7, 1
s_cbranch_scc1 l2_kernel_cv_w3b
v_add_u32 v4, 12608, v2
v_add_u32 v5, 13632, v2
v_add_u32 v6, 14656, v2
v_add_u32 v7, 15680, v2
v_add_u32 v12, 12608, v3
ds_read_b128 v[92:95], v12 offset:0
ds_read_b128 v[96:99], v12 offset:512
ds_read_b128 v[100:103], v12 offset:1024
ds_read_b128 v[104:107], v12 offset:1536
ds_read_b128 v[108:111], v12 offset:2048
ds_read_b128 v[112:115], v12 offset:2560
ds_read_b128 v[116:119], v12 offset:3072
ds_read_b128 v[120:123], v12 offset:3584
ds_read2_b32 v[156:157], v7 offset0:128 offset1:129
ds_read2_b32 v[158:159], v7 offset0:130 offset1:131
ds_read2_b32 v[160:161], v7 offset0:0 offset1:1
ds_read2_b32 v[162:163], v7 offset0:2 offset1:3
ds_read2_b32 v[164:165], v6 offset0:128 offset1:129
ds_read2_b32 v[166:167], v6 offset0:130 offset1:131
ds_read2_b32 v[168:169], v6 offset0:0 offset1:1
ds_read2_b32 v[170:171], v6 offset0:2 offset1:3
ds_read2_b32 v[172:173], v5 offset0:128 offset1:129
ds_read2_b32 v[174:175], v5 offset0:130 offset1:131
ds_read2_b32 v[176:177], v5 offset0:0 offset1:1
ds_read2_b32 v[178:179], v5 offset0:2 offset1:3
ds_read2_b32 v[180:181], v4 offset0:128 offset1:129
ds_read2_b32 v[182:183], v4 offset0:130 offset1:131
ds_read2_b32 v[184:185], v4 offset0:0 offset1:1
ds_read2_b32 v[186:187], v4 offset0:2 offset1:3
v_add_u32 v8, 26112, v2
v_add_u32 v9, 27136, v2
v_add_u32 v10, 28160, v2
v_add_u32 v11, 29184, v2
v_add_u32 v13, 26112, v3
s_waitcnt lgkmcnt(14)
v_mfma_f32_16x16x32_bf16 v[28:31], v[156:159], v[92:95], 0
ds_read_b128 v[124:127], v13 offset:0
v_mfma_f32_16x16x32_bf16 v[32:35], v[156:159], v[96:99], 0
ds_read_b128 v[128:131], v13 offset:512
v_mfma_f32_16x16x32_bf16 v[36:39], v[156:159], v[100:103], 0
v_mfma_f32_16x16x32_bf16 v[40:43], v[156:159], v[104:107], 0
v_mfma_f32_16x16x32_bf16 v[44:47], v[156:159], v[108:111], 0
v_mfma_f32_16x16x32_bf16 v[48:51], v[156:159], v[112:115], 0
v_mfma_f32_16x16x32_bf16 v[52:55], v[156:159], v[116:119], 0
v_mfma_f32_16x16x32_bf16 v[56:59], v[156:159], v[120:123], 0
ds_read2_b32 v[156:157], v11 offset0:128 offset1:129
ds_read2_b32 v[158:159], v11 offset0:130 offset1:131
s_waitcnt lgkmcnt(15)
v_mfma_f32_16x16x32_bf16 v[32:35], v[160:163], v[92:95], v[32:35]
ds_read_b128 v[132:135], v13 offset:1024
v_mfma_f32_16x16x32_bf16 v[36:39], v[160:163], v[96:99], v[36:39]
ds_read_b128 v[136:139], v13 offset:1536
v_mfma_f32_16x16x32_bf16 v[40:43], v[160:163], v[100:103], v[40:43]
v_mfma_f32_16x16x32_bf16 v[44:47], v[160:163], v[104:107], v[44:47]
v_mfma_f32_16x16x32_bf16 v[48:51], v[160:163], v[108:111], v[48:51]
v_mfma_f32_16x16x32_bf16 v[52:55], v[160:163], v[112:115], v[52:55]
v_mfma_f32_16x16x32_bf16 v[56:59], v[160:163], v[116:119], v[56:59]
ds_read2_b32 v[160:161], v11 offset0:0 offset1:1
ds_read2_b32 v[162:163], v11 offset0:2 offset1:3
s_waitcnt lgkmcnt(15)
v_mfma_f32_16x16x32_bf16 v[36:39], v[164:167], v[92:95], v[36:39]
ds_read_b128 v[140:143], v13 offset:2048
v_mfma_f32_16x16x32_bf16 v[40:43], v[164:167], v[96:99], v[40:43]
ds_read_b128 v[144:147], v13 offset:2560
v_mfma_f32_16x16x32_bf16 v[44:47], v[164:167], v[100:103], v[44:47]
v_mfma_f32_16x16x32_bf16 v[48:51], v[164:167], v[104:107], v[48:51]
v_mfma_f32_16x16x32_bf16 v[52:55], v[164:167], v[108:111], v[52:55]
v_mfma_f32_16x16x32_bf16 v[56:59], v[164:167], v[112:115], v[56:59]
ds_read2_b32 v[164:165], v10 offset0:128 offset1:129
ds_read2_b32 v[166:167], v10 offset0:130 offset1:131
s_waitcnt lgkmcnt(15)
v_mfma_f32_16x16x32_bf16 v[40:43], v[168:171], v[92:95], v[40:43]
ds_read_b128 v[148:151], v13 offset:3072
v_mfma_f32_16x16x32_bf16 v[44:47], v[168:171], v[96:99], v[44:47]
ds_read_b128 v[152:155], v13 offset:3584
v_mfma_f32_16x16x32_bf16 v[48:51], v[168:171], v[100:103], v[48:51]
v_mfma_f32_16x16x32_bf16 v[52:55], v[168:171], v[104:107], v[52:55]
v_mfma_f32_16x16x32_bf16 v[56:59], v[168:171], v[108:111], v[56:59]
ds_read2_b32 v[168:169], v10 offset0:0 offset1:1
ds_read2_b32 v[170:171], v10 offset0:2 offset1:3
s_waitcnt lgkmcnt(15)
v_mfma_f32_16x16x32_bf16 v[44:47], v[172:175], v[92:95], v[44:47]
v_mfma_f32_16x16x32_bf16 v[48:51], v[172:175], v[96:99], v[48:51]
v_mfma_f32_16x16x32_bf16 v[52:55], v[172:175], v[100:103], v[52:55]
v_mfma_f32_16x16x32_bf16 v[56:59], v[172:175], v[104:107], v[56:59]
ds_read2_b32 v[172:173], v9 offset0:128 offset1:129
ds_read2_b32 v[174:175], v9 offset0:130 offset1:131
s_waitcnt lgkmcnt(15)
v_mfma_f32_16x16x32_bf16 v[48:51], v[176:179], v[92:95], v[48:51]
v_mfma_f32_16x16x32_bf16 v[52:55], v[176:179], v[96:99], v[52:55]
v_mfma_f32_16x16x32_bf16 v[56:59], v[176:179], v[100:103], v[56:59]
ds_read2_b32 v[176:177], v9 offset0:0 offset1:1
ds_read2_b32 v[178:179], v9 offset0:2 offset1:3
s_waitcnt lgkmcnt(15)
v_mfma_f32_16x16x32_bf16 v[52:55], v[180:183], v[92:95], v[52:55]
v_mfma_f32_16x16x32_bf16 v[56:59], v[180:183], v[96:99], v[56:59]
ds_read2_b32 v[180:181], v8 offset0:128 offset1:129
ds_read2_b32 v[182:183], v8 offset0:130 offset1:131
s_waitcnt lgkmcnt(15)
v_mfma_f32_16x16x32_bf16 v[56:59], v[184:187], v[92:95], v[56:59]
ds_read2_b32 v[184:185], v8 offset0:0 offset1:1
ds_read2_b32 v[186:187], v8 offset0:2 offset1:3
v_lshlrev_b32 v22, 4, v1
v_add_u32 v22, 125184, v22
ds_write_b128 v22, v[28:31] offset:0
ds_write_b128 v22, v[32:35] offset:1024
ds_write_b128 v22, v[36:39] offset:2048
ds_write_b128 v22, v[40:43] offset:3072
ds_write_b128 v22, v[44:47] offset:4096
ds_write_b128 v22, v[48:51] offset:5120
ds_write_b128 v22, v[52:55] offset:6144
ds_write_b128 v22, v[56:59] offset:7168
v_add_u32 v4, 26048, v2
v_add_u32 v5, 27072, v2
v_add_u32 v6, 28096, v2
v_add_u32 v7, 29120, v2
v_add_u32 v12, 26048, v3
s_waitcnt lgkmcnt(15)
v_mfma_f32_16x16x32_bf16 v[60:63], v[156:159], v[124:127], 0
ds_read_b128 v[92:95], v12 offset:0
v_mfma_f32_16x16x32_bf16 v[72:75], v[156:159], v[136:139], 0
ds_read_b128 v[96:99], v12 offset:512
v_mfma_f32_16x16x32_bf16 v[76:79], v[156:159], v[140:143], 0
v_mfma_f32_16x16x32_bf16 v[88:91], v[156:159], v[152:155], 0
ds_read2_b32 v[156:157], v7 offset0:128 offset1:129
ds_read2_b32 v[158:159], v7 offset0:130 offset1:131
s_waitcnt lgkmcnt(15)
v_mfma_f32_16x16x32_bf16 v[72:75], v[160:163], v[132:135], v[72:75]
ds_read_b128 v[100:103], v12 offset:1024
v_mfma_f32_16x16x32_bf16 v[76:79], v[160:163], v[136:139], v[76:79]
ds_read_b128 v[104:107], v12 offset:1536
v_mfma_f32_16x16x32_bf16 v[88:91], v[160:163], v[148:151], v[88:91]
ds_read2_b32 v[160:161], v7 offset0:0 offset1:1
ds_read2_b32 v[162:163], v7 offset0:2 offset1:3
s_waitcnt lgkmcnt(15)
v_mfma_f32_16x16x32_bf16 v[72:75], v[164:167], v[128:131], v[72:75]
ds_read_b128 v[108:111], v12 offset:2048
v_mfma_f32_16x16x32_bf16 v[76:79], v[164:167], v[132:135], v[76:79]
ds_read_b128 v[112:115], v12 offset:2560
v_mfma_f32_16x16x32_bf16 v[88:91], v[164:167], v[144:147], v[88:91]
ds_read2_b32 v[164:165], v6 offset0:128 offset1:129
ds_read2_b32 v[166:167], v6 offset0:130 offset1:131
s_waitcnt lgkmcnt(15)
v_mfma_f32_16x16x32_bf16 v[72:75], v[168:171], v[124:127], v[72:75]
ds_read_b128 v[116:119], v12 offset:3072
v_mfma_f32_16x16x32_bf16 v[76:79], v[168:171], v[128:131], v[76:79]
ds_read_b128 v[120:123], v12 offset:3584
v_mfma_f32_16x16x32_bf16 v[88:91], v[168:171], v[140:143], v[88:91]
ds_read2_b32 v[168:169], v6 offset0:0 offset1:1
ds_read2_b32 v[170:171], v6 offset0:2 offset1:3
s_waitcnt lgkmcnt(15)
v_mfma_f32_16x16x32_bf16 v[76:79], v[172:175], v[124:127], v[76:79]
v_mfma_f32_16x16x32_bf16 v[88:91], v[172:175], v[136:139], v[88:91]
ds_read2_b32 v[172:173], v5 offset0:128 offset1:129
ds_read2_b32 v[174:175], v5 offset0:130 offset1:131
s_waitcnt lgkmcnt(15)
v_mfma_f32_16x16x32_bf16 v[88:91], v[176:179], v[132:135], v[88:91]
ds_read2_b32 v[176:177], v5 offset0:0 offset1:1
ds_read2_b32 v[178:179], v5 offset0:2 offset1:3
s_waitcnt lgkmcnt(15)
v_mfma_f32_16x16x32_bf16 v[88:91], v[180:183], v[128:131], v[88:91]
ds_read2_b32 v[180:181], v4 offset0:128 offset1:129
ds_read2_b32 v[182:183], v4 offset0:130 offset1:131
s_waitcnt lgkmcnt(15)
v_mfma_f32_16x16x32_bf16 v[88:91], v[184:187], v[124:127], v[88:91]
ds_read2_b32 v[184:185], v4 offset0:0 offset1:1
ds_read2_b32 v[186:187], v4 offset0:2 offset1:3
v_add_u32 v8, 25984, v2
v_add_u32 v9, 27008, v2
v_add_u32 v10, 28032, v2
v_add_u32 v11, 29056, v2
v_add_u32 v13, 25984, v3
s_waitcnt lgkmcnt(10)
v_mfma_f32_16x16x32_bf16 v[60:63], v[156:159], v[92:95], v[60:63]
ds_read_b128 v[124:127], v13 offset:0
v_mfma_f32_16x16x32_bf16 v[72:75], v[156:159], v[104:107], v[72:75]
ds_read_b128 v[128:131], v13 offset:512
v_mfma_f32_16x16x32_bf16 v[76:79], v[156:159], v[108:111], v[76:79]
v_mfma_f32_16x16x32_bf16 v[88:91], v[156:159], v[120:123], v[88:91]
ds_read2_b32 v[156:157], v11 offset0:128 offset1:129
ds_read2_b32 v[158:159], v11 offset0:130 offset1:131
s_waitcnt lgkmcnt(15)
v_mfma_f32_16x16x32_bf16 v[72:75], v[160:163], v[100:103], v[72:75]
ds_read_b128 v[132:135], v13 offset:1024
v_mfma_f32_16x16x32_bf16 v[76:79], v[160:163], v[104:107], v[76:79]
ds_read_b128 v[136:139], v13 offset:1536
v_mfma_f32_16x16x32_bf16 v[88:91], v[160:163], v[116:119], v[88:91]
ds_read2_b32 v[160:161], v11 offset0:0 offset1:1
ds_read2_b32 v[162:163], v11 offset0:2 offset1:3
s_waitcnt lgkmcnt(15)
v_mfma_f32_16x16x32_bf16 v[72:75], v[164:167], v[96:99], v[72:75]
ds_read_b128 v[140:143], v13 offset:2048
v_mfma_f32_16x16x32_bf16 v[76:79], v[164:167], v[100:103], v[76:79]
ds_read_b128 v[144:147], v13 offset:2560
v_mfma_f32_16x16x32_bf16 v[88:91], v[164:167], v[112:115], v[88:91]
ds_read2_b32 v[164:165], v10 offset0:128 offset1:129
ds_read2_b32 v[166:167], v10 offset0:130 offset1:131
s_waitcnt lgkmcnt(15)
v_mfma_f32_16x16x32_bf16 v[72:75], v[168:171], v[92:95], v[72:75]
ds_read_b128 v[148:151], v13 offset:3072
v_mfma_f32_16x16x32_bf16 v[76:79], v[168:171], v[96:99], v[76:79]
ds_read_b128 v[152:155], v13 offset:3584
v_mfma_f32_16x16x32_bf16 v[88:91], v[168:171], v[108:111], v[88:91]
ds_read2_b32 v[168:169], v10 offset0:0 offset1:1
ds_read2_b32 v[170:171], v10 offset0:2 offset1:3
s_waitcnt lgkmcnt(15)
v_mfma_f32_16x16x32_bf16 v[76:79], v[172:175], v[92:95], v[76:79]
v_mfma_f32_16x16x32_bf16 v[88:91], v[172:175], v[104:107], v[88:91]
ds_read2_b32 v[172:173], v9 offset0:128 offset1:129
ds_read2_b32 v[174:175], v9 offset0:130 offset1:131
s_waitcnt lgkmcnt(15)
v_mfma_f32_16x16x32_bf16 v[88:91], v[176:179], v[100:103], v[88:91]
ds_read2_b32 v[176:177], v9 offset0:0 offset1:1
ds_read2_b32 v[178:179], v9 offset0:2 offset1:3
s_waitcnt lgkmcnt(15)
v_mfma_f32_16x16x32_bf16 v[88:91], v[180:183], v[96:99], v[88:91]
ds_read2_b32 v[180:181], v8 offset0:128 offset1:129
ds_read2_b32 v[182:183], v8 offset0:130 offset1:131
s_waitcnt lgkmcnt(15)
v_mfma_f32_16x16x32_bf16 v[88:91], v[184:187], v[92:95], v[88:91]
ds_read2_b32 v[184:185], v8 offset0:0 offset1:1
ds_read2_b32 v[186:187], v8 offset0:2 offset1:3
v_add_u32 v4, 25920, v2
v_add_u32 v5, 26944, v2
v_add_u32 v6, 27968, v2
v_add_u32 v7, 28992, v2
v_add_u32 v12, 25920, v3
s_waitcnt lgkmcnt(10)
v_mfma_f32_16x16x32_bf16 v[60:63], v[156:159], v[124:127], v[60:63]
ds_read_b128 v[92:95], v12 offset:0
v_mfma_f32_16x16x32_bf16 v[72:75], v[156:159], v[136:139], v[72:75]
ds_read_b128 v[96:99], v12 offset:512
v_mfma_f32_16x16x32_bf16 v[76:79], v[156:159], v[140:143], v[76:79]
v_mfma_f32_16x16x32_bf16 v[88:91], v[156:159], v[152:155], v[88:91]
ds_read2_b32 v[156:157], v7 offset0:128 offset1:129
ds_read2_b32 v[158:159], v7 offset0:130 offset1:131
s_waitcnt lgkmcnt(15)
v_mfma_f32_16x16x32_bf16 v[72:75], v[160:163], v[132:135], v[72:75]
ds_read_b128 v[100:103], v12 offset:1024
v_mfma_f32_16x16x32_bf16 v[76:79], v[160:163], v[136:139], v[76:79]
ds_read_b128 v[104:107], v12 offset:1536
v_mfma_f32_16x16x32_bf16 v[88:91], v[160:163], v[148:151], v[88:91]
ds_read2_b32 v[160:161], v7 offset0:0 offset1:1
ds_read2_b32 v[162:163], v7 offset0:2 offset1:3
s_waitcnt lgkmcnt(15)
v_mfma_f32_16x16x32_bf16 v[72:75], v[164:167], v[128:131], v[72:75]
ds_read_b128 v[108:111], v12 offset:2048
v_mfma_f32_16x16x32_bf16 v[76:79], v[164:167], v[132:135], v[76:79]
ds_read_b128 v[112:115], v12 offset:2560
v_mfma_f32_16x16x32_bf16 v[88:91], v[164:167], v[144:147], v[88:91]
ds_read2_b32 v[164:165], v6 offset0:128 offset1:129
ds_read2_b32 v[166:167], v6 offset0:130 offset1:131
s_waitcnt lgkmcnt(15)
v_mfma_f32_16x16x32_bf16 v[72:75], v[168:171], v[124:127], v[72:75]
ds_read_b128 v[116:119], v12 offset:3072
v_mfma_f32_16x16x32_bf16 v[76:79], v[168:171], v[128:131], v[76:79]
ds_read_b128 v[120:123], v12 offset:3584
v_mfma_f32_16x16x32_bf16 v[88:91], v[168:171], v[140:143], v[88:91]
ds_read2_b32 v[168:169], v6 offset0:0 offset1:1
ds_read2_b32 v[170:171], v6 offset0:2 offset1:3
s_waitcnt lgkmcnt(15)
v_mfma_f32_16x16x32_bf16 v[76:79], v[172:175], v[124:127], v[76:79]
v_mfma_f32_16x16x32_bf16 v[88:91], v[172:175], v[136:139], v[88:91]
ds_read2_b32 v[172:173], v5 offset0:128 offset1:129
ds_read2_b32 v[174:175], v5 offset0:130 offset1:131
s_waitcnt lgkmcnt(15)
v_mfma_f32_16x16x32_bf16 v[88:91], v[176:179], v[132:135], v[88:91]
ds_read2_b32 v[176:177], v5 offset0:0 offset1:1
ds_read2_b32 v[178:179], v5 offset0:2 offset1:3
s_waitcnt lgkmcnt(15)
v_mfma_f32_16x16x32_bf16 v[88:91], v[180:183], v[128:131], v[88:91]
ds_read2_b32 v[180:181], v4 offset0:128 offset1:129
ds_read2_b32 v[182:183], v4 offset0:130 offset1:131
s_waitcnt lgkmcnt(15)
v_mfma_f32_16x16x32_bf16 v[88:91], v[184:187], v[124:127], v[88:91]
ds_read2_b32 v[184:185], v4 offset0:0 offset1:1
ds_read2_b32 v[186:187], v4 offset0:2 offset1:3
v_add_u32 v8, 25856, v2
v_add_u32 v9, 26880, v2
v_add_u32 v10, 27904, v2
v_add_u32 v11, 28928, v2
v_add_u32 v13, 25856, v3
s_waitcnt lgkmcnt(10)
v_mfma_f32_16x16x32_bf16 v[60:63], v[156:159], v[92:95], v[60:63]
ds_read_b128 v[124:127], v13 offset:0
v_mfma_f32_16x16x32_bf16 v[72:75], v[156:159], v[104:107], v[72:75]
ds_read_b128 v[128:131], v13 offset:512
v_mfma_f32_16x16x32_bf16 v[76:79], v[156:159], v[108:111], v[76:79]
v_mfma_f32_16x16x32_bf16 v[88:91], v[156:159], v[120:123], v[88:91]
ds_read2_b32 v[156:157], v11 offset0:128 offset1:129
ds_read2_b32 v[158:159], v11 offset0:130 offset1:131
s_waitcnt lgkmcnt(15)
v_mfma_f32_16x16x32_bf16 v[72:75], v[160:163], v[100:103], v[72:75]
ds_read_b128 v[132:135], v13 offset:1024
v_mfma_f32_16x16x32_bf16 v[76:79], v[160:163], v[104:107], v[76:79]
ds_read_b128 v[136:139], v13 offset:1536
v_mfma_f32_16x16x32_bf16 v[88:91], v[160:163], v[116:119], v[88:91]
ds_read2_b32 v[160:161], v11 offset0:0 offset1:1
ds_read2_b32 v[162:163], v11 offset0:2 offset1:3
s_waitcnt lgkmcnt(15)
v_mfma_f32_16x16x32_bf16 v[72:75], v[164:167], v[96:99], v[72:75]
ds_read_b128 v[140:143], v13 offset:2048
v_mfma_f32_16x16x32_bf16 v[76:79], v[164:167], v[100:103], v[76:79]
ds_read_b128 v[144:147], v13 offset:2560
v_mfma_f32_16x16x32_bf16 v[88:91], v[164:167], v[112:115], v[88:91]
ds_read2_b32 v[164:165], v10 offset0:128 offset1:129
ds_read2_b32 v[166:167], v10 offset0:130 offset1:131
s_waitcnt lgkmcnt(15)
v_mfma_f32_16x16x32_bf16 v[72:75], v[168:171], v[92:95], v[72:75]
ds_read_b128 v[148:151], v13 offset:3072
v_mfma_f32_16x16x32_bf16 v[76:79], v[168:171], v[96:99], v[76:79]
ds_read_b128 v[152:155], v13 offset:3584
v_mfma_f32_16x16x32_bf16 v[88:91], v[168:171], v[108:111], v[88:91]
ds_read2_b32 v[168:169], v10 offset0:0 offset1:1
ds_read2_b32 v[170:171], v10 offset0:2 offset1:3
s_waitcnt lgkmcnt(15)
v_mfma_f32_16x16x32_bf16 v[76:79], v[172:175], v[92:95], v[76:79]
v_mfma_f32_16x16x32_bf16 v[88:91], v[172:175], v[104:107], v[88:91]
ds_read2_b32 v[172:173], v9 offset0:128 offset1:129
ds_read2_b32 v[174:175], v9 offset0:130 offset1:131
s_waitcnt lgkmcnt(15)
v_mfma_f32_16x16x32_bf16 v[88:91], v[176:179], v[100:103], v[88:91]
ds_read2_b32 v[176:177], v9 offset0:0 offset1:1
ds_read2_b32 v[178:179], v9 offset0:2 offset1:3
s_waitcnt lgkmcnt(15)
v_mfma_f32_16x16x32_bf16 v[88:91], v[180:183], v[96:99], v[88:91]
ds_read2_b32 v[180:181], v8 offset0:128 offset1:129
ds_read2_b32 v[182:183], v8 offset0:130 offset1:131
s_waitcnt lgkmcnt(15)
v_mfma_f32_16x16x32_bf16 v[88:91], v[184:187], v[92:95], v[88:91]
ds_read2_b32 v[184:185], v8 offset0:0 offset1:1
ds_read2_b32 v[186:187], v8 offset0:2 offset1:3
v_add_u32 v4, 25792, v2
v_add_u32 v5, 26816, v2
v_add_u32 v6, 27840, v2
v_add_u32 v7, 28864, v2
v_add_u32 v12, 25792, v3
s_waitcnt lgkmcnt(10)
v_mfma_f32_16x16x32_bf16 v[60:63], v[156:159], v[124:127], v[60:63]
ds_read_b128 v[92:95], v12 offset:0
v_mfma_f32_16x16x32_bf16 v[72:75], v[156:159], v[136:139], v[72:75]
ds_read_b128 v[96:99], v12 offset:512
v_mfma_f32_16x16x32_bf16 v[76:79], v[156:159], v[140:143], v[76:79]
v_mfma_f32_16x16x32_bf16 v[88:91], v[156:159], v[152:155], v[88:91]
ds_read2_b32 v[156:157], v7 offset0:128 offset1:129
ds_read2_b32 v[158:159], v7 offset0:130 offset1:131
s_waitcnt lgkmcnt(15)
v_mfma_f32_16x16x32_bf16 v[72:75], v[160:163], v[132:135], v[72:75]
ds_read_b128 v[100:103], v12 offset:1024
v_mfma_f32_16x16x32_bf16 v[76:79], v[160:163], v[136:139], v[76:79]
ds_read_b128 v[104:107], v12 offset:1536
v_mfma_f32_16x16x32_bf16 v[88:91], v[160:163], v[148:151], v[88:91]
ds_read2_b32 v[160:161], v7 offset0:0 offset1:1
ds_read2_b32 v[162:163], v7 offset0:2 offset1:3
s_waitcnt lgkmcnt(15)
v_mfma_f32_16x16x32_bf16 v[72:75], v[164:167], v[128:131], v[72:75]
ds_read_b128 v[108:111], v12 offset:2048
v_mfma_f32_16x16x32_bf16 v[76:79], v[164:167], v[132:135], v[76:79]
ds_read_b128 v[112:115], v12 offset:2560
v_mfma_f32_16x16x32_bf16 v[88:91], v[164:167], v[144:147], v[88:91]
ds_read2_b32 v[164:165], v6 offset0:128 offset1:129
ds_read2_b32 v[166:167], v6 offset0:130 offset1:131
s_waitcnt lgkmcnt(15)
v_mfma_f32_16x16x32_bf16 v[72:75], v[168:171], v[124:127], v[72:75]
ds_read_b128 v[116:119], v12 offset:3072
v_mfma_f32_16x16x32_bf16 v[76:79], v[168:171], v[128:131], v[76:79]
ds_read_b128 v[120:123], v12 offset:3584
v_mfma_f32_16x16x32_bf16 v[88:91], v[168:171], v[140:143], v[88:91]
ds_read2_b32 v[168:169], v6 offset0:0 offset1:1
ds_read2_b32 v[170:171], v6 offset0:2 offset1:3
s_waitcnt lgkmcnt(15)
v_mfma_f32_16x16x32_bf16 v[76:79], v[172:175], v[124:127], v[76:79]
v_mfma_f32_16x16x32_bf16 v[88:91], v[172:175], v[136:139], v[88:91]
ds_read2_b32 v[172:173], v5 offset0:128 offset1:129
ds_read2_b32 v[174:175], v5 offset0:130 offset1:131
s_waitcnt lgkmcnt(15)
v_mfma_f32_16x16x32_bf16 v[88:91], v[176:179], v[132:135], v[88:91]
ds_read2_b32 v[176:177], v5 offset0:0 offset1:1
ds_read2_b32 v[178:179], v5 offset0:2 offset1:3
s_waitcnt lgkmcnt(15)
v_mfma_f32_16x16x32_bf16 v[88:91], v[180:183], v[128:131], v[88:91]
ds_read2_b32 v[180:181], v4 offset0:128 offset1:129
ds_read2_b32 v[182:183], v4 offset0:130 offset1:131
s_waitcnt lgkmcnt(15)
v_mfma_f32_16x16x32_bf16 v[88:91], v[184:187], v[124:127], v[88:91]
ds_read2_b32 v[184:185], v4 offset0:0 offset1:1
ds_read2_b32 v[186:187], v4 offset0:2 offset1:3
v_add_u32 v8, 25728, v2
v_add_u32 v9, 26752, v2
v_add_u32 v10, 27776, v2
v_add_u32 v11, 28800, v2
v_add_u32 v13, 25728, v3
s_waitcnt lgkmcnt(10)
v_mfma_f32_16x16x32_bf16 v[60:63], v[156:159], v[92:95], v[60:63]
ds_read_b128 v[124:127], v13 offset:0
v_mfma_f32_16x16x32_bf16 v[72:75], v[156:159], v[104:107], v[72:75]
ds_read_b128 v[128:131], v13 offset:512
v_mfma_f32_16x16x32_bf16 v[76:79], v[156:159], v[108:111], v[76:79]
v_mfma_f32_16x16x32_bf16 v[88:91], v[156:159], v[120:123], v[88:91]
ds_read2_b32 v[156:157], v11 offset0:128 offset1:129
ds_read2_b32 v[158:159], v11 offset0:130 offset1:131
s_waitcnt lgkmcnt(15)
v_mfma_f32_16x16x32_bf16 v[72:75], v[160:163], v[100:103], v[72:75]
ds_read_b128 v[132:135], v13 offset:1024
v_mfma_f32_16x16x32_bf16 v[76:79], v[160:163], v[104:107], v[76:79]
ds_read_b128 v[136:139], v13 offset:1536
v_mfma_f32_16x16x32_bf16 v[88:91], v[160:163], v[116:119], v[88:91]
ds_read2_b32 v[160:161], v11 offset0:0 offset1:1
ds_read2_b32 v[162:163], v11 offset0:2 offset1:3
s_waitcnt lgkmcnt(15)
v_mfma_f32_16x16x32_bf16 v[72:75], v[164:167], v[96:99], v[72:75]
ds_read_b128 v[140:143], v13 offset:2048
v_mfma_f32_16x16x32_bf16 v[76:79], v[164:167], v[100:103], v[76:79]
ds_read_b128 v[144:147], v13 offset:2560
v_mfma_f32_16x16x32_bf16 v[88:91], v[164:167], v[112:115], v[88:91]
ds_read2_b32 v[164:165], v10 offset0:128 offset1:129
ds_read2_b32 v[166:167], v10 offset0:130 offset1:131
s_waitcnt lgkmcnt(15)
v_mfma_f32_16x16x32_bf16 v[72:75], v[168:171], v[92:95], v[72:75]
ds_read_b128 v[148:151], v13 offset:3072
v_mfma_f32_16x16x32_bf16 v[76:79], v[168:171], v[96:99], v[76:79]
ds_read_b128 v[152:155], v13 offset:3584
v_mfma_f32_16x16x32_bf16 v[88:91], v[168:171], v[108:111], v[88:91]
ds_read2_b32 v[168:169], v10 offset0:0 offset1:1
ds_read2_b32 v[170:171], v10 offset0:2 offset1:3
s_waitcnt lgkmcnt(15)
v_mfma_f32_16x16x32_bf16 v[76:79], v[172:175], v[92:95], v[76:79]
v_mfma_f32_16x16x32_bf16 v[88:91], v[172:175], v[104:107], v[88:91]
ds_read2_b32 v[172:173], v9 offset0:128 offset1:129
ds_read2_b32 v[174:175], v9 offset0:130 offset1:131
s_waitcnt lgkmcnt(15)
v_mfma_f32_16x16x32_bf16 v[88:91], v[176:179], v[100:103], v[88:91]
ds_read2_b32 v[176:177], v9 offset0:0 offset1:1
ds_read2_b32 v[178:179], v9 offset0:2 offset1:3
s_waitcnt lgkmcnt(15)
v_mfma_f32_16x16x32_bf16 v[88:91], v[180:183], v[96:99], v[88:91]
ds_read2_b32 v[180:181], v8 offset0:128 offset1:129
ds_read2_b32 v[182:183], v8 offset0:130 offset1:131
s_waitcnt lgkmcnt(15)
v_mfma_f32_16x16x32_bf16 v[88:91], v[184:187], v[92:95], v[88:91]
ds_read2_b32 v[184:185], v8 offset0:0 offset1:1
ds_read2_b32 v[186:187], v8 offset0:2 offset1:3
v_add_u32 v4, 25664, v2
v_add_u32 v5, 26688, v2
v_add_u32 v6, 27712, v2
v_add_u32 v7, 28736, v2
v_add_u32 v12, 25664, v3
s_waitcnt lgkmcnt(10)
v_mfma_f32_16x16x32_bf16 v[60:63], v[156:159], v[124:127], v[60:63]
ds_read_b128 v[92:95], v12 offset:0
v_mfma_f32_16x16x32_bf16 v[72:75], v[156:159], v[136:139], v[72:75]
ds_read_b128 v[96:99], v12 offset:512
v_mfma_f32_16x16x32_bf16 v[76:79], v[156:159], v[140:143], v[76:79]
v_mfma_f32_16x16x32_bf16 v[88:91], v[156:159], v[152:155], v[88:91]
ds_read2_b32 v[156:157], v7 offset0:128 offset1:129
ds_read2_b32 v[158:159], v7 offset0:130 offset1:131
s_waitcnt lgkmcnt(15)
v_mfma_f32_16x16x32_bf16 v[72:75], v[160:163], v[132:135], v[72:75]
ds_read_b128 v[100:103], v12 offset:1024
v_mfma_f32_16x16x32_bf16 v[76:79], v[160:163], v[136:139], v[76:79]
ds_read_b128 v[104:107], v12 offset:1536
v_mfma_f32_16x16x32_bf16 v[88:91], v[160:163], v[148:151], v[88:91]
ds_read2_b32 v[160:161], v7 offset0:0 offset1:1
ds_read2_b32 v[162:163], v7 offset0:2 offset1:3
s_waitcnt lgkmcnt(15)
v_mfma_f32_16x16x32_bf16 v[72:75], v[164:167], v[128:131], v[72:75]
ds_read_b128 v[108:111], v12 offset:2048
v_mfma_f32_16x16x32_bf16 v[76:79], v[164:167], v[132:135], v[76:79]
ds_read_b128 v[112:115], v12 offset:2560
v_mfma_f32_16x16x32_bf16 v[88:91], v[164:167], v[144:147], v[88:91]
ds_read2_b32 v[164:165], v6 offset0:128 offset1:129
ds_read2_b32 v[166:167], v6 offset0:130 offset1:131
s_waitcnt lgkmcnt(15)
v_mfma_f32_16x16x32_bf16 v[72:75], v[168:171], v[124:127], v[72:75]
ds_read_b128 v[116:119], v12 offset:3072
v_mfma_f32_16x16x32_bf16 v[76:79], v[168:171], v[128:131], v[76:79]
ds_read_b128 v[120:123], v12 offset:3584
v_mfma_f32_16x16x32_bf16 v[88:91], v[168:171], v[140:143], v[88:91]
ds_read2_b32 v[168:169], v6 offset0:0 offset1:1
ds_read2_b32 v[170:171], v6 offset0:2 offset1:3
s_waitcnt lgkmcnt(15)
v_mfma_f32_16x16x32_bf16 v[76:79], v[172:175], v[124:127], v[76:79]
v_mfma_f32_16x16x32_bf16 v[88:91], v[172:175], v[136:139], v[88:91]
ds_read2_b32 v[172:173], v5 offset0:128 offset1:129
ds_read2_b32 v[174:175], v5 offset0:130 offset1:131
s_waitcnt lgkmcnt(15)
v_mfma_f32_16x16x32_bf16 v[88:91], v[176:179], v[132:135], v[88:91]
ds_read2_b32 v[176:177], v5 offset0:0 offset1:1
ds_read2_b32 v[178:179], v5 offset0:2 offset1:3
s_waitcnt lgkmcnt(15)
v_mfma_f32_16x16x32_bf16 v[88:91], v[180:183], v[128:131], v[88:91]
ds_read2_b32 v[180:181], v4 offset0:128 offset1:129
ds_read2_b32 v[182:183], v4 offset0:130 offset1:131
s_waitcnt lgkmcnt(15)
v_mfma_f32_16x16x32_bf16 v[88:91], v[184:187], v[124:127], v[88:91]
ds_read2_b32 v[184:185], v4 offset0:0 offset1:1
ds_read2_b32 v[186:187], v4 offset0:2 offset1:3
s_waitcnt lgkmcnt(10)
v_mfma_f32_16x16x32_bf16 v[60:63], v[156:159], v[92:95], v[60:63]
v_mfma_f32_16x16x32_bf16 v[72:75], v[156:159], v[104:107], v[72:75]
v_mfma_f32_16x16x32_bf16 v[76:79], v[156:159], v[108:111], v[76:79]
v_mfma_f32_16x16x32_bf16 v[88:91], v[156:159], v[120:123], v[88:91]
s_waitcnt lgkmcnt(11)
v_mfma_f32_16x16x32_bf16 v[72:75], v[160:163], v[100:103], v[72:75]
v_mfma_f32_16x16x32_bf16 v[76:79], v[160:163], v[104:107], v[76:79]
v_mfma_f32_16x16x32_bf16 v[88:91], v[160:163], v[116:119], v[88:91]
s_waitcnt lgkmcnt(12)
v_mfma_f32_16x16x32_bf16 v[72:75], v[164:167], v[96:99], v[72:75]
v_mfma_f32_16x16x32_bf16 v[76:79], v[164:167], v[100:103], v[76:79]
v_mfma_f32_16x16x32_bf16 v[88:91], v[164:167], v[112:115], v[88:91]
s_waitcnt lgkmcnt(8)
v_mfma_f32_16x16x32_bf16 v[72:75], v[168:171], v[92:95], v[72:75]
v_mfma_f32_16x16x32_bf16 v[76:79], v[168:171], v[96:99], v[76:79]
v_mfma_f32_16x16x32_bf16 v[88:91], v[168:171], v[108:111], v[88:91]
s_waitcnt lgkmcnt(6)
v_mfma_f32_16x16x32_bf16 v[76:79], v[172:175], v[92:95], v[76:79]
v_mfma_f32_16x16x32_bf16 v[88:91], v[172:175], v[104:107], v[88:91]
s_waitcnt lgkmcnt(4)
v_mfma_f32_16x16x32_bf16 v[88:91], v[176:179], v[100:103], v[88:91]
s_waitcnt lgkmcnt(2)
v_mfma_f32_16x16x32_bf16 v[88:91], v[180:183], v[96:99], v[88:91]
s_waitcnt lgkmcnt(0)
v_mfma_f32_16x16x32_bf16 v[88:91], v[184:187], v[92:95], v[88:91]
s_waitcnt lgkmcnt(0)
s_waitcnt vmcnt(0)
v_lshlrev_b32 v244, 16, v244
v_lshlrev_b32 v245, 16, v245
v_lshlrev_b32 v246, 16, v246
s_waitcnt lgkmcnt(0)
v_mov_b32 v14, 153868
v_mov_b32 v15, 3
ds_write_b32 v14, v15
v_lshlrev_b32 v14, 4, v1
v_and_b32 v16, 15, v1
v_lshrrev_b32 v17, 4, v1
v_lshlrev_b32 v18, 5, v16
v_lshl_add_u32 v19, v17, 3, v18
v_add_u32 v19, 96256, v19
ds_read_b64 v[156:157], v19 offset:0
ds_read_b64 v[158:159], v19 offset:1536
ds_read_b64 v[160:161], v19 offset:2048
ds_read_b64 v[162:163], v19 offset:3584
v_lshrrev_b32 v20, 1, v17
v_lshl_add_u32 v20, v20, 4, v18
v_and_b32 v21, 1, v17
v_mul_u32_u24 v22, 1536, v21
v_add_u32 v22, v22, v20
s_lshl_b32 s20, s10, 12
s_add_u32 s20, s20, 14745600
s_waitcnt lgkmcnt(0)
v_lshlrev_b32 v196, 16, v156
v_and_b32 v197, 0xffff0000, v156
v_lshlrev_b32 v198, 16, v157
v_and_b32 v199, 0xffff0000, v157
v_fma_f32 v60, v196, v246, v60
v_fma_f32 v61, v197, v246, v61
v_fma_f32 v62, v198, v246, v62
v_fma_f32 v63, v199, v246, v63
v_cvt_pk_bf16_f32 v188, v60, v61
v_cvt_pk_bf16_f32 v189, v62, v63
v_lshlrev_b32 v200, 16, v158
v_and_b32 v201, 0xffff0000, v158
v_lshlrev_b32 v202, 16, v159
v_and_b32 v203, 0xffff0000, v159
v_fma_f32 v72, v200, v246, v72
v_fma_f32 v73, v201, v246, v73
v_fma_f32 v74, v202, v246, v74
v_fma_f32 v75, v203, v246, v75
v_cvt_pk_bf16_f32 v190, v72, v73
v_cvt_pk_bf16_f32 v191, v74, v75
s_nop 0
v_permlane16_swap_b32 v188, v190
v_permlane16_swap_b32 v189, v191
buffer_store_dwordx4 v[188:191], v22, s[32:35], s20 offen offset:0 sc0 sc1
v_lshlrev_b32 v196, 16, v160
v_and_b32 v197, 0xffff0000, v160
v_lshlrev_b32 v198, 16, v161
v_and_b32 v199, 0xffff0000, v161
v_fma_f32 v76, v196, v246, v76
v_fma_f32 v77, v197, v246, v77
v_fma_f32 v78, v198, v246, v78
v_fma_f32 v79, v199, v246, v79
v_cvt_pk_bf16_f32 v192, v76, v77
v_cvt_pk_bf16_f32 v193, v78, v79
v_lshlrev_b32 v200, 16, v162
v_and_b32 v201, 0xffff0000, v162
v_lshlrev_b32 v202, 16, v163
v_and_b32 v203, 0xffff0000, v163
v_fma_f32 v88, v200, v246, v88
v_fma_f32 v89, v201, v246, v89
v_fma_f32 v90, v202, v246, v90
v_fma_f32 v91, v203, v246, v91
v_cvt_pk_bf16_f32 v194, v88, v89
v_cvt_pk_bf16_f32 v195, v90, v91
s_nop 0
v_permlane16_swap_b32 v192, v194
v_permlane16_swap_b32 v193, v195
buffer_store_dwordx4 v[192:195], v22, s[32:35], s20 offen offset:2048 sc0 sc1
s_branch l2_kernel_cv_cend
l2_kernel_cv_w3b:
v_add_u32 v4, 12608, v2
v_add_u32 v5, 13632, v2
v_add_u32 v6, 14656, v2
v_add_u32 v7, 15680, v2
v_add_u32 v12, 12608, v3
ds_read_b128 v[92:95], v12 offset:0
ds_read_b128 v[96:99], v12 offset:512
ds_read_b128 v[100:103], v12 offset:1024
ds_read_b128 v[104:107], v12 offset:1536
ds_read_b128 v[108:111], v12 offset:2048
ds_read_b128 v[112:115], v12 offset:2560
ds_read_b128 v[116:119], v12 offset:3072
ds_read_b128 v[120:123], v12 offset:3584
ds_read2_b32 v[156:157], v7 offset0:128 offset1:129
ds_read2_b32 v[158:159], v7 offset0:130 offset1:131
ds_read2_b32 v[160:161], v7 offset0:0 offset1:1
ds_read2_b32 v[162:163], v7 offset0:2 offset1:3
ds_read2_b32 v[164:165], v6 offset0:128 offset1:129
ds_read2_b32 v[166:167], v6 offset0:130 offset1:131
ds_read2_b32 v[168:169], v6 offset0:0 offset1:1
ds_read2_b32 v[170:171], v6 offset0:2 offset1:3
ds_read2_b32 v[172:173], v5 offset0:128 offset1:129
ds_read2_b32 v[174:175], v5 offset0:130 offset1:131
ds_read2_b32 v[176:177], v5 offset0:0 offset1:1
ds_read2_b32 v[178:179], v5 offset0:2 offset1:3
ds_read2_b32 v[180:181], v4 offset0:128 offset1:129
ds_read2_b32 v[182:183], v4 offset0:130 offset1:131
ds_read2_b32 v[184:185], v4 offset0:0 offset1:1
ds_read2_b32 v[186:187], v4 offset0:2 offset1:3
v_add_u32 v8, 26112, v2
v_add_u32 v9, 27136, v2
v_add_u32 v10, 28160, v2
v_add_u32 v11, 29184, v2
v_add_u32 v13, 26112, v3
s_waitcnt lgkmcnt(14)
v_mfma_f32_16x16x32_bf16 v[28:31], v[156:159], v[92:95], 0
ds_read_b128 v[124:127], v13 offset:0
v_mfma_f32_16x16x32_bf16 v[32:35], v[156:159], v[96:99], 0
ds_read_b128 v[128:131], v13 offset:512
v_mfma_f32_16x16x32_bf16 v[36:39], v[156:159], v[100:103], 0
v_mfma_f32_16x16x32_bf16 v[40:43], v[156:159], v[104:107], 0
v_mfma_f32_16x16x32_bf16 v[44:47], v[156:159], v[108:111], 0
v_mfma_f32_16x16x32_bf16 v[48:51], v[156:159], v[112:115], 0
v_mfma_f32_16x16x32_bf16 v[52:55], v[156:159], v[116:119], 0
v_mfma_f32_16x16x32_bf16 v[56:59], v[156:159], v[120:123], 0
ds_read2_b32 v[156:157], v11 offset0:128 offset1:129
ds_read2_b32 v[158:159], v11 offset0:130 offset1:131
s_waitcnt lgkmcnt(15)
v_mfma_f32_16x16x32_bf16 v[32:35], v[160:163], v[92:95], v[32:35]
ds_read_b128 v[132:135], v13 offset:1024
v_mfma_f32_16x16x32_bf16 v[36:39], v[160:163], v[96:99], v[36:39]
ds_read_b128 v[136:139], v13 offset:1536
v_mfma_f32_16x16x32_bf16 v[40:43], v[160:163], v[100:103], v[40:43]
v_mfma_f32_16x16x32_bf16 v[44:47], v[160:163], v[104:107], v[44:47]
v_mfma_f32_16x16x32_bf16 v[48:51], v[160:163], v[108:111], v[48:51]
v_mfma_f32_16x16x32_bf16 v[52:55], v[160:163], v[112:115], v[52:55]
v_mfma_f32_16x16x32_bf16 v[56:59], v[160:163], v[116:119], v[56:59]
ds_read2_b32 v[160:161], v11 offset0:0 offset1:1
ds_read2_b32 v[162:163], v11 offset0:2 offset1:3
s_waitcnt lgkmcnt(15)
v_mfma_f32_16x16x32_bf16 v[36:39], v[164:167], v[92:95], v[36:39]
ds_read_b128 v[140:143], v13 offset:2048
v_mfma_f32_16x16x32_bf16 v[40:43], v[164:167], v[96:99], v[40:43]
ds_read_b128 v[144:147], v13 offset:2560
v_mfma_f32_16x16x32_bf16 v[44:47], v[164:167], v[100:103], v[44:47]
v_mfma_f32_16x16x32_bf16 v[48:51], v[164:167], v[104:107], v[48:51]
v_mfma_f32_16x16x32_bf16 v[52:55], v[164:167], v[108:111], v[52:55]
v_mfma_f32_16x16x32_bf16 v[56:59], v[164:167], v[112:115], v[56:59]
ds_read2_b32 v[164:165], v10 offset0:128 offset1:129
ds_read2_b32 v[166:167], v10 offset0:130 offset1:131
s_waitcnt lgkmcnt(15)
v_mfma_f32_16x16x32_bf16 v[40:43], v[168:171], v[92:95], v[40:43]
ds_read_b128 v[148:151], v13 offset:3072
v_mfma_f32_16x16x32_bf16 v[44:47], v[168:171], v[96:99], v[44:47]
ds_read_b128 v[152:155], v13 offset:3584
v_mfma_f32_16x16x32_bf16 v[48:51], v[168:171], v[100:103], v[48:51]
v_mfma_f32_16x16x32_bf16 v[52:55], v[168:171], v[104:107], v[52:55]
v_mfma_f32_16x16x32_bf16 v[56:59], v[168:171], v[108:111], v[56:59]
ds_read2_b32 v[168:169], v10 offset0:0 offset1:1
ds_read2_b32 v[170:171], v10 offset0:2 offset1:3
s_waitcnt lgkmcnt(15)
v_mfma_f32_16x16x32_bf16 v[44:47], v[172:175], v[92:95], v[44:47]
v_mfma_f32_16x16x32_bf16 v[48:51], v[172:175], v[96:99], v[48:51]
v_mfma_f32_16x16x32_bf16 v[52:55], v[172:175], v[100:103], v[52:55]
v_mfma_f32_16x16x32_bf16 v[56:59], v[172:175], v[104:107], v[56:59]
ds_read2_b32 v[172:173], v9 offset0:128 offset1:129
ds_read2_b32 v[174:175], v9 offset0:130 offset1:131
s_waitcnt lgkmcnt(15)
v_mfma_f32_16x16x32_bf16 v[48:51], v[176:179], v[92:95], v[48:51]
v_mfma_f32_16x16x32_bf16 v[52:55], v[176:179], v[96:99], v[52:55]
v_mfma_f32_16x16x32_bf16 v[56:59], v[176:179], v[100:103], v[56:59]
ds_read2_b32 v[176:177], v9 offset0:0 offset1:1
ds_read2_b32 v[178:179], v9 offset0:2 offset1:3
s_waitcnt lgkmcnt(15)
v_mfma_f32_16x16x32_bf16 v[52:55], v[180:183], v[92:95], v[52:55]
v_mfma_f32_16x16x32_bf16 v[56:59], v[180:183], v[96:99], v[56:59]
ds_read2_b32 v[180:181], v8 offset0:128 offset1:129
ds_read2_b32 v[182:183], v8 offset0:130 offset1:131
s_waitcnt lgkmcnt(15)
v_mfma_f32_16x16x32_bf16 v[56:59], v[184:187], v[92:95], v[56:59]
v_lshlrev_b32 v22, 4, v1
v_add_u32 v22, 125184, v22
ds_write_b128 v22, v[28:31] offset:0
ds_write_b128 v22, v[32:35] offset:1024
ds_write_b128 v22, v[36:39] offset:2048
ds_write_b128 v22, v[40:43] offset:3072
ds_write_b128 v22, v[44:47] offset:4096
ds_write_b128 v22, v[48:51] offset:5120
ds_write_b128 v22, v[52:55] offset:6144
ds_write_b128 v22, v[56:59] offset:7168
v_add_u32 v4, 26048, v2
v_add_u32 v5, 27072, v2
v_add_u32 v6, 28096, v2
v_add_u32 v7, 29120, v2
v_add_u32 v12, 26048, v3
s_waitcnt lgkmcnt(15)
v_mfma_f32_16x16x32_bf16 v[64:67], v[156:159], v[128:131], 0
ds_read_b128 v[92:95], v12 offset:0
v_mfma_f32_16x16x32_bf16 v[68:71], v[156:159], v[132:135], 0
ds_read_b128 v[96:99], v12 offset:512
v_mfma_f32_16x16x32_bf16 v[80:83], v[156:159], v[144:147], 0
v_mfma_f32_16x16x32_bf16 v[84:87], v[156:159], v[148:151], 0
ds_read2_b32 v[156:157], v7 offset0:128 offset1:129
ds_read2_b32 v[158:159], v7 offset0:130 offset1:131
s_waitcnt lgkmcnt(15)
v_mfma_f32_16x16x32_bf16 v[64:67], v[160:163], v[124:127], v[64:67]
ds_read_b128 v[100:103], v12 offset:1024
v_mfma_f32_16x16x32_bf16 v[68:71], v[160:163], v[128:131], v[68:71]
ds_read_b128 v[104:107], v12 offset:1536
v_mfma_f32_16x16x32_bf16 v[80:83], v[160:163], v[140:143], v[80:83]
v_mfma_f32_16x16x32_bf16 v[84:87], v[160:163], v[144:147], v[84:87]
ds_read2_b32 v[160:161], v7 offset0:0 offset1:1
ds_read2_b32 v[162:163], v7 offset0:2 offset1:3
s_waitcnt lgkmcnt(15)
v_mfma_f32_16x16x32_bf16 v[68:71], v[164:167], v[124:127], v[68:71]
ds_read_b128 v[108:111], v12 offset:2048
v_mfma_f32_16x16x32_bf16 v[80:83], v[164:167], v[136:139], v[80:83]
ds_read_b128 v[112:115], v12 offset:2560
v_mfma_f32_16x16x32_bf16 v[84:87], v[164:167], v[140:143], v[84:87]
ds_read2_b32 v[164:165], v6 offset0:128 offset1:129
ds_read2_b32 v[166:167], v6 offset0:130 offset1:131
s_waitcnt lgkmcnt(15)
v_mfma_f32_16x16x32_bf16 v[80:83], v[168:171], v[132:135], v[80:83]
ds_read_b128 v[116:119], v12 offset:3072
v_mfma_f32_16x16x32_bf16 v[84:87], v[168:171], v[136:139], v[84:87]
ds_read_b128 v[120:123], v12 offset:3584
ds_read2_b32 v[168:169], v6 offset0:0 offset1:1
ds_read2_b32 v[170:171], v6 offset0:2 offset1:3
s_waitcnt lgkmcnt(15)
v_mfma_f32_16x16x32_bf16 v[80:83], v[172:175], v[128:131], v[80:83]
v_mfma_f32_16x16x32_bf16 v[84:87], v[172:175], v[132:135], v[84:87]
ds_read2_b32 v[172:173], v5 offset0:128 offset1:129
ds_read2_b32 v[174:175], v5 offset0:130 offset1:131
s_waitcnt lgkmcnt(15)
v_mfma_f32_16x16x32_bf16 v[80:83], v[176:179], v[124:127], v[80:83]
v_mfma_f32_16x16x32_bf16 v[84:87], v[176:179], v[128:131], v[84:87]
ds_read2_b32 v[176:177], v5 offset0:0 offset1:1
ds_read2_b32 v[178:179], v5 offset0:2 offset1:3
s_waitcnt lgkmcnt(15)
v_mfma_f32_16x16x32_bf16 v[84:87], v[180:183], v[124:127], v[84:87]
ds_read2_b32 v[180:181], v4 offset0:128 offset1:129
ds_read2_b32 v[182:183], v4 offset0:130 offset1:131
v_add_u32 v8, 25984, v2
v_add_u32 v9, 27008, v2
v_add_u32 v10, 28032, v2
v_add_u32 v11, 29056, v2
v_add_u32 v13, 25984, v3
s_waitcnt lgkmcnt(9)
v_mfma_f32_16x16x32_bf16 v[64:67], v[156:159], v[96:99], v[64:67]
ds_read_b128 v[124:127], v13 offset:0
v_mfma_f32_16x16x32_bf16 v[68:71], v[156:159], v[100:103], v[68:71]
ds_read_b128 v[128:131], v13 offset:512
v_mfma_f32_16x16x32_bf16 v[80:83], v[156:159], v[112:115], v[80:83]
v_mfma_f32_16x16x32_bf16 v[84:87], v[156:159], v[116:119], v[84:87]
ds_read2_b32 v[156:157], v11 offset0:128 offset1:129
ds_read2_b32 v[158:159], v11 offset0:130 offset1:131
s_waitcnt lgkmcnt(15)
v_mfma_f32_16x16x32_bf16 v[64:67], v[160:163], v[92:95], v[64:67]
ds_read_b128 v[132:135], v13 offset:1024
v_mfma_f32_16x16x32_bf16 v[68:71], v[160:163], v[96:99], v[68:71]
ds_read_b128 v[136:139], v13 offset:1536
v_mfma_f32_16x16x32_bf16 v[80:83], v[160:163], v[108:111], v[80:83]
v_mfma_f32_16x16x32_bf16 v[84:87], v[160:163], v[112:115], v[84:87]
ds_read2_b32 v[160:161], v11 offset0:0 offset1:1
ds_read2_b32 v[162:163], v11 offset0:2 offset1:3
s_waitcnt lgkmcnt(15)
v_mfma_f32_16x16x32_bf16 v[68:71], v[164:167], v[92:95], v[68:71]
ds_read_b128 v[140:143], v13 offset:2048
v_mfma_f32_16x16x32_bf16 v[80:83], v[164:167], v[104:107], v[80:83]
ds_read_b128 v[144:147], v13 offset:2560
v_mfma_f32_16x16x32_bf16 v[84:87], v[164:167], v[108:111], v[84:87]
ds_read2_b32 v[164:165], v10 offset0:128 offset1:129
ds_read2_b32 v[166:167], v10 offset0:130 offset1:131
s_waitcnt lgkmcnt(15)
v_mfma_f32_16x16x32_bf16 v[80:83], v[168:171], v[100:103], v[80:83]
ds_read_b128 v[148:151], v13 offset:3072
v_mfma_f32_16x16x32_bf16 v[84:87], v[168:171], v[104:107], v[84:87]
ds_read_b128 v[152:155], v13 offset:3584
ds_read2_b32 v[168:169], v10 offset0:0 offset1:1
ds_read2_b32 v[170:171], v10 offset0:2 offset1:3
s_waitcnt lgkmcnt(15)
v_mfma_f32_16x16x32_bf16 v[80:83], v[172:175], v[96:99], v[80:83]
v_mfma_f32_16x16x32_bf16 v[84:87], v[172:175], v[100:103], v[84:87]
ds_read2_b32 v[172:173], v9 offset0:128 offset1:129
ds_read2_b32 v[174:175], v9 offset0:130 offset1:131
s_waitcnt lgkmcnt(15)
v_mfma_f32_16x16x32_bf16 v[80:83], v[176:179], v[92:95], v[80:83]
v_mfma_f32_16x16x32_bf16 v[84:87], v[176:179], v[96:99], v[84:87]
ds_read2_b32 v[176:177], v9 offset0:0 offset1:1
ds_read2_b32 v[178:179], v9 offset0:2 offset1:3
s_waitcnt lgkmcnt(15)
v_mfma_f32_16x16x32_bf16 v[84:87], v[180:183], v[92:95], v[84:87]
ds_read2_b32 v[180:181], v8 offset0:128 offset1:129
ds_read2_b32 v[182:183], v8 offset0:130 offset1:131
v_add_u32 v4, 25920, v2
v_add_u32 v5, 26944, v2
v_add_u32 v6, 27968, v2
v_add_u32 v7, 28992, v2
v_add_u32 v12, 25920, v3
s_waitcnt lgkmcnt(9)
v_mfma_f32_16x16x32_bf16 v[64:67], v[156:159], v[128:131], v[64:67]
ds_read_b128 v[92:95], v12 offset:0
v_mfma_f32_16x16x32_bf16 v[68:71], v[156:159], v[132:135], v[68:71]
ds_read_b128 v[96:99], v12 offset:512
v_mfma_f32_16x16x32_bf16 v[80:83], v[156:159], v[144:147], v[80:83]
v_mfma_f32_16x16x32_bf16 v[84:87], v[156:159], v[148:151], v[84:87]
ds_read2_b32 v[156:157], v7 offset0:128 offset1:129
ds_read2_b32 v[158:159], v7 offset0:130 offset1:131
s_waitcnt lgkmcnt(15)
v_mfma_f32_16x16x32_bf16 v[64:67], v[160:163], v[124:127], v[64:67]
ds_read_b128 v[100:103], v12 offset:1024
v_mfma_f32_16x16x32_bf16 v[68:71], v[160:163], v[128:131], v[68:71]
ds_read_b128 v[104:107], v12 offset:1536
v_mfma_f32_16x16x32_bf16 v[80:83], v[160:163], v[140:143], v[80:83]
v_mfma_f32_16x16x32_bf16 v[84:87], v[160:163], v[144:147], v[84:87]
ds_read2_b32 v[160:161], v7 offset0:0 offset1:1
ds_read2_b32 v[162:163], v7 offset0:2 offset1:3
s_waitcnt lgkmcnt(15)
v_mfma_f32_16x16x32_bf16 v[68:71], v[164:167], v[124:127], v[68:71]
ds_read_b128 v[108:111], v12 offset:2048
v_mfma_f32_16x16x32_bf16 v[80:83], v[164:167], v[136:139], v[80:83]
ds_read_b128 v[112:115], v12 offset:2560
v_mfma_f32_16x16x32_bf16 v[84:87], v[164:167], v[140:143], v[84:87]
ds_read2_b32 v[164:165], v6 offset0:128 offset1:129
ds_read2_b32 v[166:167], v6 offset0:130 offset1:131
s_waitcnt lgkmcnt(15)
v_mfma_f32_16x16x32_bf16 v[80:83], v[168:171], v[132:135], v[80:83]
ds_read_b128 v[116:119], v12 offset:3072
v_mfma_f32_16x16x32_bf16 v[84:87], v[168:171], v[136:139], v[84:87]
ds_read_b128 v[120:123], v12 offset:3584
ds_read2_b32 v[168:169], v6 offset0:0 offset1:1
ds_read2_b32 v[170:171], v6 offset0:2 offset1:3
s_waitcnt lgkmcnt(15)
v_mfma_f32_16x16x32_bf16 v[80:83], v[172:175], v[128:131], v[80:83]
v_mfma_f32_16x16x32_bf16 v[84:87], v[172:175], v[132:135], v[84:87]
ds_read2_b32 v[172:173], v5 offset0:128 offset1:129
ds_read2_b32 v[174:175], v5 offset0:130 offset1:131
s_waitcnt lgkmcnt(15)
v_mfma_f32_16x16x32_bf16 v[80:83], v[176:179], v[124:127], v[80:83]
v_mfma_f32_16x16x32_bf16 v[84:87], v[176:179], v[128:131], v[84:87]
ds_read2_b32 v[176:177], v5 offset0:0 offset1:1
ds_read2_b32 v[178:179], v5 offset0:2 offset1:3
s_waitcnt lgkmcnt(15)
v_mfma_f32_16x16x32_bf16 v[84:87], v[180:183], v[124:127], v[84:87]
ds_read2_b32 v[180:181], v4 offset0:128 offset1:129
ds_read2_b32 v[182:183], v4 offset0:130 offset1:131
v_add_u32 v8, 25856, v2
v_add_u32 v9, 26880, v2
v_add_u32 v10, 27904, v2
v_add_u32 v11, 28928, v2
v_add_u32 v13, 25856, v3
s_waitcnt lgkmcnt(9)
v_mfma_f32_16x16x32_bf16 v[64:67], v[156:159], v[96:99], v[64:67]
ds_read_b128 v[124:127], v13 offset:0
v_mfma_f32_16x16x32_bf16 v[68:71], v[156:159], v[100:103], v[68:71]
ds_read_b128 v[128:131], v13 offset:512
v_mfma_f32_16x16x32_bf16 v[80:83], v[156:159], v[112:115], v[80:83]
v_mfma_f32_16x16x32_bf16 v[84:87], v[156:159], v[116:119], v[84:87]
ds_read2_b32 v[156:157], v11 offset0:128 offset1:129
ds_read2_b32 v[158:159], v11 offset0:130 offset1:131
s_waitcnt lgkmcnt(15)
v_mfma_f32_16x16x32_bf16 v[64:67], v[160:163], v[92:95], v[64:67]
ds_read_b128 v[132:135], v13 offset:1024
v_mfma_f32_16x16x32_bf16 v[68:71], v[160:163], v[96:99], v[68:71]
ds_read_b128 v[136:139], v13 offset:1536
v_mfma_f32_16x16x32_bf16 v[80:83], v[160:163], v[108:111], v[80:83]
v_mfma_f32_16x16x32_bf16 v[84:87], v[160:163], v[112:115], v[84:87]
ds_read2_b32 v[160:161], v11 offset0:0 offset1:1
ds_read2_b32 v[162:163], v11 offset0:2 offset1:3
s_waitcnt lgkmcnt(15)
v_mfma_f32_16x16x32_bf16 v[68:71], v[164:167], v[92:95], v[68:71]
ds_read_b128 v[140:143], v13 offset:2048
v_mfma_f32_16x16x32_bf16 v[80:83], v[164:167], v[104:107], v[80:83]
ds_read_b128 v[144:147], v13 offset:2560
v_mfma_f32_16x16x32_bf16 v[84:87], v[164:167], v[108:111], v[84:87]
ds_read2_b32 v[164:165], v10 offset0:128 offset1:129
ds_read2_b32 v[166:167], v10 offset0:130 offset1:131
s_waitcnt lgkmcnt(15)
v_mfma_f32_16x16x32_bf16 v[80:83], v[168:171], v[100:103], v[80:83]
ds_read_b128 v[148:151], v13 offset:3072
v_mfma_f32_16x16x32_bf16 v[84:87], v[168:171], v[104:107], v[84:87]
ds_read_b128 v[152:155], v13 offset:3584
ds_read2_b32 v[168:169], v10 offset0:0 offset1:1
ds_read2_b32 v[170:171], v10 offset0:2 offset1:3
s_waitcnt lgkmcnt(15)
v_mfma_f32_16x16x32_bf16 v[80:83], v[172:175], v[96:99], v[80:83]
v_mfma_f32_16x16x32_bf16 v[84:87], v[172:175], v[100:103], v[84:87]
ds_read2_b32 v[172:173], v9 offset0:128 offset1:129
ds_read2_b32 v[174:175], v9 offset0:130 offset1:131
s_waitcnt lgkmcnt(15)
v_mfma_f32_16x16x32_bf16 v[80:83], v[176:179], v[92:95], v[80:83]
v_mfma_f32_16x16x32_bf16 v[84:87], v[176:179], v[96:99], v[84:87]
ds_read2_b32 v[176:177], v9 offset0:0 offset1:1
ds_read2_b32 v[178:179], v9 offset0:2 offset1:3
s_waitcnt lgkmcnt(15)
v_mfma_f32_16x16x32_bf16 v[84:87], v[180:183], v[92:95], v[84:87]
ds_read2_b32 v[180:181], v8 offset0:128 offset1:129
ds_read2_b32 v[182:183], v8 offset0:130 offset1:131
v_add_u32 v4, 25792, v2
v_add_u32 v5, 26816, v2
v_add_u32 v6, 27840, v2
v_add_u32 v7, 28864, v2
v_add_u32 v12, 25792, v3
s_waitcnt lgkmcnt(9)
v_mfma_f32_16x16x32_bf16 v[64:67], v[156:159], v[128:131], v[64:67]
ds_read_b128 v[92:95], v12 offset:0
v_mfma_f32_16x16x32_bf16 v[68:71], v[156:159], v[132:135], v[68:71]
ds_read_b128 v[96:99], v12 offset:512
v_mfma_f32_16x16x32_bf16 v[80:83], v[156:159], v[144:147], v[80:83]
v_mfma_f32_16x16x32_bf16 v[84:87], v[156:159], v[148:151], v[84:87]
ds_read2_b32 v[156:157], v7 offset0:128 offset1:129
ds_read2_b32 v[158:159], v7 offset0:130 offset1:131
s_waitcnt lgkmcnt(15)
v_mfma_f32_16x16x32_bf16 v[64:67], v[160:163], v[124:127], v[64:67]
ds_read_b128 v[100:103], v12 offset:1024
v_mfma_f32_16x16x32_bf16 v[68:71], v[160:163], v[128:131], v[68:71]
ds_read_b128 v[104:107], v12 offset:1536
v_mfma_f32_16x16x32_bf16 v[80:83], v[160:163], v[140:143], v[80:83]
v_mfma_f32_16x16x32_bf16 v[84:87], v[160:163], v[144:147], v[84:87]
ds_read2_b32 v[160:161], v7 offset0:0 offset1:1
ds_read2_b32 v[162:163], v7 offset0:2 offset1:3
s_waitcnt lgkmcnt(15)
v_mfma_f32_16x16x32_bf16 v[68:71], v[164:167], v[124:127], v[68:71]
ds_read_b128 v[108:111], v12 offset:2048
v_mfma_f32_16x16x32_bf16 v[80:83], v[164:167], v[136:139], v[80:83]
ds_read_b128 v[112:115], v12 offset:2560
v_mfma_f32_16x16x32_bf16 v[84:87], v[164:167], v[140:143], v[84:87]
ds_read2_b32 v[164:165], v6 offset0:128 offset1:129
ds_read2_b32 v[166:167], v6 offset0:130 offset1:131
s_waitcnt lgkmcnt(15)
v_mfma_f32_16x16x32_bf16 v[80:83], v[168:171], v[132:135], v[80:83]
ds_read_b128 v[116:119], v12 offset:3072
v_mfma_f32_16x16x32_bf16 v[84:87], v[168:171], v[136:139], v[84:87]
ds_read_b128 v[120:123], v12 offset:3584
ds_read2_b32 v[168:169], v6 offset0:0 offset1:1
ds_read2_b32 v[170:171], v6 offset0:2 offset1:3
s_waitcnt lgkmcnt(15)
v_mfma_f32_16x16x32_bf16 v[80:83], v[172:175], v[128:131], v[80:83]
v_mfma_f32_16x16x32_bf16 v[84:87], v[172:175], v[132:135], v[84:87]
ds_read2_b32 v[172:173], v5 offset0:128 offset1:129
ds_read2_b32 v[174:175], v5 offset0:130 offset1:131
s_waitcnt lgkmcnt(15)
v_mfma_f32_16x16x32_bf16 v[80:83], v[176:179], v[124:127], v[80:83]
v_mfma_f32_16x16x32_bf16 v[84:87], v[176:179], v[128:131], v[84:87]
ds_read2_b32 v[176:177], v5 offset0:0 offset1:1
ds_read2_b32 v[178:179], v5 offset0:2 offset1:3
s_waitcnt lgkmcnt(15)
v_mfma_f32_16x16x32_bf16 v[84:87], v[180:183], v[124:127], v[84:87]
ds_read2_b32 v[180:181], v4 offset0:128 offset1:129
ds_read2_b32 v[182:183], v4 offset0:130 offset1:131
v_add_u32 v8, 25728, v2
v_add_u32 v9, 26752, v2
v_add_u32 v10, 27776, v2
v_add_u32 v11, 28800, v2
v_add_u32 v13, 25728, v3
s_waitcnt lgkmcnt(9)
v_mfma_f32_16x16x32_bf16 v[64:67], v[156:159], v[96:99], v[64:67]
ds_read_b128 v[124:127], v13 offset:0
v_mfma_f32_16x16x32_bf16 v[68:71], v[156:159], v[100:103], v[68:71]
ds_read_b128 v[128:131], v13 offset:512
v_mfma_f32_16x16x32_bf16 v[80:83], v[156:159], v[112:115], v[80:83]
v_mfma_f32_16x16x32_bf16 v[84:87], v[156:159], v[116:119], v[84:87]
ds_read2_b32 v[156:157], v11 offset0:128 offset1:129
ds_read2_b32 v[158:159], v11 offset0:130 offset1:131
s_waitcnt lgkmcnt(15)
v_mfma_f32_16x16x32_bf16 v[64:67], v[160:163], v[92:95], v[64:67]
ds_read_b128 v[132:135], v13 offset:1024
v_mfma_f32_16x16x32_bf16 v[68:71], v[160:163], v[96:99], v[68:71]
ds_read_b128 v[136:139], v13 offset:1536
v_mfma_f32_16x16x32_bf16 v[80:83], v[160:163], v[108:111], v[80:83]
v_mfma_f32_16x16x32_bf16 v[84:87], v[160:163], v[112:115], v[84:87]
ds_read2_b32 v[160:161], v11 offset0:0 offset1:1
ds_read2_b32 v[162:163], v11 offset0:2 offset1:3
s_waitcnt lgkmcnt(15)
v_mfma_f32_16x16x32_bf16 v[68:71], v[164:167], v[92:95], v[68:71]
ds_read_b128 v[140:143], v13 offset:2048
v_mfma_f32_16x16x32_bf16 v[80:83], v[164:167], v[104:107], v[80:83]
ds_read_b128 v[144:147], v13 offset:2560
v_mfma_f32_16x16x32_bf16 v[84:87], v[164:167], v[108:111], v[84:87]
ds_read2_b32 v[164:165], v10 offset0:128 offset1:129
ds_read2_b32 v[166:167], v10 offset0:130 offset1:131
s_waitcnt lgkmcnt(15)
v_mfma_f32_16x16x32_bf16 v[80:83], v[168:171], v[100:103], v[80:83]
ds_read_b128 v[148:151], v13 offset:3072
v_mfma_f32_16x16x32_bf16 v[84:87], v[168:171], v[104:107], v[84:87]
ds_read_b128 v[152:155], v13 offset:3584
ds_read2_b32 v[168:169], v10 offset0:0 offset1:1
ds_read2_b32 v[170:171], v10 offset0:2 offset1:3
s_waitcnt lgkmcnt(15)
v_mfma_f32_16x16x32_bf16 v[80:83], v[172:175], v[96:99], v[80:83]
v_mfma_f32_16x16x32_bf16 v[84:87], v[172:175], v[100:103], v[84:87]
ds_read2_b32 v[172:173], v9 offset0:128 offset1:129
ds_read2_b32 v[174:175], v9 offset0:130 offset1:131
s_waitcnt lgkmcnt(15)
v_mfma_f32_16x16x32_bf16 v[80:83], v[176:179], v[92:95], v[80:83]
v_mfma_f32_16x16x32_bf16 v[84:87], v[176:179], v[96:99], v[84:87]
ds_read2_b32 v[176:177], v9 offset0:0 offset1:1
ds_read2_b32 v[178:179], v9 offset0:2 offset1:3
s_waitcnt lgkmcnt(15)
v_mfma_f32_16x16x32_bf16 v[84:87], v[180:183], v[92:95], v[84:87]
ds_read2_b32 v[180:181], v8 offset0:128 offset1:129
ds_read2_b32 v[182:183], v8 offset0:130 offset1:131
v_add_u32 v4, 25664, v2
v_add_u32 v5, 26688, v2
v_add_u32 v6, 27712, v2
v_add_u32 v7, 28736, v2
v_add_u32 v12, 25664, v3
s_waitcnt lgkmcnt(9)
v_mfma_f32_16x16x32_bf16 v[64:67], v[156:159], v[128:131], v[64:67]
ds_read_b128 v[92:95], v12 offset:0
v_mfma_f32_16x16x32_bf16 v[68:71], v[156:159], v[132:135], v[68:71]
ds_read_b128 v[96:99], v12 offset:512
v_mfma_f32_16x16x32_bf16 v[80:83], v[156:159], v[144:147], v[80:83]
v_mfma_f32_16x16x32_bf16 v[84:87], v[156:159], v[148:151], v[84:87]
ds_read2_b32 v[156:157], v7 offset0:128 offset1:129
ds_read2_b32 v[158:159], v7 offset0:130 offset1:131
s_waitcnt lgkmcnt(15)
v_mfma_f32_16x16x32_bf16 v[64:67], v[160:163], v[124:127], v[64:67]
ds_read_b128 v[100:103], v12 offset:1024
v_mfma_f32_16x16x32_bf16 v[68:71], v[160:163], v[128:131], v[68:71]
ds_read_b128 v[104:107], v12 offset:1536
v_mfma_f32_16x16x32_bf16 v[80:83], v[160:163], v[140:143], v[80:83]
v_mfma_f32_16x16x32_bf16 v[84:87], v[160:163], v[144:147], v[84:87]
ds_read2_b32 v[160:161], v7 offset0:0 offset1:1
ds_read2_b32 v[162:163], v7 offset0:2 offset1:3
s_waitcnt lgkmcnt(15)
v_mfma_f32_16x16x32_bf16 v[68:71], v[164:167], v[124:127], v[68:71]
ds_read_b128 v[108:111], v12 offset:2048
v_mfma_f32_16x16x32_bf16 v[80:83], v[164:167], v[136:139], v[80:83]
ds_read_b128 v[112:115], v12 offset:2560
v_mfma_f32_16x16x32_bf16 v[84:87], v[164:167], v[140:143], v[84:87]
ds_read2_b32 v[164:165], v6 offset0:128 offset1:129
ds_read2_b32 v[166:167], v6 offset0:130 offset1:131
s_waitcnt lgkmcnt(15)
v_mfma_f32_16x16x32_bf16 v[80:83], v[168:171], v[132:135], v[80:83]
ds_read_b128 v[116:119], v12 offset:3072
v_mfma_f32_16x16x32_bf16 v[84:87], v[168:171], v[136:139], v[84:87]
ds_read_b128 v[120:123], v12 offset:3584
ds_read2_b32 v[168:169], v6 offset0:0 offset1:1
ds_read2_b32 v[170:171], v6 offset0:2 offset1:3
s_waitcnt lgkmcnt(15)
v_mfma_f32_16x16x32_bf16 v[80:83], v[172:175], v[128:131], v[80:83]
v_mfma_f32_16x16x32_bf16 v[84:87], v[172:175], v[132:135], v[84:87]
ds_read2_b32 v[172:173], v5 offset0:128 offset1:129
ds_read2_b32 v[174:175], v5 offset0:130 offset1:131
s_waitcnt lgkmcnt(15)
v_mfma_f32_16x16x32_bf16 v[80:83], v[176:179], v[124:127], v[80:83]
v_mfma_f32_16x16x32_bf16 v[84:87], v[176:179], v[128:131], v[84:87]
ds_read2_b32 v[176:177], v5 offset0:0 offset1:1
ds_read2_b32 v[178:179], v5 offset0:2 offset1:3
s_waitcnt lgkmcnt(15)
v_mfma_f32_16x16x32_bf16 v[84:87], v[180:183], v[124:127], v[84:87]
ds_read2_b32 v[180:181], v4 offset0:128 offset1:129
ds_read2_b32 v[182:183], v4 offset0:130 offset1:131
s_waitcnt lgkmcnt(9)
v_mfma_f32_16x16x32_bf16 v[64:67], v[156:159], v[96:99], v[64:67]
v_mfma_f32_16x16x32_bf16 v[68:71], v[156:159], v[100:103], v[68:71]
v_mfma_f32_16x16x32_bf16 v[80:83], v[156:159], v[112:115], v[80:83]
v_mfma_f32_16x16x32_bf16 v[84:87], v[156:159], v[116:119], v[84:87]
s_waitcnt lgkmcnt(12)
v_mfma_f32_16x16x32_bf16 v[64:67], v[160:163], v[92:95], v[64:67]
v_mfma_f32_16x16x32_bf16 v[68:71], v[160:163], v[96:99], v[68:71]
v_mfma_f32_16x16x32_bf16 v[80:83], v[160:163], v[108:111], v[80:83]
v_mfma_f32_16x16x32_bf16 v[84:87], v[160:163], v[112:115], v[84:87]
s_waitcnt lgkmcnt(10)
v_mfma_f32_16x16x32_bf16 v[68:71], v[164:167], v[92:95], v[68:71]
v_mfma_f32_16x16x32_bf16 v[80:83], v[164:167], v[104:107], v[80:83]
v_mfma_f32_16x16x32_bf16 v[84:87], v[164:167], v[108:111], v[84:87]
s_waitcnt lgkmcnt(6)
v_mfma_f32_16x16x32_bf16 v[80:83], v[168:171], v[100:103], v[80:83]
v_mfma_f32_16x16x32_bf16 v[84:87], v[168:171], v[104:107], v[84:87]
s_waitcnt lgkmcnt(4)
v_mfma_f32_16x16x32_bf16 v[80:83], v[172:175], v[96:99], v[80:83]
v_mfma_f32_16x16x32_bf16 v[84:87], v[172:175], v[100:103], v[84:87]
s_waitcnt lgkmcnt(2)
v_mfma_f32_16x16x32_bf16 v[80:83], v[176:179], v[92:95], v[80:83]
v_mfma_f32_16x16x32_bf16 v[84:87], v[176:179], v[96:99], v[84:87]
s_waitcnt lgkmcnt(0)
v_mfma_f32_16x16x32_bf16 v[84:87], v[180:183], v[92:95], v[84:87]
s_waitcnt lgkmcnt(0)
s_waitcnt vmcnt(0)
v_lshlrev_b32 v244, 16, v244
v_lshlrev_b32 v245, 16, v245
v_lshlrev_b32 v246, 16, v246
s_waitcnt lgkmcnt(0)
v_mov_b32 v14, 153868
v_mov_b32 v15, 3
ds_write_b32 v14, v15
v_lshlrev_b32 v14, 4, v1
v_and_b32 v16, 15, v1
v_lshrrev_b32 v17, 4, v1
v_lshlrev_b32 v18, 5, v16
v_lshl_add_u32 v19, v17, 3, v18
v_add_u32 v19, 96256, v19
ds_read_b64 v[156:157], v19 offset:512
ds_read_b64 v[158:159], v19 offset:1024
ds_read_b64 v[160:161], v19 offset:2560
ds_read_b64 v[162:163], v19 offset:3072
v_lshrrev_b32 v20, 1, v17
v_lshl_add_u32 v20, v20, 4, v18
v_and_b32 v21, 1, v17
v_mul_u32_u24 v22, 512, v21
v_add_u32 v22, v22, v20
s_lshl_b32 s20, s10, 12
s_add_u32 s20, s20, 14745600
s_waitcnt lgkmcnt(0)
v_lshlrev_b32 v196, 16, v156
v_and_b32 v197, 0xffff0000, v156
v_lshlrev_b32 v198, 16, v157
v_and_b32 v199, 0xffff0000, v157
v_fma_f32 v64, v196, v246, v64
v_fma_f32 v65, v197, v246, v65
v_fma_f32 v66, v198, v246, v66
v_fma_f32 v67, v199, v246, v67
v_cvt_pk_bf16_f32 v188, v64, v65
v_cvt_pk_bf16_f32 v189, v66, v67
v_lshlrev_b32 v200, 16, v158
v_and_b32 v201, 0xffff0000, v158
v_lshlrev_b32 v202, 16, v159
v_and_b32 v203, 0xffff0000, v159
v_fma_f32 v68, v200, v246, v68
v_fma_f32 v69, v201, v246, v69
v_fma_f32 v70, v202, v246, v70
v_fma_f32 v71, v203, v246, v71
v_cvt_pk_bf16_f32 v190, v68, v69
v_cvt_pk_bf16_f32 v191, v70, v71
s_nop 0
v_permlane16_swap_b32 v188, v190
v_permlane16_swap_b32 v189, v191
buffer_store_dwordx4 v[188:191], v22, s[32:35], s20 offen offset:512 sc0 sc1
v_lshlrev_b32 v196, 16, v160
v_and_b32 v197, 0xffff0000, v160
v_lshlrev_b32 v198, 16, v161
v_and_b32 v199, 0xffff0000, v161
v_fma_f32 v80, v196, v246, v80
v_fma_f32 v81, v197, v246, v81
v_fma_f32 v82, v198, v246, v82
v_fma_f32 v83, v199, v246, v83
v_cvt_pk_bf16_f32 v192, v80, v81
v_cvt_pk_bf16_f32 v193, v82, v83
v_lshlrev_b32 v200, 16, v162
v_and_b32 v201, 0xffff0000, v162
v_lshlrev_b32 v202, 16, v163
v_and_b32 v203, 0xffff0000, v163
v_fma_f32 v84, v200, v246, v84
v_fma_f32 v85, v201, v246, v85
v_fma_f32 v86, v202, v246, v86
v_fma_f32 v87, v203, v246, v87
v_cvt_pk_bf16_f32 v194, v84, v85
v_cvt_pk_bf16_f32 v195, v86, v87
s_nop 0
v_permlane16_swap_b32 v192, v194
v_permlane16_swap_b32 v193, v195
buffer_store_dwordx4 v[192:195], v22, s[32:35], s20 offen offset:2560 sc0 sc1
l2_kernel_cv_cend:
s_add_u32 s20, s11, 0
s_lshl_b32 s20, s20, 10
s_add_u32 m0, s20, 143616
s_nop 0
buffer_load_dwordx4 v248, s[36:39], s56 offen lds
xt_4:
s_add_u32 s20, s11, 4
s_lshl_b32 s20, s20, 10
s_add_u32 m0, s20, 143616
s_nop 0
buffer_load_dwordx4 v249, s[36:39], s56 offen lds
xt_5:
s_cmp_ge_u32 s11, 2
s_cbranch_scc1 xt_6
s_add_u32 s20, s11, 8
s_lshl_b32 s20, s20, 10
s_add_u32 m0, s20, 143616
s_nop 0
buffer_load_dwordx4 v250, s[36:39], s56 offen lds
xt_6:
v_mov_b32 v14, 153876
s_mov_b32 s59, 0
l2_kernel_late:
ds_read_b32 v15, v14
s_waitcnt lgkmcnt(0)
v_readfirstlane_b32 s58, v15
s_nop 3
s_cmp_ge_u32 s58, 1
s_cbranch_scc1 l2_kernel_late_ok
s_sleep 2
s_add_u32 s59, s59, 1
s_cmp_lt_u32 s59, 0x100000
s_cbranch_scc1 l2_kernel_late
l2_kernel_late_ok:
v_lshrrev_b32 v14, 3, v1
v_lshlrev_b32 v14, 12, v14
v_and_b32 v15, 7, v1
v_lshl_add_u32 v14, v15, 4, v14
s_mul_i32 s20, s5, 327680
s_lshl_b32 s21, s4, 7
s_add_u32 s20, s20, s21
s_add_u32 s57, s20, 14745600
v_lshlrev_b32 v16, 4, v1
v_mov_b32 v100, 0
v_mov_b32 v101, 0
v_mov_b32 v102, 0
v_mov_b32 v103, 0
s_add_u32 s20, s11, 0
s_lshl_b32 s20, s20, 15
s_add_u32 s20, s20, s57
buffer_load_dwordx4 v[92:95], v14, s[32:35], s20 offen sc1
sl_7:
s_add_u32 s20, s11, 4
s_lshl_b32 s20, s20, 15
s_add_u32 s20, s20, s57
buffer_load_dwordx4 v[96:99], v14, s[32:35], s20 offen sc1
sl_8:
s_cmp_ge_u32 s11, 2
s_cbranch_scc1 sl_9
s_add_u32 s20, s11, 8
s_lshl_b32 s20, s20, 15
s_add_u32 s20, s20, s57
buffer_load_dwordx4 v[100:103], v14, s[32:35], s20 offen sc1
sl_9:
s_mov_b32 s40, s28
s_and_b32 s41, s29, 0xffff
s_mov_b32 s42, 0x280000
s_mov_b32 s43, 0x20000
s_lshl_b32 s20, s4, 2
s_add_u32 s20, s20, s11
s_mul_i32 s20, s20, 20480
s_mul_i32 s21, s5, 160
s_add_u32 s23, s20, s21
v_mov_b32 v17, v14
v_mov_b32 v14, v16
v_lshlrev_b32 v7, 4, v1
s_sub_u32 s20, s11, 0
s_and_b32 s20, s20, 3
s_mul_i32 s20, s20, 17408
s_add_u32 s20, s20, 0
v_add_u32 v2, s20, v7
s_sub_u32 s20, s11, 1
s_and_b32 s20, s20, 3
s_mul_i32 s20, s20, 17408
s_add_u32 s20, s20, 0
v_add_u32 v3, s20, v7
s_sub_u32 s20, s11, 2
s_and_b32 s20, s20, 3
s_mul_i32 s20, s20, 17408
s_add_u32 s20, s20, 0
v_add_u32 v4, s20, v7
s_sub_u32 s20, s11, 3
s_and_b32 s20, s20, 3
s_mul_i32 s20, s20, 17408
s_add_u32 s20, s20, 0
v_add_u32 v5, s20, v7
v_and_b32 v6, 15, v1
v_lshrrev_b32 v9, 4, v1
v_lshrrev_b32 v10, 2, v6
v_lshl_add_u32 v10, v9, 2, v10
v_lshlrev_b32 v10, 7, v10
v_and_b32 v11, 3, v6
v_lshl_add_u32 v10, v11, 3, v10
s_lshl_b32 s20, s11, 5
s_add_u32 s20, s20, 133376
v_add_u32 v10, s20, v10
v_mul_u32_u24 v12, 1280, v6
v_lshl_add_u32 v13, v9, 3, v12
v_and_b32 v11, 1, v9
v_lshl_add_u32 v12, v11, 5, v12
v_lshrrev_b32 v11, 1, v9
v_lshl_add_u32 v12, v11, 4, v12
v_mul_u32_u24 v11, 160, v6
v_lshl_add_u32 v11, v9, 3, v11
s_mul_i32 s20, s11, 2560
s_add_u32 s20, s20, 143616
v_add_u32 v11, s20, v11
s_mov_b32 s28, 0xbfb8aa3b
s_mov_b32 s29, 0xbfb8aa3b
s_mov_b32 s26, 1.0
s_mov_b32 s27, 1.0
s_waitcnt vmcnt(0)
s_mov_b32 s59, 0
l2_kernel_sagain:
v_max3_u32 v15, v92, v93, v94
v_max3_u32 v15, v15, v95, v96
v_max3_u32 v15, v15, v97, v98
v_max3_u32 v15, v15, v99, v100
v_max3_u32 v15, v15, v101, v102
v_max_u32 v15, v15, v103
v_cmp_eq_u32 vcc, -1, v15
s_nop 3
s_cmp_eq_u64 vcc, 0
s_cbranch_scc1 l2_kernel_sok
s_add_u32 s59, s59, 1
s_cmp_ge_u32 s59, 0x4000
s_cbranch_scc1 l2_kernel_sok
s_sleep 4
s_add_u32 s20, s11, 0
s_lshl_b32 s20, s20, 15
s_add_u32 s20, s20, s57
buffer_load_dwordx4 v[92:95], v17, s[32:35], s20 offen sc1
sr_10:
s_add_u32 s20, s11, 4
s_lshl_b32 s20, s20, 15
s_add_u32 s20, s20, s57
buffer_load_dwordx4 v[96:99], v17, s[32:35], s20 offen sc1
sr_11:
s_cmp_ge_u32 s11, 2
s_cbranch_scc1 sr_12
s_add_u32 s20, s11, 8
s_lshl_b32 s20, s20, 15
s_add_u32 s20, s20, s57
buffer_load_dwordx4 v[100:103], v17, s[32:35], s20 offen sc1
sr_12:
s_waitcnt vmcnt(0)
s_branch l2_kernel_sagain
l2_kernel_sok:
s_add_u32 s20, s11, 0
s_lshl_b32 s20, s20, 10
s_add_u32 s20, s20, 133376
v_add_u32 v15, s20, v14
ds_write_b128 v15, v[92:95]
sw_13:
s_add_u32 s20, s11, 4
s_lshl_b32 s20, s20, 10
s_add_u32 s20, s20, 133376
v_add_u32 v15, s20, v14
ds_write_b128 v15, v[96:99]
sw_14:
s_cmp_ge_u32 s11, 2
s_cbranch_scc1 sw_15
s_add_u32 s20, s11, 8
s_lshl_b32 s20, s20, 10
s_add_u32 s20, s20, 133376
v_add_u32 v15, s20, v14
ds_write_b128 v15, v[100:103]
sw_15:
s_waitcnt lgkmcnt(0)
s_barrier
s_setprio 0
ds_read_b128 v[96:99], v2 offset:0
ds_read_b128 v[100:103], v2 offset:1024
ds_read_b128 v[104:107], v3 offset:5120
ds_read_b128 v[108:111], v3 offset:6144
ds_read_b128 v[112:115], v4 offset:10240
ds_read_b128 v[116:119], v4 offset:11264
ds_read_b128 v[120:123], v5 offset:15360
ds_read_b128 v[124:127], v5 offset:16384
ds_read_b64_tr_b16 v[128:129], v10 offset:6144
ds_read_b64_tr_b16 v[130:131], v10 offset:8192
ds_read_b64 v[132:133], v11 offset:96
ds_read_b64 v[134:135], v11 offset:128
s_waitcnt lgkmcnt(4)
v_pk_add_f32 v[96:97], v[96:97], v[104:105]
v_pk_add_f32 v[98:99], v[98:99], v[106:107]
v_pk_add_f32 v[96:97], v[96:97], v[112:113]
v_pk_add_f32 v[98:99], v[98:99], v[114:115]
v_pk_add_f32 v[96:97], v[96:97], v[120:121]
v_pk_add_f32 v[98:99], v[98:99], v[122:123]
v_pk_add_f32 v[100:101], v[100:101], v[108:109]
v_pk_add_f32 v[102:103], v[102:103], v[110:111]
v_pk_add_f32 v[100:101], v[100:101], v[116:117]
v_pk_add_f32 v[102:103], v[102:103], v[118:119]
v_pk_add_f32 v[100:101], v[100:101], v[124:125]
v_pk_add_f32 v[102:103], v[102:103], v[126:127]
v_pk_mul_f32 v[136:137], v[96:97], s[28:29]
v_pk_mul_f32 v[138:139], v[98:99], s[28:29]
v_exp_f32 v136, v136
v_exp_f32 v137, v137
v_exp_f32 v138, v138
v_exp_f32 v139, v139
s_waitcnt lgkmcnt(0)
v_lshlrev_b32 v140, 16, v128
v_and_b32 v141, 0xffff0000, v128
v_lshlrev_b32 v142, 16, v129
v_and_b32 v143, 0xffff0000, v129
v_pk_add_f32 v[136:137], v[136:137], s[26:27]
v_pk_add_f32 v[138:139], v[138:139], s[26:27]
v_pk_mul_f32 v[96:97], v[96:97], v[140:141]
v_pk_mul_f32 v[98:99], v[98:99], v[142:143]
v_rcp_f32 v136, v136
v_rcp_f32 v137, v137
v_rcp_f32 v138, v138
v_rcp_f32 v139, v139
v_lshlrev_b32 v140, 16, v132
v_and_b32 v141, 0xffff0000, v132
v_lshlrev_b32 v142, 16, v133
v_and_b32 v143, 0xffff0000, v133
v_pk_fma_f32 v[96:97], v[96:97], v[136:137], v[140:141]
v_pk_fma_f32 v[98:99], v[98:99], v[138:139], v[142:143]
v_cvt_pk_bf16_f32 v144, v96, v97
v_cvt_pk_bf16_f32 v145, v98, v99
v_pk_mul_f32 v[136:137], v[100:101], s[28:29]
v_pk_mul_f32 v[138:139], v[102:103], s[28:29]
v_exp_f32 v136, v136
v_exp_f32 v137, v137
v_exp_f32 v138, v138
v_exp_f32 v139, v139
v_lshlrev_b32 v140, 16, v130
v_and_b32 v141, 0xffff0000, v130
v_lshlrev_b32 v142, 16, v131
v_and_b32 v143, 0xffff0000, v131
v_pk_add_f32 v[136:137], v[136:137], s[26:27]
v_pk_add_f32 v[138:139], v[138:139], s[26:27]
v_pk_mul_f32 v[100:101], v[100:101], v[140:141]
v_pk_mul_f32 v[102:103], v[102:103], v[142:143]
v_rcp_f32 v136, v136
v_rcp_f32 v137, v137
v_rcp_f32 v138, v138
v_rcp_f32 v139, v139
v_lshlrev_b32 v140, 16, v134
v_and_b32 v141, 0xffff0000, v134
v_lshlrev_b32 v142, 16, v135
v_and_b32 v143, 0xffff0000, v135
v_pk_fma_f32 v[100:101], v[100:101], v[136:137], v[140:141]
v_pk_fma_f32 v[102:103], v[102:103], v[138:139], v[142:143]
v_cvt_pk_bf16_f32 v146, v100, v101
v_cvt_pk_bf16_f32 v147, v102, v103
s_nop 0
v_permlane16_swap_b32 v144, v146
v_permlane16_swap_b32 v145, v147
buffer_store_dwordx4 v[144:147], v12, s[40:43], s23 offen offset:96
s_branch l2_kernel_fin
l2_kernel_gemm:
v_lshlrev_b32 v7, 4, v1
s_mul_i32 s20, s6, 57344
s_add_u32 s21, s6, 0
s_and_b32 s21, s21, 3
s_lshl_b32 s21, s21, 10
s_add_u32 s21, s21, s20
v_add_u32 v2, s21, v7
s_add_u32 s21, s6, 1
s_and_b32 s21, s21, 3
s_lshl_b32 s21, s21, 10
s_add_u32 s21, s21, s20
v_add_u32 v3, s21, v7
s_add_u32 s21, s6, 2
s_and_b32 s21, s21, 3
s_lshl_b32 s21, s21, 10
s_add_u32 s21, s21, s20
v_add_u32 v4, s21, v7
s_add_u32 s21, s6, 3
s_and_b32 s21, s21, 3
s_lshl_b32 s21, s21, 10
s_add_u32 s21, s21, s20
v_add_u32 v5, s21, v7
s_mul_i32 s20, s6, 71680
v_add_u32 v6, s20, v7
s_waitcnt lgkmcnt(0)
s_mul_i32 s20, s4, 221184
s_add_u32 s20, s20, 7667712
s_add_u32 s12, s24, s20
s_addc_u32 s13, s25, 0
s_and_b32 s13, s13, 0xffff
s_mov_b32 s14, 0x36000
s_mov_b32 s15, 0x20000
s_mul_i32 s20, s5, 276480
s_add_u32 s20, s20, 5439488
s_add_u32 s16, s24, s20
s_addc_u32 s17, s25, 0
s_and_b32 s17, s17, 0xffff
s_mov_b32 s18, 0x43800
s_mov_b32 s19, 0x20000
s_movk_i32 s22, 4096
s_barrier
buffer_load_dwordx4 v[96:99], v2, s[12:15], 0 offen
buffer_load_dwordx4 v[100:103], v3, s[12:15], 0 offen
buffer_load_dwordx4 v[104:107], v4, s[12:15], 0 offen
buffer_load_dwordx4 v[108:111], v5, s[12:15], 0 offen
buffer_load_dwordx4 v[112:115], v6, s[16:19], 0 offen offset:0
buffer_load_dwordx4 v[116:119], v6, s[16:19], 0 offen offset:1024
buffer_load_dwordx4 v[120:123], v6, s[16:19], 0 offen offset:2048
buffer_load_dwordx4 v[124:127], v6, s[16:19], 0 offen offset:3072
buffer_load_dwordx4 v[128:131], v6, s[16:19], s22 offen
v_add_u32 v2, 0x1000, v2
v_add_u32 v3, 0x1000, v3
v_add_u32 v4, 0x1000, v4
v_add_u32 v5, 0x1000, v5
v_add_u32 v6, 0x1400, v6
buffer_load_dwordx4 v[132:135], v2, s[12:15], 0 offen
buffer_load_dwordx4 v[136:139], v3, s[12:15], 0 offen
buffer_load_dwordx4 v[140:143], v4, s[12:15], 0 offen
buffer_load_dwordx4 v[144:147], v5, s[12:15], 0 offen
buffer_load_dwordx4 v[148:151], v6, s[16:19], 0 offen offset:0
buffer_load_dwordx4 v[152:155], v6, s[16:19], 0 offen offset:1024
buffer_load_dwordx4 v[156:159], v6, s[16:19], 0 offen offset:2048
buffer_load_dwordx4 v[160:163], v6, s[16:19], 0 offen offset:3072
buffer_load_dwordx4 v[164:167], v6, s[16:19], s22 offen
v_add_u32 v2, 0x1000, v2
v_add_u32 v3, 0x1000, v3
v_add_u32 v4, 0x1000, v4
v_add_u32 v5, 0x1000, v5
v_add_u32 v6, 0x1400, v6
buffer_load_dwordx4 v[168:171], v2, s[12:15], 0 offen
buffer_load_dwordx4 v[172:175], v3, s[12:15], 0 offen
buffer_load_dwordx4 v[176:179], v4, s[12:15], 0 offen
buffer_load_dwordx4 v[180:183], v5, s[12:15], 0 offen
buffer_load_dwordx4 v[184:187], v6, s[16:19], 0 offen offset:0
buffer_load_dwordx4 v[188:191], v6, s[16:19], 0 offen offset:1024
buffer_load_dwordx4 v[192:195], v6, s[16:19], 0 offen offset:2048
buffer_load_dwordx4 v[196:199], v6, s[16:19], 0 offen offset:3072
buffer_load_dwordx4 v[200:203], v6, s[16:19], s22 offen
v_add_u32 v2, 0x1000, v2
v_add_u32 v3, 0x1000, v3
v_add_u32 v4, 0x1000, v4
v_add_u32 v5, 0x1000, v5
v_add_u32 v6, 0x1400, v6
s_mov_b32 s40, s28
s_and_b32 s41, s29, 0xffff
s_mov_b32 s42, 0x280000
s_mov_b32 s43, 0x20000
s_waitcnt vmcnt(18)
v_mfma_f32_16x16x32_bf16 v[16:19], v[112:115], v[96:99], 0
buffer_load_dwordx4 v[204:207], v2, s[12:15], 0 offen
v_mfma_f32_16x16x32_bf16 v[36:39], v[112:115], v[100:103], 0
buffer_load_dwordx4 v[208:211], v3, s[12:15], 0 offen
v_mfma_f32_16x16x32_bf16 v[56:59], v[112:115], v[104:107], 0
buffer_load_dwordx4 v[212:215], v4, s[12:15], 0 offen
v_mfma_f32_16x16x32_bf16 v[76:79], v[112:115], v[108:111], 0
buffer_load_dwordx4 v[216:219], v5, s[12:15], 0 offen
v_mfma_f32_16x16x32_bf16 v[20:23], v[116:119], v[96:99], 0
buffer_load_dwordx4 v[220:223], v6, s[16:19], 0 offen offset:0
v_mfma_f32_16x16x32_bf16 v[40:43], v[116:119], v[100:103], 0
buffer_load_dwordx4 v[224:227], v6, s[16:19], 0 offen offset:1024
v_mfma_f32_16x16x32_bf16 v[60:63], v[116:119], v[104:107], 0
buffer_load_dwordx4 v[228:231], v6, s[16:19], 0 offen offset:2048
v_mfma_f32_16x16x32_bf16 v[80:83], v[116:119], v[108:111], 0
buffer_load_dwordx4 v[232:235], v6, s[16:19], 0 offen offset:3072
v_mfma_f32_16x16x32_bf16 v[24:27], v[120:123], v[96:99], 0
buffer_load_dwordx4 v[236:239], v6, s[16:19], s22 offen
v_mfma_f32_16x16x32_bf16 v[44:47], v[120:123], v[100:103], 0
v_add_u32 v2, 0x1000, v2
v_mfma_f32_16x16x32_bf16 v[64:67], v[120:123], v[104:107], 0
v_add_u32 v3, 0x1000, v3
v_mfma_f32_16x16x32_bf16 v[84:87], v[120:123], v[108:111], 0
v_add_u32 v4, 0x1000, v4
v_mfma_f32_16x16x32_bf16 v[28:31], v[124:127], v[96:99], 0
v_add_u32 v5, 0x1000, v5
v_mfma_f32_16x16x32_bf16 v[48:51], v[124:127], v[100:103], 0
v_add_u32 v6, 0x1400, v6
v_mfma_f32_16x16x32_bf16 v[68:71], v[124:127], v[104:107], 0
v_mfma_f32_16x16x32_bf16 v[88:91], v[124:127], v[108:111], 0
v_mfma_f32_16x16x32_bf16 v[32:35], v[128:131], v[96:99], 0
v_mfma_f32_16x16x32_bf16 v[52:55], v[128:131], v[100:103], 0
v_mfma_f32_16x16x32_bf16 v[72:75], v[128:131], v[104:107], 0
v_mfma_f32_16x16x32_bf16 v[92:95], v[128:131], v[108:111], 0
s_waitcnt vmcnt(18)
v_mfma_f32_16x16x32_bf16 v[16:19], v[148:151], v[132:135], v[16:19]
buffer_load_dwordx4 v[96:99], v2, s[12:15], 0 offen
v_mfma_f32_16x16x32_bf16 v[36:39], v[148:151], v[136:139], v[36:39]
buffer_load_dwordx4 v[100:103], v3, s[12:15], 0 offen
v_mfma_f32_16x16x32_bf16 v[56:59], v[148:151], v[140:143], v[56:59]
buffer_load_dwordx4 v[104:107], v4, s[12:15], 0 offen
v_mfma_f32_16x16x32_bf16 v[76:79], v[148:151], v[144:147], v[76:79]
buffer_load_dwordx4 v[108:111], v5, s[12:15], 0 offen
v_mfma_f32_16x16x32_bf16 v[20:23], v[152:155], v[132:135], v[20:23]
buffer_load_dwordx4 v[112:115], v6, s[16:19], 0 offen offset:0
v_mfma_f32_16x16x32_bf16 v[40:43], v[152:155], v[136:139], v[40:43]
buffer_load_dwordx4 v[116:119], v6, s[16:19], 0 offen offset:1024
v_mfma_f32_16x16x32_bf16 v[60:63], v[152:155], v[140:143], v[60:63]
buffer_load_dwordx4 v[120:123], v6, s[16:19], 0 offen offset:2048
v_mfma_f32_16x16x32_bf16 v[80:83], v[152:155], v[144:147], v[80:83]
buffer_load_dwordx4 v[124:127], v6, s[16:19], 0 offen offset:3072
v_mfma_f32_16x16x32_bf16 v[24:27], v[156:159], v[132:135], v[24:27]
buffer_load_dwordx4 v[128:131], v6, s[16:19], s22 offen
v_mfma_f32_16x16x32_bf16 v[44:47], v[156:159], v[136:139], v[44:47]
v_add_u32 v2, 0x1000, v2
v_mfma_f32_16x16x32_bf16 v[64:67], v[156:159], v[140:143], v[64:67]
v_add_u32 v3, 0x1000, v3
v_mfma_f32_16x16x32_bf16 v[84:87], v[156:159], v[144:147], v[84:87]
v_add_u32 v4, 0x1000, v4
v_mfma_f32_16x16x32_bf16 v[28:31], v[160:163], v[132:135], v[28:31]
v_add_u32 v5, 0x1000, v5
v_mfma_f32_16x16x32_bf16 v[48:51], v[160:163], v[136:139], v[48:51]
v_add_u32 v6, 0x1400, v6
v_mfma_f32_16x16x32_bf16 v[68:71], v[160:163], v[140:143], v[68:71]
v_mfma_f32_16x16x32_bf16 v[88:91], v[160:163], v[144:147], v[88:91]
v_mfma_f32_16x16x32_bf16 v[32:35], v[164:167], v[132:135], v[32:35]
v_mfma_f32_16x16x32_bf16 v[52:55], v[164:167], v[136:139], v[52:55]
v_mfma_f32_16x16x32_bf16 v[72:75], v[164:167], v[140:143], v[72:75]
v_mfma_f32_16x16x32_bf16 v[92:95], v[164:167], v[144:147], v[92:95]
s_waitcnt vmcnt(18)
v_mfma_f32_16x16x32_bf16 v[16:19], v[184:187], v[168:171], v[16:19]
buffer_load_dwordx4 v[132:135], v2, s[12:15], 0 offen
v_mfma_f32_16x16x32_bf16 v[36:39], v[184:187], v[172:175], v[36:39]
buffer_load_dwordx4 v[136:139], v3, s[12:15], 0 offen
v_mfma_f32_16x16x32_bf16 v[56:59], v[184:187], v[176:179], v[56:59]
buffer_load_dwordx4 v[140:143], v4, s[12:15], 0 offen
v_mfma_f32_16x16x32_bf16 v[76:79], v[184:187], v[180:183], v[76:79]
buffer_load_dwordx4 v[144:147], v5, s[12:15], 0 offen
v_mfma_f32_16x16x32_bf16 v[20:23], v[188:191], v[168:171], v[20:23]
buffer_load_dwordx4 v[148:151], v6, s[16:19], 0 offen offset:0
v_mfma_f32_16x16x32_bf16 v[40:43], v[188:191], v[172:175], v[40:43]
buffer_load_dwordx4 v[152:155], v6, s[16:19], 0 offen offset:1024
v_mfma_f32_16x16x32_bf16 v[60:63], v[188:191], v[176:179], v[60:63]
buffer_load_dwordx4 v[156:159], v6, s[16:19], 0 offen offset:2048
v_mfma_f32_16x16x32_bf16 v[80:83], v[188:191], v[180:183], v[80:83]
buffer_load_dwordx4 v[160:163], v6, s[16:19], 0 offen offset:3072
v_mfma_f32_16x16x32_bf16 v[24:27], v[192:195], v[168:171], v[24:27]
buffer_load_dwordx4 v[164:167], v6, s[16:19], s22 offen
v_mfma_f32_16x16x32_bf16 v[44:47], v[192:195], v[172:175], v[44:47]
v_add_u32 v2, 0x1000, v2
v_mfma_f32_16x16x32_bf16 v[64:67], v[192:195], v[176:179], v[64:67]
v_add_u32 v3, 0x1000, v3
v_mfma_f32_16x16x32_bf16 v[84:87], v[192:195], v[180:183], v[84:87]
v_add_u32 v4, 0x1000, v4
v_mfma_f32_16x16x32_bf16 v[28:31], v[196:199], v[168:171], v[28:31]
v_add_u32 v5, 0x1000, v5
v_mfma_f32_16x16x32_bf16 v[48:51], v[196:199], v[172:175], v[48:51]
v_add_u32 v6, 0x1400, v6
v_mfma_f32_16x16x32_bf16 v[68:71], v[196:199], v[176:179], v[68:71]
v_mfma_f32_16x16x32_bf16 v[88:91], v[196:199], v[180:183], v[88:91]
v_mfma_f32_16x16x32_bf16 v[32:35], v[200:203], v[168:171], v[32:35]
v_mfma_f32_16x16x32_bf16 v[52:55], v[200:203], v[172:175], v[52:55]
v_mfma_f32_16x16x32_bf16 v[72:75], v[200:203], v[176:179], v[72:75]
v_mfma_f32_16x16x32_bf16 v[92:95], v[200:203], v[180:183], v[92:95]
s_lshl_b32 s20, s4, 2
s_add_u32 s20, s20, s6
s_mul_i32 s20, s20, 20480
s_mul_i32 s21, s5, 160
s_add_u32 s23, s20, s21
v_mov_b32 v10, 0
buffer_load_dword v11, v10, s[40:43], s23 offen
s_waitcnt vmcnt(19)
v_mfma_f32_16x16x32_bf16 v[16:19], v[220:223], v[204:207], v[16:19]
buffer_load_dwordx4 v[168:171], v2, s[12:15], 0 offen
v_mfma_f32_16x16x32_bf16 v[36:39], v[220:223], v[208:211], v[36:39]
buffer_load_dwordx4 v[172:175], v3, s[12:15], 0 offen
v_mfma_f32_16x16x32_bf16 v[56:59], v[220:223], v[212:215], v[56:59]
buffer_load_dwordx4 v[176:179], v4, s[12:15], 0 offen
v_mfma_f32_16x16x32_bf16 v[76:79], v[220:223], v[216:219], v[76:79]
buffer_load_dwordx4 v[180:183], v5, s[12:15], 0 offen
v_mfma_f32_16x16x32_bf16 v[20:23], v[224:227], v[204:207], v[20:23]
buffer_load_dwordx4 v[184:187], v6, s[16:19], 0 offen offset:0
v_mfma_f32_16x16x32_bf16 v[40:43], v[224:227], v[208:211], v[40:43]
buffer_load_dwordx4 v[188:191], v6, s[16:19], 0 offen offset:1024
v_mfma_f32_16x16x32_bf16 v[60:63], v[224:227], v[212:215], v[60:63]
buffer_load_dwordx4 v[192:195], v6, s[16:19], 0 offen offset:2048
v_mfma_f32_16x16x32_bf16 v[80:83], v[224:227], v[216:219], v[80:83]
buffer_load_dwordx4 v[196:199], v6, s[16:19], 0 offen offset:3072
v_mfma_f32_16x16x32_bf16 v[24:27], v[228:231], v[204:207], v[24:27]
buffer_load_dwordx4 v[200:203], v6, s[16:19], s22 offen
v_mfma_f32_16x16x32_bf16 v[44:47], v[228:231], v[208:211], v[44:47]
v_add_u32 v2, 0x1000, v2
v_mfma_f32_16x16x32_bf16 v[64:67], v[228:231], v[212:215], v[64:67]
v_add_u32 v3, 0x1000, v3
v_mfma_f32_16x16x32_bf16 v[84:87], v[228:231], v[216:219], v[84:87]
v_add_u32 v4, 0x1000, v4
v_mfma_f32_16x16x32_bf16 v[28:31], v[232:235], v[204:207], v[28:31]
v_add_u32 v5, 0x1000, v5
v_mfma_f32_16x16x32_bf16 v[48:51], v[232:235], v[208:211], v[48:51]
v_add_u32 v6, 0x1400, v6
v_mfma_f32_16x16x32_bf16 v[68:71], v[232:235], v[212:215], v[68:71]
v_mfma_f32_16x16x32_bf16 v[88:91], v[232:235], v[216:219], v[88:91]
v_mfma_f32_16x16x32_bf16 v[32:35], v[236:239], v[204:207], v[32:35]
v_mfma_f32_16x16x32_bf16 v[52:55], v[236:239], v[208:211], v[52:55]
v_mfma_f32_16x16x32_bf16 v[72:75], v[236:239], v[212:215], v[72:75]
v_mfma_f32_16x16x32_bf16 v[92:95], v[236:239], v[216:219], v[92:95]
s_waitcnt vmcnt(19)
v_mfma_f32_16x16x32_bf16 v[16:19], v[112:115], v[96:99], v[16:19]
buffer_load_dwordx4 v[204:207], v2, s[12:15], 0 offen
v_mfma_f32_16x16x32_bf16 v[36:39], v[112:115], v[100:103], v[36:39]
buffer_load_dwordx4 v[208:211], v3, s[12:15], 0 offen
v_mfma_f32_16x16x32_bf16 v[56:59], v[112:115], v[104:107], v[56:59]
buffer_load_dwordx4 v[212:215], v4, s[12:15], 0 offen
v_mfma_f32_16x16x32_bf16 v[76:79], v[112:115], v[108:111], v[76:79]
buffer_load_dwordx4 v[216:219], v5, s[12:15], 0 offen
v_mfma_f32_16x16x32_bf16 v[20:23], v[116:119], v[96:99], v[20:23]
buffer_load_dwordx4 v[220:223], v6, s[16:19], 0 offen offset:0
v_mfma_f32_16x16x32_bf16 v[40:43], v[116:119], v[100:103], v[40:43]
buffer_load_dwordx4 v[224:227], v6, s[16:19], 0 offen offset:1024
v_mfma_f32_16x16x32_bf16 v[60:63], v[116:119], v[104:107], v[60:63]
buffer_load_dwordx4 v[228:231], v6, s[16:19], 0 offen offset:2048
v_mfma_f32_16x16x32_bf16 v[80:83], v[116:119], v[108:111], v[80:83]
buffer_load_dwordx4 v[232:235], v6, s[16:19], 0 offen offset:3072
v_mfma_f32_16x16x32_bf16 v[24:27], v[120:123], v[96:99], v[24:27]
buffer_load_dwordx4 v[236:239], v6, s[16:19], s22 offen
v_mfma_f32_16x16x32_bf16 v[44:47], v[120:123], v[100:103], v[44:47]
v_add_u32 v2, 0x1000, v2
v_mfma_f32_16x16x32_bf16 v[64:67], v[120:123], v[104:107], v[64:67]
v_add_u32 v3, 0x1000, v3
v_mfma_f32_16x16x32_bf16 v[84:87], v[120:123], v[108:111], v[84:87]
v_add_u32 v4, 0x1000, v4
v_mfma_f32_16x16x32_bf16 v[28:31], v[124:127], v[96:99], v[28:31]
v_add_u32 v5, 0x1000, v5
v_mfma_f32_16x16x32_bf16 v[48:51], v[124:127], v[100:103], v[48:51]
v_add_u32 v6, 0x1400, v6
v_mfma_f32_16x16x32_bf16 v[68:71], v[124:127], v[104:107], v[68:71]
v_mfma_f32_16x16x32_bf16 v[88:91], v[124:127], v[108:111], v[88:91]
v_mfma_f32_16x16x32_bf16 v[32:35], v[128:131], v[96:99], v[32:35]
v_mfma_f32_16x16x32_bf16 v[52:55], v[128:131], v[100:103], v[52:55]
v_mfma_f32_16x16x32_bf16 v[72:75], v[128:131], v[104:107], v[72:75]
v_mfma_f32_16x16x32_bf16 v[92:95], v[128:131], v[108:111], v[92:95]
s_waitcnt vmcnt(19)
v_mfma_f32_16x16x32_bf16 v[16:19], v[148:151], v[132:135], v[16:19]
buffer_load_dwordx4 v[96:99], v2, s[12:15], 0 offen
v_mfma_f32_16x16x32_bf16 v[36:39], v[148:151], v[136:139], v[36:39]
buffer_load_dwordx4 v[100:103], v3, s[12:15], 0 offen
v_mfma_f32_16x16x32_bf16 v[56:59], v[148:151], v[140:143], v[56:59]
buffer_load_dwordx4 v[104:107], v4, s[12:15], 0 offen
v_mfma_f32_16x16x32_bf16 v[76:79], v[148:151], v[144:147], v[76:79]
buffer_load_dwordx4 v[108:111], v5, s[12:15], 0 offen
v_mfma_f32_16x16x32_bf16 v[20:23], v[152:155], v[132:135], v[20:23]
buffer_load_dwordx4 v[112:115], v6, s[16:19], 0 offen offset:0
v_mfma_f32_16x16x32_bf16 v[40:43], v[152:155], v[136:139], v[40:43]
buffer_load_dwordx4 v[116:119], v6, s[16:19], 0 offen offset:1024
v_mfma_f32_16x16x32_bf16 v[60:63], v[152:155], v[140:143], v[60:63]
buffer_load_dwordx4 v[120:123], v6, s[16:19], 0 offen offset:2048
v_mfma_f32_16x16x32_bf16 v[80:83], v[152:155], v[144:147], v[80:83]
buffer_load_dwordx4 v[124:127], v6, s[16:19], 0 offen offset:3072
v_mfma_f32_16x16x32_bf16 v[24:27], v[156:159], v[132:135], v[24:27]
buffer_load_dwordx4 v[128:131], v6, s[16:19], s22 offen
v_mfma_f32_16x16x32_bf16 v[44:47], v[156:159], v[136:139], v[44:47]
v_add_u32 v2, 0x1000, v2
v_mfma_f32_16x16x32_bf16 v[64:67], v[156:159], v[140:143], v[64:67]
v_add_u32 v3, 0x1000, v3
v_mfma_f32_16x16x32_bf16 v[84:87], v[156:159], v[144:147], v[84:87]
v_add_u32 v4, 0x1000, v4
v_mfma_f32_16x16x32_bf16 v[28:31], v[160:163], v[132:135], v[28:31]
v_add_u32 v5, 0x1000, v5
v_mfma_f32_16x16x32_bf16 v[48:51], v[160:163], v[136:139], v[48:51]
v_add_u32 v6, 0x1400, v6
v_mfma_f32_16x16x32_bf16 v[68:71], v[160:163], v[140:143], v[68:71]
v_mfma_f32_16x16x32_bf16 v[88:91], v[160:163], v[144:147], v[88:91]
v_mfma_f32_16x16x32_bf16 v[32:35], v[164:167], v[132:135], v[32:35]
v_mfma_f32_16x16x32_bf16 v[52:55], v[164:167], v[136:139], v[52:55]
v_mfma_f32_16x16x32_bf16 v[72:75], v[164:167], v[140:143], v[72:75]
v_mfma_f32_16x16x32_bf16 v[92:95], v[164:167], v[144:147], v[92:95]
s_waitcnt vmcnt(18)
v_mfma_f32_16x16x32_bf16 v[16:19], v[184:187], v[168:171], v[16:19]
buffer_load_dwordx4 v[132:135], v2, s[12:15], 0 offen
v_mfma_f32_16x16x32_bf16 v[36:39], v[184:187], v[172:175], v[36:39]
buffer_load_dwordx4 v[136:139], v3, s[12:15], 0 offen
v_mfma_f32_16x16x32_bf16 v[56:59], v[184:187], v[176:179], v[56:59]
buffer_load_dwordx4 v[140:143], v4, s[12:15], 0 offen
v_mfma_f32_16x16x32_bf16 v[76:79], v[184:187], v[180:183], v[76:79]
buffer_load_dwordx4 v[144:147], v5, s[12:15], 0 offen
v_mfma_f32_16x16x32_bf16 v[20:23], v[188:191], v[168:171], v[20:23]
buffer_load_dwordx4 v[148:151], v6, s[16:19], 0 offen offset:0
v_mfma_f32_16x16x32_bf16 v[40:43], v[188:191], v[172:175], v[40:43]
buffer_load_dwordx4 v[152:155], v6, s[16:19], 0 offen offset:1024
v_mfma_f32_16x16x32_bf16 v[60:63], v[188:191], v[176:179], v[60:63]
buffer_load_dwordx4 v[156:159], v6, s[16:19], 0 offen offset:2048
v_mfma_f32_16x16x32_bf16 v[80:83], v[188:191], v[180:183], v[80:83]
buffer_load_dwordx4 v[160:163], v6, s[16:19], 0 offen offset:3072
v_mfma_f32_16x16x32_bf16 v[24:27], v[192:195], v[168:171], v[24:27]
buffer_load_dwordx4 v[164:167], v6, s[16:19], s22 offen
v_mfma_f32_16x16x32_bf16 v[44:47], v[192:195], v[172:175], v[44:47]
v_add_u32 v2, 0x1000, v2
v_mfma_f32_16x16x32_bf16 v[64:67], v[192:195], v[176:179], v[64:67]
v_add_u32 v3, 0x1000, v3
v_mfma_f32_16x16x32_bf16 v[84:87], v[192:195], v[180:183], v[84:87]
v_add_u32 v4, 0x1000, v4
v_mfma_f32_16x16x32_bf16 v[28:31], v[196:199], v[168:171], v[28:31]
v_add_u32 v5, 0x1000, v5
v_mfma_f32_16x16x32_bf16 v[48:51], v[196:199], v[172:175], v[48:51]
v_add_u32 v6, 0x1400, v6
v_mfma_f32_16x16x32_bf16 v[68:71], v[196:199], v[176:179], v[68:71]
v_mfma_f32_16x16x32_bf16 v[88:91], v[196:199], v[180:183], v[88:91]
v_mfma_f32_16x16x32_bf16 v[32:35], v[200:203], v[168:171], v[32:35]
v_mfma_f32_16x16x32_bf16 v[52:55], v[200:203], v[172:175], v[52:55]
v_mfma_f32_16x16x32_bf16 v[72:75], v[200:203], v[176:179], v[72:75]
v_mfma_f32_16x16x32_bf16 v[92:95], v[200:203], v[180:183], v[92:95]
s_waitcnt vmcnt(18)
v_mfma_f32_16x16x32_bf16 v[16:19], v[220:223], v[204:207], v[16:19]
buffer_load_dwordx4 v[168:171], v2, s[12:15], 0 offen
v_mfma_f32_16x16x32_bf16 v[36:39], v[220:223], v[208:211], v[36:39]
buffer_load_dwordx4 v[172:175], v3, s[12:15], 0 offen
v_mfma_f32_16x16x32_bf16 v[56:59], v[220:223], v[212:215], v[56:59]
buffer_load_dwordx4 v[176:179], v4, s[12:15], 0 offen
v_mfma_f32_16x16x32_bf16 v[76:79], v[220:223], v[216:219], v[76:79]
buffer_load_dwordx4 v[180:183], v5, s[12:15], 0 offen
v_mfma_f32_16x16x32_bf16 v[20:23], v[224:227], v[204:207], v[20:23]
buffer_load_dwordx4 v[184:187], v6, s[16:19], 0 offen offset:0
v_mfma_f32_16x16x32_bf16 v[40:43], v[224:227], v[208:211], v[40:43]
buffer_load_dwordx4 v[188:191], v6, s[16:19], 0 offen offset:1024
v_mfma_f32_16x16x32_bf16 v[60:63], v[224:227], v[212:215], v[60:63]
buffer_load_dwordx4 v[192:195], v6, s[16:19], 0 offen offset:2048
v_mfma_f32_16x16x32_bf16 v[80:83], v[224:227], v[216:219], v[80:83]
buffer_load_dwordx4 v[196:199], v6, s[16:19], 0 offen offset:3072
v_mfma_f32_16x16x32_bf16 v[24:27], v[228:231], v[204:207], v[24:27]
buffer_load_dwordx4 v[200:203], v6, s[16:19], s22 offen
v_mfma_f32_16x16x32_bf16 v[44:47], v[228:231], v[208:211], v[44:47]
v_add_u32 v2, 0x1000, v2
v_mfma_f32_16x16x32_bf16 v[64:67], v[228:231], v[212:215], v[64:67]
v_add_u32 v3, 0x1000, v3
v_mfma_f32_16x16x32_bf16 v[84:87], v[228:231], v[216:219], v[84:87]
v_add_u32 v4, 0x1000, v4
v_mfma_f32_16x16x32_bf16 v[28:31], v[232:235], v[204:207], v[28:31]
v_add_u32 v5, 0x1000, v5
v_mfma_f32_16x16x32_bf16 v[48:51], v[232:235], v[208:211], v[48:51]
v_add_u32 v6, 0x1400, v6
v_mfma_f32_16x16x32_bf16 v[68:71], v[232:235], v[212:215], v[68:71]
v_mfma_f32_16x16x32_bf16 v[88:91], v[232:235], v[216:219], v[88:91]
v_mfma_f32_16x16x32_bf16 v[32:35], v[236:239], v[204:207], v[32:35]
v_mfma_f32_16x16x32_bf16 v[52:55], v[236:239], v[208:211], v[52:55]
v_mfma_f32_16x16x32_bf16 v[72:75], v[236:239], v[212:215], v[72:75]
v_mfma_f32_16x16x32_bf16 v[92:95], v[236:239], v[216:219], v[92:95]
s_waitcnt vmcnt(18)
v_mfma_f32_16x16x32_bf16 v[16:19], v[112:115], v[96:99], v[16:19]
buffer_load_dwordx4 v[204:207], v2, s[12:15], 0 offen
v_mfma_f32_16x16x32_bf16 v[36:39], v[112:115], v[100:103], v[36:39]
buffer_load_dwordx4 v[208:211], v3, s[12:15], 0 offen
v_mfma_f32_16x16x32_bf16 v[56:59], v[112:115], v[104:107], v[56:59]
buffer_load_dwordx4 v[212:215], v4, s[12:15], 0 offen
v_mfma_f32_16x16x32_bf16 v[76:79], v[112:115], v[108:111], v[76:79]
buffer_load_dwordx4 v[216:219], v5, s[12:15], 0 offen
v_mfma_f32_16x16x32_bf16 v[20:23], v[116:119], v[96:99], v[20:23]
buffer_load_dwordx4 v[220:223], v6, s[16:19], 0 offen offset:0
v_mfma_f32_16x16x32_bf16 v[40:43], v[116:119], v[100:103], v[40:43]
buffer_load_dwordx4 v[224:227], v6, s[16:19], 0 offen offset:1024
v_mfma_f32_16x16x32_bf16 v[60:63], v[116:119], v[104:107], v[60:63]
buffer_load_dwordx4 v[228:231], v6, s[16:19], 0 offen offset:2048
v_mfma_f32_16x16x32_bf16 v[80:83], v[116:119], v[108:111], v[80:83]
buffer_load_dwordx4 v[232:235], v6, s[16:19], 0 offen offset:3072
v_mfma_f32_16x16x32_bf16 v[24:27], v[120:123], v[96:99], v[24:27]
buffer_load_dwordx4 v[236:239], v6, s[16:19], s22 offen
v_mfma_f32_16x16x32_bf16 v[44:47], v[120:123], v[100:103], v[44:47]
v_add_u32 v2, 0x1000, v2
v_mfma_f32_16x16x32_bf16 v[64:67], v[120:123], v[104:107], v[64:67]
v_add_u32 v3, 0x1000, v3
v_mfma_f32_16x16x32_bf16 v[84:87], v[120:123], v[108:111], v[84:87]
v_add_u32 v4, 0x1000, v4
v_mfma_f32_16x16x32_bf16 v[28:31], v[124:127], v[96:99], v[28:31]
v_add_u32 v5, 0x1000, v5
v_mfma_f32_16x16x32_bf16 v[48:51], v[124:127], v[100:103], v[48:51]
v_add_u32 v6, 0x1400, v6
v_mfma_f32_16x16x32_bf16 v[68:71], v[124:127], v[104:107], v[68:71]
v_mfma_f32_16x16x32_bf16 v[88:91], v[124:127], v[108:111], v[88:91]
v_mfma_f32_16x16x32_bf16 v[32:35], v[128:131], v[96:99], v[32:35]
v_mfma_f32_16x16x32_bf16 v[52:55], v[128:131], v[100:103], v[52:55]
v_mfma_f32_16x16x32_bf16 v[72:75], v[128:131], v[104:107], v[72:75]
v_mfma_f32_16x16x32_bf16 v[92:95], v[128:131], v[108:111], v[92:95]
s_cmp_lg_u32 s6, 0
s_cbranch_scc1 late_16
v_mov_b32 v10, 153876
v_mov_b32 v11, 1
ds_write_b32 v10, v11
late_16:
s_waitcnt vmcnt(18)
v_mfma_f32_16x16x32_bf16 v[16:19], v[148:151], v[132:135], v[16:19]
buffer_load_dwordx4 v[96:99], v2, s[12:15], 0 offen
v_mfma_f32_16x16x32_bf16 v[36:39], v[148:151], v[136:139], v[36:39]
buffer_load_dwordx4 v[100:103], v3, s[12:15], 0 offen
v_mfma_f32_16x16x32_bf16 v[56:59], v[148:151], v[140:143], v[56:59]
buffer_load_dwordx4 v[104:107], v4, s[12:15], 0 offen
v_mfma_f32_16x16x32_bf16 v[76:79], v[148:151], v[144:147], v[76:79]
buffer_load_dwordx4 v[108:111], v5, s[12:15], 0 offen
v_mfma_f32_16x16x32_bf16 v[20:23], v[152:155], v[132:135], v[20:23]
buffer_load_dwordx4 v[112:115], v6, s[16:19], 0 offen offset:0
v_mfma_f32_16x16x32_bf16 v[40:43], v[152:155], v[136:139], v[40:43]
buffer_load_dwordx4 v[116:119], v6, s[16:19], 0 offen offset:1024
v_mfma_f32_16x16x32_bf16 v[60:63], v[152:155], v[140:143], v[60:63]
buffer_load_dwordx4 v[120:123], v6, s[16:19], 0 offen offset:2048
v_mfma_f32_16x16x32_bf16 v[80:83], v[152:155], v[144:147], v[80:83]
buffer_load_dwordx4 v[124:127], v6, s[16:19], 0 offen offset:3072
v_mfma_f32_16x16x32_bf16 v[24:27], v[156:159], v[132:135], v[24:27]
buffer_load_dwordx4 v[128:131], v6, s[16:19], s22 offen
v_mfma_f32_16x16x32_bf16 v[44:47], v[156:159], v[136:139], v[44:47]
v_add_u32 v2, 0x1000, v2
v_mfma_f32_16x16x32_bf16 v[64:67], v[156:159], v[140:143], v[64:67]
v_add_u32 v3, 0x1000, v3
v_mfma_f32_16x16x32_bf16 v[84:87], v[156:159], v[144:147], v[84:87]
v_add_u32 v4, 0x1000, v4
v_mfma_f32_16x16x32_bf16 v[28:31], v[160:163], v[132:135], v[28:31]
v_add_u32 v5, 0x1000, v5
v_mfma_f32_16x16x32_bf16 v[48:51], v[160:163], v[136:139], v[48:51]
v_add_u32 v6, 0x1400, v6
v_mfma_f32_16x16x32_bf16 v[68:71], v[160:163], v[140:143], v[68:71]
v_mfma_f32_16x16x32_bf16 v[88:91], v[160:163], v[144:147], v[88:91]
v_mfma_f32_16x16x32_bf16 v[32:35], v[164:167], v[132:135], v[32:35]
v_mfma_f32_16x16x32_bf16 v[52:55], v[164:167], v[136:139], v[52:55]
v_mfma_f32_16x16x32_bf16 v[72:75], v[164:167], v[140:143], v[72:75]
v_mfma_f32_16x16x32_bf16 v[92:95], v[164:167], v[144:147], v[92:95]
s_waitcnt vmcnt(18)
v_mfma_f32_16x16x32_bf16 v[16:19], v[184:187], v[168:171], v[16:19]
buffer_load_dwordx4 v[132:135], v2, s[12:15], 0 offen
v_mfma_f32_16x16x32_bf16 v[36:39], v[184:187], v[172:175], v[36:39]
buffer_load_dwordx4 v[136:139], v3, s[12:15], 0 offen
v_mfma_f32_16x16x32_bf16 v[56:59], v[184:187], v[176:179], v[56:59]
buffer_load_dwordx4 v[140:143], v4, s[12:15], 0 offen
v_mfma_f32_16x16x32_bf16 v[76:79], v[184:187], v[180:183], v[76:79]
buffer_load_dwordx4 v[144:147], v5, s[12:15], 0 offen
v_mfma_f32_16x16x32_bf16 v[20:23], v[188:191], v[168:171], v[20:23]
buffer_load_dwordx4 v[148:151], v6, s[16:19], 0 offen offset:0
v_mfma_f32_16x16x32_bf16 v[40:43], v[188:191], v[172:175], v[40:43]
buffer_load_dwordx4 v[152:155], v6, s[16:19], 0 offen offset:1024
v_mfma_f32_16x16x32_bf16 v[60:63], v[188:191], v[176:179], v[60:63]
buffer_load_dwordx4 v[156:159], v6, s[16:19], 0 offen offset:2048
v_mfma_f32_16x16x32_bf16 v[80:83], v[188:191], v[180:183], v[80:83]
buffer_load_dwordx4 v[160:163], v6, s[16:19], 0 offen offset:3072
v_mfma_f32_16x16x32_bf16 v[24:27], v[192:195], v[168:171], v[24:27]
buffer_load_dwordx4 v[164:167], v6, s[16:19], s22 offen
v_mfma_f32_16x16x32_bf16 v[44:47], v[192:195], v[172:175], v[44:47]
v_add_u32 v2, 0x1000, v2
v_mfma_f32_16x16x32_bf16 v[64:67], v[192:195], v[176:179], v[64:67]
v_add_u32 v3, 0x1000, v3
v_mfma_f32_16x16x32_bf16 v[84:87], v[192:195], v[180:183], v[84:87]
v_add_u32 v4, 0x1000, v4
v_mfma_f32_16x16x32_bf16 v[28:31], v[196:199], v[168:171], v[28:31]
v_add_u32 v5, 0x1000, v5
v_mfma_f32_16x16x32_bf16 v[48:51], v[196:199], v[172:175], v[48:51]
v_add_u32 v6, 0x1400, v6
v_mfma_f32_16x16x32_bf16 v[68:71], v[196:199], v[176:179], v[68:71]
v_mfma_f32_16x16x32_bf16 v[88:91], v[196:199], v[180:183], v[88:91]
v_mfma_f32_16x16x32_bf16 v[32:35], v[200:203], v[168:171], v[32:35]
v_mfma_f32_16x16x32_bf16 v[52:55], v[200:203], v[172:175], v[52:55]
v_mfma_f32_16x16x32_bf16 v[72:75], v[200:203], v[176:179], v[72:75]
v_mfma_f32_16x16x32_bf16 v[92:95], v[200:203], v[180:183], v[92:95]
s_waitcnt vmcnt(18)
v_mfma_f32_16x16x32_bf16 v[16:19], v[220:223], v[204:207], v[16:19]
v_mfma_f32_16x16x32_bf16 v[36:39], v[220:223], v[208:211], v[36:39]
v_mfma_f32_16x16x32_bf16 v[56:59], v[220:223], v[212:215], v[56:59]
v_mfma_f32_16x16x32_bf16 v[76:79], v[220:223], v[216:219], v[76:79]
v_mfma_f32_16x16x32_bf16 v[20:23], v[224:227], v[204:207], v[20:23]
v_mfma_f32_16x16x32_bf16 v[40:43], v[224:227], v[208:211], v[40:43]
v_mfma_f32_16x16x32_bf16 v[60:63], v[224:227], v[212:215], v[60:63]
v_mfma_f32_16x16x32_bf16 v[80:83], v[224:227], v[216:219], v[80:83]
v_mfma_f32_16x16x32_bf16 v[24:27], v[228:231], v[204:207], v[24:27]
v_mfma_f32_16x16x32_bf16 v[44:47], v[228:231], v[208:211], v[44:47]
v_mfma_f32_16x16x32_bf16 v[64:67], v[228:231], v[212:215], v[64:67]
v_mfma_f32_16x16x32_bf16 v[84:87], v[228:231], v[216:219], v[84:87]
v_mfma_f32_16x16x32_bf16 v[28:31], v[232:235], v[204:207], v[28:31]
v_mfma_f32_16x16x32_bf16 v[48:51], v[232:235], v[208:211], v[48:51]
v_mfma_f32_16x16x32_bf16 v[68:71], v[232:235], v[212:215], v[68:71]
v_mfma_f32_16x16x32_bf16 v[88:91], v[232:235], v[216:219], v[88:91]
v_mfma_f32_16x16x32_bf16 v[32:35], v[236:239], v[204:207], v[32:35]
v_mfma_f32_16x16x32_bf16 v[52:55], v[236:239], v[208:211], v[52:55]
v_mfma_f32_16x16x32_bf16 v[72:75], v[236:239], v[212:215], v[72:75]
v_mfma_f32_16x16x32_bf16 v[92:95], v[236:239], v[216:219], v[92:95]
s_waitcnt vmcnt(9)
v_mfma_f32_16x16x32_bf16 v[16:19], v[112:115], v[96:99], v[16:19]
v_mfma_f32_16x16x32_bf16 v[36:39], v[112:115], v[100:103], v[36:39]
v_mfma_f32_16x16x32_bf16 v[56:59], v[112:115], v[104:107], v[56:59]
v_mfma_f32_16x16x32_bf16 v[76:79], v[112:115], v[108:111], v[76:79]
v_mfma_f32_16x16x32_bf16 v[20:23], v[116:119], v[96:99], v[20:23]
v_mfma_f32_16x16x32_bf16 v[40:43], v[116:119], v[100:103], v[40:43]
v_mfma_f32_16x16x32_bf16 v[60:63], v[116:119], v[104:107], v[60:63]
v_mfma_f32_16x16x32_bf16 v[80:83], v[116:119], v[108:111], v[80:83]
v_mfma_f32_16x16x32_bf16 v[24:27], v[120:123], v[96:99], v[24:27]
v_mfma_f32_16x16x32_bf16 v[44:47], v[120:123], v[100:103], v[44:47]
v_mfma_f32_16x16x32_bf16 v[64:67], v[120:123], v[104:107], v[64:67]
v_mfma_f32_16x16x32_bf16 v[84:87], v[120:123], v[108:111], v[84:87]
v_mfma_f32_16x16x32_bf16 v[28:31], v[124:127], v[96:99], v[28:31]
v_mfma_f32_16x16x32_bf16 v[48:51], v[124:127], v[100:103], v[48:51]
v_mfma_f32_16x16x32_bf16 v[68:71], v[124:127], v[104:107], v[68:71]
v_mfma_f32_16x16x32_bf16 v[88:91], v[124:127], v[108:111], v[88:91]
v_mfma_f32_16x16x32_bf16 v[32:35], v[128:131], v[96:99], v[32:35]
v_mfma_f32_16x16x32_bf16 v[52:55], v[128:131], v[100:103], v[52:55]
v_mfma_f32_16x16x32_bf16 v[72:75], v[128:131], v[104:107], v[72:75]
v_mfma_f32_16x16x32_bf16 v[92:95], v[128:131], v[108:111], v[92:95]
s_waitcnt vmcnt(0)
s_mul_i32 s20, s6, 17408
s_add_u32 s20, s20, 0
v_lshlrev_b32 v7, 4, v1
v_add_u32 v8, s20, v7
v_mfma_f32_16x16x32_bf16 v[36:39], v[148:151], v[136:139], v[36:39]
v_mfma_f32_16x16x32_bf16 v[40:43], v[152:155], v[136:139], v[40:43]
v_mfma_f32_16x16x32_bf16 v[44:47], v[156:159], v[136:139], v[44:47]
v_mfma_f32_16x16x32_bf16 v[48:51], v[160:163], v[136:139], v[48:51]
v_mfma_f32_16x16x32_bf16 v[52:55], v[164:167], v[136:139], v[52:55]
v_mfma_f32_16x16x32_bf16 v[56:59], v[148:151], v[140:143], v[56:59]
v_mfma_f32_16x16x32_bf16 v[60:63], v[152:155], v[140:143], v[60:63]
v_mfma_f32_16x16x32_bf16 v[64:67], v[156:159], v[140:143], v[64:67]
v_mfma_f32_16x16x32_bf16 v[68:71], v[160:163], v[140:143], v[68:71]
ds_write_b128 v8, v[36:39] offset:2048
v_mfma_f32_16x16x32_bf16 v[72:75], v[164:167], v[140:143], v[72:75]
ds_write_b128 v8, v[40:43] offset:3072
v_mfma_f32_16x16x32_bf16 v[76:79], v[148:151], v[144:147], v[76:79]
ds_write_b128 v8, v[44:47] offset:4096
v_mfma_f32_16x16x32_bf16 v[80:83], v[152:155], v[144:147], v[80:83]
ds_write_b128 v8, v[48:51] offset:5120
v_mfma_f32_16x16x32_bf16 v[84:87], v[156:159], v[144:147], v[84:87]
ds_write_b128 v8, v[52:55] offset:6144
v_mfma_f32_16x16x32_bf16 v[88:91], v[160:163], v[144:147], v[88:91]
ds_write_b128 v8, v[56:59] offset:7168
v_mfma_f32_16x16x32_bf16 v[92:95], v[164:167], v[144:147], v[92:95]
ds_write_b128 v8, v[60:63] offset:8192
v_mfma_f32_16x16x32_bf16 v[28:31], v[160:163], v[132:135], v[28:31]
ds_write_b128 v8, v[64:67] offset:9216
v_mfma_f32_16x16x32_bf16 v[32:35], v[164:167], v[132:135], v[32:35]
ds_write_b128 v8, v[68:71] offset:10240
v_mfma_f32_16x16x32_bf16 v[16:19], v[148:151], v[132:135], v[16:19]
ds_write_b128 v8, v[72:75] offset:11264
v_mfma_f32_16x16x32_bf16 v[20:23], v[152:155], v[132:135], v[20:23]
ds_write_b128 v8, v[76:79] offset:12288
v_mfma_f32_16x16x32_bf16 v[24:27], v[156:159], v[132:135], v[24:27]
ds_write_b128 v8, v[80:83] offset:13312
ds_write_b128 v8, v[84:87] offset:14336
ds_write_b128 v8, v[88:91] offset:15360
ds_write_b128 v8, v[92:95] offset:16384
ds_write_b128 v8, v[28:31] offset:0
ds_write_b128 v8, v[32:35] offset:1024
s_lshl_b32 s20, s4, 2
s_add_u32 s20, s20, s6
s_mul_i32 s20, s20, 20480
s_mul_i32 s21, s5, 160
s_add_u32 s23, s20, s21
v_lshlrev_b32 v7, 4, v1
s_sub_u32 s20, s6, 1
s_and_b32 s20, s20, 3
s_mul_i32 s20, s20, 17408
s_add_u32 s20, s20, 0
v_add_u32 v2, s20, v7
s_sub_u32 s20, s6, 2
s_and_b32 s20, s20, 3
s_mul_i32 s20, s20, 17408
s_add_u32 s20, s20, 0
v_add_u32 v3, s20, v7
s_sub_u32 s20, s6, 3
s_and_b32 s20, s20, 3
s_mul_i32 s20, s20, 17408
s_add_u32 s20, s20, 0
v_add_u32 v4, s20, v7
v_and_b32 v6, 15, v1
v_lshrrev_b32 v9, 4, v1
v_lshrrev_b32 v10, 2, v6
v_lshl_add_u32 v10, v9, 2, v10
v_lshlrev_b32 v10, 7, v10
v_and_b32 v11, 3, v6
v_lshl_add_u32 v10, v11, 3, v10
s_lshl_b32 s20, s6, 5
s_add_u32 s20, s20, 133376
v_add_u32 v10, s20, v10
v_mul_u32_u24 v12, 1280, v6
v_lshl_add_u32 v13, v9, 3, v12
v_and_b32 v11, 1, v9
v_lshl_add_u32 v12, v11, 5, v12
v_lshrrev_b32 v11, 1, v9
v_lshl_add_u32 v12, v11, 4, v12
v_mul_u32_u24 v11, 160, v6
v_lshl_add_u32 v11, v9, 3, v11
s_mul_i32 s20, s6, 2560
s_add_u32 s20, s20, 143616
v_add_u32 v11, s20, v11
s_mov_b32 s28, 0xbfb8aa3b
s_mov_b32 s29, 0xbfb8aa3b
s_mov_b32 s26, 1.0
s_mov_b32 s27, 1.0
s_waitcnt lgkmcnt(0)
s_barrier
ds_read_b128 v[96:99], v2 offset:2048
ds_read_b128 v[100:103], v2 offset:3072
ds_read_b128 v[104:107], v2 offset:4096
ds_read_b128 v[108:111], v3 offset:7168
ds_read_b128 v[112:115], v3 offset:8192
ds_read_b128 v[116:119], v3 offset:9216
ds_read_b128 v[120:123], v4 offset:12288
ds_read_b128 v[124:127], v4 offset:13312
ds_read_b128 v[128:131], v4 offset:14336
ds_read_b64_tr_b16 v[132:133], v10 offset:0
ds_read_b64_tr_b16 v[134:135], v10 offset:2048
ds_read_b64_tr_b16 v[136:137], v10 offset:4096
ds_read_b64 v[138:139], v11 offset:0
ds_read_b64 v[140:141], v11 offset:32
ds_read_b64 v[142:143], v11 offset:64
s_waitcnt lgkmcnt(6)
v_pk_add_f32 v[16:17], v[16:17], v[96:97]
v_pk_add_f32 v[18:19], v[18:19], v[98:99]
v_pk_add_f32 v[16:17], v[16:17], v[108:109]
v_pk_add_f32 v[18:19], v[18:19], v[110:111]
v_pk_add_f32 v[16:17], v[16:17], v[120:121]
v_pk_add_f32 v[18:19], v[18:19], v[122:123]
v_pk_add_f32 v[20:21], v[20:21], v[100:101]
v_pk_add_f32 v[22:23], v[22:23], v[102:103]
v_pk_add_f32 v[20:21], v[20:21], v[112:113]
v_pk_add_f32 v[22:23], v[22:23], v[114:115]
v_pk_add_f32 v[20:21], v[20:21], v[124:125]
v_pk_add_f32 v[22:23], v[22:23], v[126:127]
v_pk_add_f32 v[24:25], v[24:25], v[104:105]
v_pk_add_f32 v[26:27], v[26:27], v[106:107]
v_pk_add_f32 v[24:25], v[24:25], v[116:117]
v_pk_add_f32 v[26:27], v[26:27], v[118:119]
v_pk_add_f32 v[24:25], v[24:25], v[128:129]
v_pk_add_f32 v[26:27], v[26:27], v[130:131]
v_pk_mul_f32 v[144:145], v[16:17], s[28:29]
v_pk_mul_f32 v[146:147], v[18:19], s[28:29]
v_exp_f32 v144, v144
v_exp_f32 v145, v145
v_exp_f32 v146, v146
v_exp_f32 v147, v147
s_waitcnt lgkmcnt(0)
v_lshlrev_b32 v148, 16, v132
v_and_b32 v149, 0xffff0000, v132
v_lshlrev_b32 v150, 16, v133
v_and_b32 v151, 0xffff0000, v133
v_pk_add_f32 v[144:145], v[144:145], s[26:27]
v_pk_add_f32 v[146:147], v[146:147], s[26:27]
v_pk_mul_f32 v[16:17], v[16:17], v[148:149]
v_pk_mul_f32 v[18:19], v[18:19], v[150:151]
v_rcp_f32 v144, v144
v_rcp_f32 v145, v145
v_rcp_f32 v146, v146
v_rcp_f32 v147, v147
v_lshlrev_b32 v148, 16, v138
v_and_b32 v149, 0xffff0000, v138
v_lshlrev_b32 v150, 16, v139
v_and_b32 v151, 0xffff0000, v139
v_pk_fma_f32 v[16:17], v[16:17], v[144:145], v[148:149]
v_pk_fma_f32 v[18:19], v[18:19], v[146:147], v[150:151]
v_cvt_pk_bf16_f32 v152, v16, v17
v_cvt_pk_bf16_f32 v153, v18, v19
v_pk_mul_f32 v[144:145], v[20:21], s[28:29]
v_pk_mul_f32 v[146:147], v[22:23], s[28:29]
v_exp_f32 v144, v144
v_exp_f32 v145, v145
v_exp_f32 v146, v146
v_exp_f32 v147, v147
v_lshlrev_b32 v148, 16, v134
v_and_b32 v149, 0xffff0000, v134
v_lshlrev_b32 v150, 16, v135
v_and_b32 v151, 0xffff0000, v135
v_pk_add_f32 v[144:145], v[144:145], s[26:27]
v_pk_add_f32 v[146:147], v[146:147], s[26:27]
v_pk_mul_f32 v[20:21], v[20:21], v[148:149]
v_pk_mul_f32 v[22:23], v[22:23], v[150:151]
v_rcp_f32 v144, v144
v_rcp_f32 v145, v145
v_rcp_f32 v146, v146
v_rcp_f32 v147, v147
v_lshlrev_b32 v148, 16, v140
v_and_b32 v149, 0xffff0000, v140
v_lshlrev_b32 v150, 16, v141
v_and_b32 v151, 0xffff0000, v141
v_pk_fma_f32 v[20:21], v[20:21], v[144:145], v[148:149]
v_pk_fma_f32 v[22:23], v[22:23], v[146:147], v[150:151]
v_cvt_pk_bf16_f32 v154, v20, v21
v_cvt_pk_bf16_f32 v155, v22, v23
s_nop 0
v_permlane16_swap_b32 v152, v154
v_permlane16_swap_b32 v153, v155
buffer_store_dwordx4 v[152:155], v12, s[40:43], s23 offen offset:0
v_pk_mul_f32 v[144:145], v[24:25], s[28:29]
v_pk_mul_f32 v[146:147], v[26:27], s[28:29]
v_exp_f32 v144, v144
v_exp_f32 v145, v145
v_exp_f32 v146, v146
v_exp_f32 v147, v147
v_lshlrev_b32 v148, 16, v136
v_and_b32 v149, 0xffff0000, v136
v_lshlrev_b32 v150, 16, v137
v_and_b32 v151, 0xffff0000, v137
v_pk_add_f32 v[144:145], v[144:145], s[26:27]
v_pk_add_f32 v[146:147], v[146:147], s[26:27]
v_pk_mul_f32 v[24:25], v[24:25], v[148:149]
v_pk_mul_f32 v[26:27], v[26:27], v[150:151]
v_rcp_f32 v144, v144
v_rcp_f32 v145, v145
v_rcp_f32 v146, v146
v_rcp_f32 v147, v147
v_lshlrev_b32 v148, 16, v142
v_and_b32 v149, 0xffff0000, v142
v_lshlrev_b32 v150, 16, v143
v_and_b32 v151, 0xffff0000, v143
v_pk_fma_f32 v[24:25], v[24:25], v[144:145], v[148:149]
v_pk_fma_f32 v[26:27], v[26:27], v[146:147], v[150:151]
v_cvt_pk_bf16_f32 v156, v24, v25
v_cvt_pk_bf16_f32 v157, v26, v27
buffer_store_dwordx2 v[156:157], v13, s[40:43], s23 offen offset:64
l2_kernel_fin:
l2_kernel_end:
s_endpgm
l2_code_end:

.section .rodata,"a"
.p2align 6
.amdhsa_kernel l2_kernel
  .amdhsa_next_free_vgpr 256
  .amdhsa_next_free_sgpr 102
  .amdhsa_accum_offset 256
  .amdhsa_group_segment_fixed_size 0
  .amdhsa_kernarg_size 104
  .amdhsa_user_sgpr_count 2
  .amdhsa_user_sgpr_kernarg_segment_ptr 1
  .amdhsa_system_sgpr_workgroup_id_x 1
.end_amdhsa_kernel
```
